```python
import torch

def _softmax(x, axis=-1):
    return torch.softmax(x, dim=axis)
def _gelu(x):
    return torch.nn.functional.gelu(x, approximate="tanh")
def _silu(x):
    return torch.nn.functional.silu(x)
def _sigmoid(x):
    return torch.sigmoid(x)
def _layernorm(x, axis=-1, eps=1e-5):
    m = x.mean(dim=axis, keepdim=True)
    v = x.var(dim=axis, keepdim=True, unbiased=False)
    return (x - m) / torch.sqrt(v + eps)
def _scatter_add(tgt, idx, src, axis=0):
    return tgt.clone().index_add_(axis, idx, src)
def _segment_sum(src, seg, n):
    out = torch.zeros((n,) + src.shape[1:], dtype=src.dtype)
    return out.index_add_(0, seg, src)
def _pad(x, pw):
    flat = tuple(v for pair in reversed(pw) for v in pair)
    return torch.nn.functional.pad(x, flat)

kernel_name = 'parallel_sum__mha_block__mixer_token_mlp__prompt'

def setup_inputs():

    _w = (lambda a: (lambda t: t.to(torch.bfloat16) if t.is_floating_point() else t)(torch.as_tensor(a)))
    def _A_setup():
        B, S, D, H = 1, 2048, 640, 32
        return {
            "x": _w((lambda *s: torch.randn(*s, dtype=torch.bfloat16) * 0.05)(B, S, D)),
            "wqkv": _w((lambda *s: torch.randn(*s, dtype=torch.bfloat16) * 0.05)(D, 3 * D)),
            "wo": _w((lambda *s: torch.randn(*s, dtype=torch.bfloat16) * 0.05)(D, D)),
        }
    _A_in = _A_setup()

    def _B_setup():
        B, S, D, F = 1, 2048, 640, 1728
        return {
            "x": _w((lambda *s: torch.randn(*s, dtype=torch.bfloat16) * 0.05)(B, S, D)),
            "w1": _w((lambda *s: torch.randn(*s, dtype=torch.bfloat16) * 1.6)(S, F) * (S ** -0.5)),
            "b1": _w((lambda *s: torch.randn(*s, dtype=torch.bfloat16) * 12.8)(F) * 0.02),
            "w2": _w((lambda *s: torch.randn(*s, dtype=torch.bfloat16) * 0.8)(F, S) * (F ** -0.5)),
            "b2": _w((lambda *s: torch.randn(*s, dtype=torch.bfloat16) * 12.8)(S) * 0.02),
        }
    _B_in = _B_setup()

    return {
        "A_x": _A_in["x"],
        "A_wqkv": _A_in["wqkv"],
        "A_wo": _A_in["wo"],
        "B_x": _B_in["x"],
        "B_w1": _B_in["w1"],
        "B_b1": _B_in["b1"],
        "B_w2": _B_in["w2"],
        "B_b2": _B_in["b2"],
    }

def reference(A_x, A_wqkv, A_wo, B_x, B_w1, B_b1, B_w2, B_b2):
    def _A_ref(x, wqkv, wo):
        B, S, D = x.shape
        H = 32
        Dh = D // H
        qkv = (lambda x, *d: x.permute(*d))((x @ wqkv).reshape(B, S, 3, H, Dh), 2, 0, 3, 1, 4)
        q, k, v = qkv[0], qkv[1], qkv[2]
        scores = torch.einsum("bhqd,bhkd->bhqk", q, k) * (Dh ** -0.5)
        p = _softmax(scores, axis=-1)
        o = torch.einsum("bhqk,bhkd->bhqd", p, v)
        return (lambda x, *d: x.permute(*d))(o, 0, 2, 1, 3).reshape(B, S, D) @ wo

    def _B_ref(x, w1, b1, w2, b2):
        B, S, D = x.shape
        h = _layernorm(x, axis=-1)
        u = torch.einsum("bsd,sf->bdf", h, w1) + b1
        u = _gelu(u)
        y = torch.einsum("bdf,fs->bds", u, w2) + b2
        return (lambda x, *d: x.permute(*d))(y, 0, 2, 1)

    x = A_x
    xn = _layernorm(x, axis=-1)
    return x + _A_ref(xn, A_wqkv, A_wo) + _B_ref(xn, B_w1, B_b1, B_w2, B_b2)
```

```asm
; @launch grid=(256,1,1) block=(768,1,1) lds=163840
.amdgcn_target "amdgcn-amd-amdhsa--gfx950"
.text
.globl parallel_sum__mha_block__mixer_token_mlp__prompt_kernel
.p2align 8
.type parallel_sum__mha_block__mixer_token_mlp__prompt_kernel,@function
parallel_sum__mha_block__mixer_token_mlp__prompt_kernel:
    s_cmp_ge_u32 s2, 256
    s_cbranch_scc1 parallel_sum__mha_block__mixer_token_mlp__prompt_kernel_end
    s_load_dwordx4 s[4:7], s[0:1], 0
    s_load_dwordx2 s[36:37], s[0:1], 80
    s_load_dwordx2 s[54:55], s[0:1], 72
    s_getpc_b64 s[40:41]
parallel_sum__mha_block__mixer_token_mlp__prompt_kernel_pc0:
    s_add_u32 s40, s40, parallel_sum__mha_block__mixer_token_mlp__prompt_kernel-parallel_sum__mha_block__mixer_token_mlp__prompt_kernel_pc0
    s_addc_u32 s41, s41, (parallel_sum__mha_block__mixer_token_mlp__prompt_kernel-parallel_sum__mha_block__mixer_token_mlp__prompt_kernel_pc0)>>32
    v_min_u32 v22, (code_end-parallel_sum__mha_block__mixer_token_mlp__prompt_kernel)>>7, v0
    v_lshlrev_b32 v22, 7, v22
    v_mov_b32 v23, s41
    v_add_co_u32 v22, vcc, s40, v22
    s_nop 1
    v_addc_co_u32 v23, vcc, 0, v23, vcc
    global_load_dword v39, v[22:23], off
    v_and_b32 v1, 63, v0
    v_lshrrev_b32 v32, 6, v0
    v_and_b32 v2, 31, v0
    v_readfirstlane_b32 s20, v32
    v_lshrrev_b32 v3, 5, v1
    s_and_b32 s3, s2, 7
    s_lshr_b32 s26, s2, 3
    s_lshr_b32 s21, s3, 1
    s_lshl_b32 s21, s21, 2
    s_and_b32 s33, s26, 3
    s_add_u32 s21, s21, s33
    s_and_b32 s22, s3, 1
    s_lshl_b32 s22, s22, 3
    s_lshr_b32 s33, s26, 2
    s_add_u32 s22, s22, s33
    s_bfe_u32 s28, s20, 0x10001
    s_and_b32 s29, s20, 1
    s_mov_b32 s27, 0x3f803f80
    s_mov_b32 s60, 0
    s_cmp_eq_u32 s22, 15
    s_cselect_b32 s58, 8, 4
    s_cmp_ge_u32 s20, 8
    s_cbranch_scc1 parallel_sum__mha_block__mixer_token_mlp__prompt_kernel_side
    s_cmp_eq_u32 s22, 15
    s_cbranch_scc1 parallel_sum__mha_block__mixer_token_mlp__prompt_kernel_idle
    s_cmp_lt_u32 s20, 4
    s_cbranch_scc1 parallel_sum__mha_block__mixer_token_mlp__prompt_kernel_comp
    s_sub_u32 s20, s20, 4
    s_load_dwordx2 s[40:41], s[0:1], 32
    v_lshrrev_b32 v32, 3, v1
    s_lshl_b32 s26, s20, 3
    v_add_u32 v32, s26, v32
    v_mul_u32_u24 v32, 1280, v32
    v_lshrrev_b32 v33, 4, v1
    s_lshl_b32 s26, s29, 2
    v_add_u32 v34, s26, v33
    v_and_b32 v35, 7, v1
    v_xor_b32 v34, v34, v35
    v_lshl_add_u32 v4, v34, 4, v32
    v_add_u32 v5, 40960, v4
    v_add_u32 v6, 81920, v4
    v_add_u32 v7, 122880, v4
    s_lshl_b32 s26, s20, 2
    v_add_u32 v32, s26, v33
    v_mul_u32_u24 v32, 3840, v32
    v_bfe_u32 v34, v1, 2, 2
    v_xor_b32 v34, v34, v33
    v_lshl_add_u32 v32, v34, 6, v32
    v_and_b32 v34, 3, v1
    v_lshl_add_u32 v8, v34, 4, v32
    v_add_u32 v9, 61440, v8
    v_add_u32 v10, 122880, v8
    v_add_u32 v11, 184320, v8
    s_mul_i32 s23, s21, 163840
    s_lshl_b32 s24, s22, 8
    s_lshl_b32 s25, s20, 10
    s_and_b32 s26, s21, 3
    s_mul_i32 s26, s26, 9
    s_lshr_b32 s26, s26, 2
    s_lshl_b32 s33, s22, 2
    s_add_u32 s26, s26, s33
    s_mul_i32 s33, s26, 58255
    s_lshr_b32 s33, s33, 19
    s_mul_i32 s33, s33, 9
    s_sub_u32 s35, s26, s33
    s_lshl_b32 s30, s35, 7
    s_add_u32 s30, s23, s30
    s_mul_i32 s31, s35, 245760
    s_add_u32 s31, s24, s31
    s_add_u32 s23, s23, 1152
    s_add_u32 s24, s24, 2211840
    s_mov_b32 s32, s35
    s_waitcnt lgkmcnt(0)
    s_mov_b32 s8, s4
    s_and_b32 s9, s5, 0xffff
    s_mov_b32 s10, 2621440
    s_mov_b32 s11, 0x00020000
    s_mov_b32 s12, s6
    s_and_b32 s13, s7, 0xffff
    s_mov_b32 s14, 2457600
    s_mov_b32 s15, 0x00020000
    s_mov_b32 s34, 0
    s_add_u32 s26, s25, s34
    s_add_u32 m0, s26, 0
    s_nop 0
    buffer_load_dwordx4 v4, s[8:11], s23 offen  lds
    s_add_u32 m0, s26, 16384
    s_nop 0
    buffer_load_dwordx4 v8, s[12:15], s24 offen  lds
    s_add_u32 m0, s26, 4096
    s_nop 0
    buffer_load_dwordx4 v5, s[8:11], s23 offen  lds
    s_add_u32 m0, s26, 20480
    s_nop 0
    buffer_load_dwordx4 v9, s[12:15], s24 offen  lds
    s_add_u32 m0, s26, 8192
    s_nop 0
    buffer_load_dwordx4 v6, s[8:11], s23 offen  lds
    s_add_u32 m0, s26, 24576
    s_nop 0
    buffer_load_dwordx4 v10, s[12:15], s24 offen  lds
    s_add_u32 m0, s26, 12288
    s_nop 0
    buffer_load_dwordx4 v7, s[8:11], s23 offen  lds
    s_add_u32 m0, s26, 28672
    s_nop 0
    buffer_load_dwordx4 v11, s[12:15], s24 offen  lds
    s_add_u32 s34, s34, 0x8000
    s_and_b32 s34, s34, 0x1ffff
    s_add_u32 s35, s35, 1
    s_cmp_eq_u32 s35, 9
    s_cselect_b32 s38, 1152, 0
    s_cselect_b32 s39, 2211840, 0
    s_add_u32 s23, s23, 128
    s_add_u32 s24, s24, 245760
    s_sub_u32 s23, s23, s38
    s_sub_u32 s24, s24, s39
    s_mov_b32 s23, s30
    s_mov_b32 s24, s31
    s_mov_b32 s35, s32
    s_mov_b32 s33, 9
parallel_sum__mha_block__mixer_token_mlp__prompt_kernel_ll:
    s_add_u32 s26, s25, s34
    s_add_u32 m0, s26, 0
    s_nop 0
    buffer_load_dwordx4 v4, s[8:11], s23 offen  lds
    s_add_u32 m0, s26, 16384
    s_nop 0
    buffer_load_dwordx4 v8, s[12:15], s24 offen  lds
    s_add_u32 m0, s26, 4096
    s_nop 0
    buffer_load_dwordx4 v5, s[8:11], s23 offen  lds
    s_add_u32 m0, s26, 20480
    s_nop 0
    buffer_load_dwordx4 v9, s[12:15], s24 offen  lds
    s_add_u32 m0, s26, 8192
    s_nop 0
    buffer_load_dwordx4 v6, s[8:11], s23 offen  lds
    s_add_u32 m0, s26, 24576
    s_nop 0
    buffer_load_dwordx4 v10, s[12:15], s24 offen  lds
    s_add_u32 m0, s26, 12288
    s_nop 0
    buffer_load_dwordx4 v7, s[8:11], s23 offen  lds
    s_add_u32 m0, s26, 28672
    s_nop 0
    buffer_load_dwordx4 v11, s[12:15], s24 offen  lds
    s_add_u32 s34, s34, 0x8000
    s_and_b32 s34, s34, 0x1ffff
    s_add_u32 s35, s35, 1
    s_cmp_eq_u32 s35, 9
    s_cselect_b32 s38, 1152, 0
    s_cselect_b32 s39, 2211840, 0
    s_add_u32 s23, s23, 128
    s_add_u32 s24, s24, 245760
    s_sub_u32 s23, s23, s38
    s_sub_u32 s24, s24, s39
    s_waitcnt vmcnt(8)
    s_barrier
    s_sub_u32 s33, s33, 1
    s_cmp_lg_u32 s33, 0
    s_cbranch_scc1 parallel_sum__mha_block__mixer_token_mlp__prompt_kernel_ll
    s_mov_b32 s16, s36
    s_and_b32 s17, s37, 0xffff
    s_mov_b32 s18, 24117248
    s_mov_b32 s19, 0x00020000
    s_mov_b32 s44, s54
    s_and_b32 s45, s55, 0xffff
    s_mov_b32 s46, 256
    s_mov_b32 s47, 0x00020000
    v_and_b32 v34, 15, v1
    v_lshlrev_b32 v34, 4, v34
    s_mov_b32 s38, 0x40000
    buffer_load_dword v35, v34, s[44:47], 0 offen sc1
    s_waitcnt vmcnt(1)
    s_barrier
    s_branch parallel_sum__mha_block__mixer_token_mlp__prompt_kernel_chk
parallel_sum__mha_block__mixer_token_mlp__prompt_kernel_poll:
    buffer_load_dword v35, v34, s[44:47], 0 offen sc1
parallel_sum__mha_block__mixer_token_mlp__prompt_kernel_chk:
    s_waitcnt vmcnt(0)
    v_cmp_ne_u32 vcc, 1, v35
    s_nop 4
    s_cbranch_vccz parallel_sum__mha_block__mixer_token_mlp__prompt_kernel_got
    s_sleep 2
    s_sub_u32 s38, s38, 1
    s_cmp_lg_u32 s38, 0
    s_cbranch_scc1 parallel_sum__mha_block__mixer_token_mlp__prompt_kernel_poll
parallel_sum__mha_block__mixer_token_mlp__prompt_kernel_got:
    s_lshl_b32 s26, s21, 10
    s_lshl_b32 s33, s20, 8
    s_add_u32 s26, s26, s33
    s_add_u32 s26, s26, 21626880
    v_lshlrev_b32 v34, 3, v2
    buffer_load_dwordx2 v[36:37], v34, s[16:19], s26 offen sc1
    s_barrier
    s_lshl_b32 s26, s20, 7
    s_add_u32 s26, s26, 141824
    v_lshl_add_u32 v32, v2, 2, s26
    s_waitcnt vmcnt(0)
    ds_write_b32 v32, v36
    ds_write_b32 v32, v37 offset:512
    s_waitcnt lgkmcnt(0)
    s_barrier
    s_branch parallel_sum__mha_block__mixer_token_mlp__prompt_kernel_gemm
parallel_sum__mha_block__mixer_token_mlp__prompt_kernel_side:
    s_setprio 3
    s_load_dwordx2 s[40:41], s[0:1], 32
    s_sub_u32 s20, s20, 8
    s_lshl_b32 s26, s2, 3
    s_lshl_b32 s33, s20, 1
    s_add_u32 s26, s26, s33
    s_mul_i32 s26, s26, 1280
    v_mul_u32_u24 v32, 1280, v3
    v_lshl_add_u32 v33, v2, 4, v32
    v_lshl_add_u32 v34, v2, 3, v32
    s_waitcnt lgkmcnt(0)
    s_mov_b32 s8, s4
    s_and_b32 s9, s5, 0xffff
    s_mov_b32 s10, 2621440
    s_mov_b32 s11, 0x00020000
    s_mov_b32 s16, s36
    s_and_b32 s17, s37, 0xffff
    s_mov_b32 s18, 24117248
    s_mov_b32 s19, 0x00020000
    buffer_load_dwordx4 v[40:43], v33, s[8:11], s26 offen
    buffer_load_dwordx4 v[44:47], v33, s[8:11], s26 offen offset:512
    buffer_load_dwordx2 v[48:49], v34, s[8:11], s26 offen offset:1024
    s_lshl_b32 s26, s20, 1
    v_add_u32 v4, s26, v3
    v_mul_u32_u24 v4, 1344, v4
    v_add_u32 v4, 131072, v4
    v_lshl_add_u32 v5, v2, 3, v4
    v_lshl_add_u32 v4, v2, 4, v4
    v_bfe_u32 v6, v1, 2, 2
    v_mul_u32_u24 v6, 1344, v6
    v_lshrrev_b32 v7, 4, v1
    v_lshl_add_u32 v6, v7, 5, v6
    v_and_b32 v7, 3, v1
    v_lshl_add_u32 v6, v7, 3, v6
    v_add_u32 v6, 131072, v6
    v_lshlrev_b32 v8, 4, v1
    s_lshl_b32 s25, s20, 10
    s_add_u32 s25, s25, 16384
    v_mov_b32 v100, 0
    v_mov_b32 v101, 0
    v_mov_b32 v102, 0
    v_mov_b32 v103, 0
    v_mov_b32 v104, 0
    v_mov_b32 v105, 0
    v_mov_b32 v106, 0
    v_mov_b32 v107, 0
    v_and_b32 v9, 15, v1
    v_lshlrev_b32 v9, 2, v9
    v_add_u32 v9, 140416, v9
    ds_write_b32 v9, v100
    ds_write_b32 v9, v100 offset:1344
    s_mov_b32 s38, 2
    s_waitcnt vmcnt(0)
parallel_sum__mha_block__mixer_token_mlp__prompt_kernel_ln:
    v_mov_b32 v32, 0
    v_mov_b32 v34, 0
    v_dot2_f32_bf16 v32, v40, s27, v32
    v_dot2_f32_bf16 v34, v40, v40, v34
    v_dot2_f32_bf16 v32, v41, s27, v32
    v_dot2_f32_bf16 v34, v41, v41, v34
    v_dot2_f32_bf16 v32, v42, s27, v32
    v_dot2_f32_bf16 v34, v42, v42, v34
    v_dot2_f32_bf16 v32, v43, s27, v32
    v_dot2_f32_bf16 v34, v43, v43, v34
    v_dot2_f32_bf16 v32, v44, s27, v32
    v_dot2_f32_bf16 v34, v44, v44, v34
    v_dot2_f32_bf16 v32, v45, s27, v32
    v_dot2_f32_bf16 v34, v45, v45, v34
    v_dot2_f32_bf16 v32, v46, s27, v32
    v_dot2_f32_bf16 v34, v46, v46, v34
    v_dot2_f32_bf16 v32, v47, s27, v32
    v_dot2_f32_bf16 v34, v47, v47, v34
    v_dot2_f32_bf16 v32, v48, s27, v32
    v_dot2_f32_bf16 v34, v48, v48, v34
    v_dot2_f32_bf16 v32, v49, s27, v32
    v_dot2_f32_bf16 v34, v49, v49, v34
    v_lshlrev_b32 v50, 16, v40
    v_and_b32 v51, 0xffff0000, v40
    v_lshlrev_b32 v52, 16, v41
    v_add_f32_dpp v33, v32, v32 quad_perm:[1,0,3,2] row_mask:0xf bank_mask:0xf
    v_add_f32_dpp v35, v34, v34 quad_perm:[1,0,3,2] row_mask:0xf bank_mask:0xf
    v_and_b32 v53, 0xffff0000, v41
    v_lshlrev_b32 v54, 16, v42
    v_and_b32 v55, 0xffff0000, v42
    v_add_f32_dpp v32, v33, v33 quad_perm:[2,3,0,1] row_mask:0xf bank_mask:0xf
    v_add_f32_dpp v34, v35, v35 quad_perm:[2,3,0,1] row_mask:0xf bank_mask:0xf
    v_lshlrev_b32 v56, 16, v43
    v_and_b32 v57, 0xffff0000, v43
    v_lshlrev_b32 v58, 16, v44
    v_add_f32_dpp v33, v32, v32 row_half_mirror row_mask:0xf bank_mask:0xf
    v_add_f32_dpp v35, v34, v34 row_half_mirror row_mask:0xf bank_mask:0xf
    v_and_b32 v59, 0xffff0000, v44
    v_lshlrev_b32 v60, 16, v45
    v_and_b32 v61, 0xffff0000, v45
    v_add_f32_dpp v32, v33, v33 row_mirror row_mask:0xf bank_mask:0xf
    v_add_f32_dpp v34, v35, v35 row_mirror row_mask:0xf bank_mask:0xf
    v_lshlrev_b32 v62, 16, v46
    v_and_b32 v63, 0xffff0000, v46
    v_lshlrev_b32 v64, 16, v47
    v_mov_b32 v33, v32
    v_mov_b32 v35, v34
    v_and_b32 v65, 0xffff0000, v47
    v_lshlrev_b32 v66, 16, v48
    v_and_b32 v67, 0xffff0000, v48
    v_permlane16_swap_b32 v32, v33
    v_permlane16_swap_b32 v34, v35
    v_lshlrev_b32 v68, 16, v49
    v_and_b32 v69, 0xffff0000, v49
    v_add_f32 v32, v32, v33
    v_add_f32 v34, v34, v35
    v_mul_f32 v32, 0x3acccccd, v32
    v_mul_f32 v34, 0x3acccccd, v34
    v_fma_f32 v34, -v32, v32, v34
    v_max_f32 v34, 0, v34
    v_add_f32 v34, 0x3727c5ac, v34
    v_rsq_f32 v34, v34
    v_pk_add_f32 v[50:51], v[50:51], v[32:33] op_sel_hi:[1,0] neg_lo:[0,1] neg_hi:[0,1]
    v_pk_add_f32 v[52:53], v[52:53], v[32:33] op_sel_hi:[1,0] neg_lo:[0,1] neg_hi:[0,1]
    v_pk_add_f32 v[54:55], v[54:55], v[32:33] op_sel_hi:[1,0] neg_lo:[0,1] neg_hi:[0,1]
    v_pk_add_f32 v[56:57], v[56:57], v[32:33] op_sel_hi:[1,0] neg_lo:[0,1] neg_hi:[0,1]
    v_pk_add_f32 v[58:59], v[58:59], v[32:33] op_sel_hi:[1,0] neg_lo:[0,1] neg_hi:[0,1]
    v_pk_add_f32 v[60:61], v[60:61], v[32:33] op_sel_hi:[1,0] neg_lo:[0,1] neg_hi:[0,1]
    v_pk_add_f32 v[62:63], v[62:63], v[32:33] op_sel_hi:[1,0] neg_lo:[0,1] neg_hi:[0,1]
    v_pk_add_f32 v[64:65], v[64:65], v[32:33] op_sel_hi:[1,0] neg_lo:[0,1] neg_hi:[0,1]
    v_pk_add_f32 v[66:67], v[66:67], v[32:33] op_sel_hi:[1,0] neg_lo:[0,1] neg_hi:[0,1]
    v_pk_add_f32 v[68:69], v[68:69], v[32:33] op_sel_hi:[1,0] neg_lo:[0,1] neg_hi:[0,1]
    v_pk_mul_f32 v[50:51], v[50:51], v[34:35] op_sel_hi:[1,0]
    v_pk_mul_f32 v[52:53], v[52:53], v[34:35] op_sel_hi:[1,0]
    v_pk_mul_f32 v[54:55], v[54:55], v[34:35] op_sel_hi:[1,0]
    v_pk_mul_f32 v[56:57], v[56:57], v[34:35] op_sel_hi:[1,0]
    v_pk_mul_f32 v[58:59], v[58:59], v[34:35] op_sel_hi:[1,0]
    v_pk_mul_f32 v[60:61], v[60:61], v[34:35] op_sel_hi:[1,0]
    v_pk_mul_f32 v[62:63], v[62:63], v[34:35] op_sel_hi:[1,0]
    v_pk_mul_f32 v[64:65], v[64:65], v[34:35] op_sel_hi:[1,0]
    v_pk_mul_f32 v[66:67], v[66:67], v[34:35] op_sel_hi:[1,0]
    v_pk_mul_f32 v[68:69], v[68:69], v[34:35] op_sel_hi:[1,0]
    v_cvt_pk_bf16_f32 v40, v50, v51
    v_cvt_pk_bf16_f32 v41, v52, v53
    v_cvt_pk_bf16_f32 v42, v54, v55
    v_cvt_pk_bf16_f32 v43, v56, v57
    v_cvt_pk_bf16_f32 v44, v58, v59
    v_cvt_pk_bf16_f32 v45, v60, v61
    v_cvt_pk_bf16_f32 v46, v62, v63
    v_cvt_pk_bf16_f32 v47, v64, v65
    v_cvt_pk_bf16_f32 v48, v66, v67
    v_cvt_pk_bf16_f32 v49, v68, v69
    s_sub_u32 s38, s38, 1
    s_cmp_lg_u32 s38, 0
    s_cbranch_scc1 parallel_sum__mha_block__mixer_token_mlp__prompt_kernel_ln
    ds_write_b128 v4, v[40:43]
    ds_write_b128 v4, v[44:47] offset:512
    ds_write_b64 v5, v[48:49] offset:1024
    s_waitcnt lgkmcnt(0)
    s_setprio 0
    s_barrier
    s_add_u32 s26, s20, 0
    s_min_u32 s26, s26, 9
    s_lshl_b32 s33, s26, 7
    v_add_u32 v32, s33, v6
    ds_read_b64_tr_b16 v[72:73], v32
    ds_read_b64_tr_b16 v[74:75], v32 offset:5376
    s_add_u32 s26, s20, 4
    s_min_u32 s26, s26, 9
    s_lshl_b32 s33, s26, 7
    v_add_u32 v33, s33, v6
    ds_read_b64_tr_b16 v[76:77], v33
    ds_read_b64_tr_b16 v[78:79], v33 offset:5376
    s_add_u32 s26, s20, 8
    s_min_u32 s26, s26, 9
    s_lshl_b32 s33, s26, 7
    v_add_u32 v34, s33, v6
    ds_read_b64_tr_b16 v[80:81], v34
    ds_read_b64_tr_b16 v[82:83], v34 offset:5376
    s_cmp_lg_u32 s22, 15
    s_cbranch_scc1 parallel_sum__mha_block__mixer_token_mlp__prompt_kernel_cs0
    s_waitcnt lgkmcnt(0)
    s_mul_i32 s39, s2, 10240
    s_add_u32 s39, s39, 7864320
    s_add_u32 s26, s20, 0
    s_min_u32 s26, s26, 9
    s_lshl_b32 s33, s26, 10
    s_add_u32 s33, s33, s39
    buffer_store_dwordx4 v[72:75], v8, s[16:19], s33 offen sc1
    s_add_u32 s26, s20, 4
    s_min_u32 s26, s26, 9
    s_lshl_b32 s33, s26, 10
    s_add_u32 s33, s33, s39
    buffer_store_dwordx4 v[76:79], v8, s[16:19], s33 offen sc1
    s_add_u32 s26, s20, 8
    s_min_u32 s26, s26, 9
    s_lshl_b32 s33, s26, 10
    s_add_u32 s33, s33, s39
    buffer_store_dwordx4 v[80:83], v8, s[16:19], s33 offen sc1
    s_waitcnt vmcnt(0)
    s_barrier
    s_branch parallel_sum__mha_block__mixer_token_mlp__prompt_kernel_attB
parallel_sum__mha_block__mixer_token_mlp__prompt_kernel_cs0:
    s_mov_b32 s34, 0
    s_mov_b32 s38, 10
parallel_sum__mha_block__mixer_token_mlp__prompt_kernel_cs:
    s_add_u32 s26, s25, s34
    v_add_u32 v9, s26, v8
    ds_read_b128 v[84:87], v9 offset:0
    ds_read_b128 v[88:91], v9 offset:4096
    ds_read_b128 v[92:95], v9 offset:8192
    ds_read_b128 v[96:99], v9 offset:12288
    s_add_u32 s34, s34, 0x8000
    s_and_b32 s34, s34, 0x1ffff
    s_waitcnt lgkmcnt(3)
    v_lshlrev_b32 v108, 16, v84
    v_and_b32 v109, 0xffff0000, v84
    v_lshlrev_b32 v110, 16, v85
    v_and_b32 v111, 0xffff0000, v85
    v_lshlrev_b32 v112, 16, v86
    v_and_b32 v113, 0xffff0000, v86
    v_lshlrev_b32 v114, 16, v87
    v_and_b32 v115, 0xffff0000, v87
    v_add_f32 v100, v100, v108
    v_add_f32 v101, v101, v109
    v_add_f32 v102, v102, v110
    v_add_f32 v103, v103, v111
    v_add_f32 v104, v104, v112
    v_add_f32 v105, v105, v113
    v_add_f32 v106, v106, v114
    v_add_f32 v107, v107, v115
    s_waitcnt lgkmcnt(2)
    v_lshlrev_b32 v108, 16, v88
    v_and_b32 v109, 0xffff0000, v88
    v_lshlrev_b32 v110, 16, v89
    v_and_b32 v111, 0xffff0000, v89
    v_lshlrev_b32 v112, 16, v90
    v_and_b32 v113, 0xffff0000, v90
    v_lshlrev_b32 v114, 16, v91
    v_and_b32 v115, 0xffff0000, v91
    v_add_f32 v100, v100, v108
    v_add_f32 v101, v101, v109
    v_add_f32 v102, v102, v110
    v_add_f32 v103, v103, v111
    v_add_f32 v104, v104, v112
    v_add_f32 v105, v105, v113
    v_add_f32 v106, v106, v114
    v_add_f32 v107, v107, v115
    s_waitcnt lgkmcnt(1)
    v_lshlrev_b32 v108, 16, v92
    v_and_b32 v109, 0xffff0000, v92
    v_lshlrev_b32 v110, 16, v93
    v_and_b32 v111, 0xffff0000, v93
    v_lshlrev_b32 v112, 16, v94
    v_and_b32 v113, 0xffff0000, v94
    v_lshlrev_b32 v114, 16, v95
    v_and_b32 v115, 0xffff0000, v95
    v_add_f32 v100, v100, v108
    v_add_f32 v101, v101, v109
    v_add_f32 v102, v102, v110
    v_add_f32 v103, v103, v111
    v_add_f32 v104, v104, v112
    v_add_f32 v105, v105, v113
    v_add_f32 v106, v106, v114
    v_add_f32 v107, v107, v115
    s_waitcnt lgkmcnt(0)
    v_lshlrev_b32 v108, 16, v96
    v_and_b32 v109, 0xffff0000, v96
    v_lshlrev_b32 v110, 16, v97
    v_and_b32 v111, 0xffff0000, v97
    v_lshlrev_b32 v112, 16, v98
    v_and_b32 v113, 0xffff0000, v98
    v_lshlrev_b32 v114, 16, v99
    v_and_b32 v115, 0xffff0000, v99
    v_add_f32 v100, v100, v108
    v_add_f32 v101, v101, v109
    v_add_f32 v102, v102, v110
    v_add_f32 v103, v103, v111
    v_add_f32 v104, v104, v112
    v_add_f32 v105, v105, v113
    v_add_f32 v106, v106, v114
    v_add_f32 v107, v107, v115
    s_cmp_lg_u32 s38, 3
    s_cbranch_scc1 parallel_sum__mha_block__mixer_token_mlp__prompt_kernel_nh
    s_mul_i32 s39, s2, 10240
    s_add_u32 s39, s39, 7864320
    s_add_u32 s26, s20, 0
    s_min_u32 s26, s26, 9
    s_lshl_b32 s33, s26, 10
    s_add_u32 s33, s33, s39
    buffer_store_dwordx4 v[72:75], v8, s[16:19], s33 offen sc1
    s_add_u32 s26, s20, 4
    s_min_u32 s26, s26, 9
    s_lshl_b32 s33, s26, 10
    s_add_u32 s33, s33, s39
    buffer_store_dwordx4 v[76:79], v8, s[16:19], s33 offen sc1
    s_add_u32 s26, s20, 8
    s_min_u32 s26, s26, 9
    s_lshl_b32 s33, s26, 10
    s_add_u32 s33, s33, s39
    buffer_store_dwordx4 v[80:83], v8, s[16:19], s33 offen sc1
parallel_sum__mha_block__mixer_token_mlp__prompt_kernel_nh:
    s_sub_u32 s38, s38, 1
    s_cmp_eq_u32 s38, 0
    s_cbranch_scc1 parallel_sum__mha_block__mixer_token_mlp__prompt_kernel_cse
    s_barrier
    s_branch parallel_sum__mha_block__mixer_token_mlp__prompt_kernel_cs
parallel_sum__mha_block__mixer_token_mlp__prompt_kernel_cse:
    v_bfe_u32 v32, v1, 2, 2
    v_lshrrev_b32 v33, 4, v1
    v_xor_b32 v32, v32, v33
    v_lshlrev_b32 v32, 7, v32
    v_and_b32 v34, 3, v1
    v_lshl_add_u32 v32, v34, 5, v32
    s_lshl_b32 s26, s20, 11
    s_add_u32 s26, s26, 131072
    v_lshl_add_u32 v32, v33, 9, v32
    v_add_u32 v32, s26, v32
    ds_write_b128 v32, v[100:103]
    ds_write_b128 v32, v[104:107] offset:16
    v_lshlrev_b32 v33, 12, v3
    v_lshl_add_u32 v33, v2, 2, v33
    s_lshl_b32 s26, s20, 7
    s_add_u32 s33, s26, 131072
    v_add_u32 v33, s33, v33
    s_add_u32 s33, s26, 142848
    v_lshl_add_u32 v34, v2, 2, s33
    s_waitcnt lgkmcnt(0)
    s_barrier
    ds_read_b32 v108, v33 offset:0
    ds_read_b32 v109, v33 offset:512
    ds_read_b32 v110, v33 offset:1024
    ds_read_b32 v111, v33 offset:1536
    ds_read_b32 v112, v33 offset:2048
    ds_read_b32 v113, v33 offset:2560
    ds_read_b32 v114, v33 offset:3072
    ds_read_b32 v115, v33 offset:3584
    s_waitcnt lgkmcnt(0)
    v_add_f32 v108, v108, v112
    v_add_f32 v109, v109, v113
    v_add_f32 v110, v110, v114
    v_add_f32 v111, v111, v115
    v_add_f32 v108, v108, v109
    v_add_f32 v110, v110, v111
    v_add_f32 v108, v108, v110
    v_mov_b32 v109, v108
    s_nop 1
    v_permlane32_swap_b32 v108, v109
    v_add_f32 v108, v108, v109
    ds_write_b32 v34, v108
    s_waitcnt vmcnt(0) lgkmcnt(0)
    s_barrier
    s_branch parallel_sum__mha_block__mixer_token_mlp__prompt_kernel_attB
parallel_sum__mha_block__mixer_token_mlp__prompt_kernel_idle:
    s_load_dwordx2 s[42:43], s[0:1], 16
    v_lshrrev_b32 v32, 2, v1
    v_mul_u32_u24 v33, 1280, v32
    v_and_b32 v34, 3, v1
    v_lshl_add_u32 v33, v34, 4, v33
    s_lshl_b32 s26, s21, 3
    s_add_u32 s26, s26, s20
    s_mul_i32 s33, s26, 20480
    s_waitcnt lgkmcnt(0)
    s_mov_b32 s8, s4
    s_and_b32 s9, s5, 0xffff
    s_mov_b32 s10, 2621440
    s_mov_b32 s11, 0x00020000
    s_mov_b32 s16, s36
    s_and_b32 s17, s37, 0xffff
    s_mov_b32 s18, 24117248
    s_mov_b32 s19, 0x00020000
    s_mov_b32 s44, s54
    s_and_b32 s45, s55, 0xffff
    s_mov_b32 s46, 256
    s_mov_b32 s47, 0x00020000
    buffer_load_dwordx4 v[64:67], v33, s[8:11], s33 offen offset:0
    buffer_load_dwordx4 v[68:71], v33, s[8:11], s33 offen offset:64
    buffer_load_dwordx4 v[72:75], v33, s[8:11], s33 offen offset:128
    buffer_load_dwordx4 v[76:79], v33, s[8:11], s33 offen offset:192
    buffer_load_dwordx4 v[80:83], v33, s[8:11], s33 offen offset:256
    buffer_load_dwordx4 v[84:87], v33, s[8:11], s33 offen offset:320
    buffer_load_dwordx4 v[88:91], v33, s[8:11], s33 offen offset:384
    buffer_load_dwordx4 v[92:95], v33, s[8:11], s33 offen offset:448
    buffer_load_dwordx4 v[96:99], v33, s[8:11], s33 offen offset:512
    buffer_load_dwordx4 v[100:103], v33, s[8:11], s33 offen offset:576
    buffer_load_dwordx4 v[104:107], v33, s[8:11], s33 offen offset:640
    buffer_load_dwordx4 v[108:111], v33, s[8:11], s33 offen offset:704
    buffer_load_dwordx4 v[112:115], v33, s[8:11], s33 offen offset:768
    buffer_load_dwordx4 v[116:119], v33, s[8:11], s33 offen offset:832
    buffer_load_dwordx4 v[120:123], v33, s[8:11], s33 offen offset:896
    buffer_load_dwordx4 v[124:127], v33, s[8:11], s33 offen offset:960
    buffer_load_dwordx4 v[128:131], v33, s[8:11], s33 offen offset:1024
    buffer_load_dwordx4 v[132:135], v33, s[8:11], s33 offen offset:1088
    buffer_load_dwordx4 v[136:139], v33, s[8:11], s33 offen offset:1152
    buffer_load_dwordx4 v[140:143], v33, s[8:11], s33 offen offset:1216
    v_mov_b32 v36, 0
    v_mov_b32 v37, 0
    s_waitcnt vmcnt(16)
    v_dot2_f32_bf16 v36, v64, s27, v36
    v_dot2_f32_bf16 v37, v64, v64, v37
    v_dot2_f32_bf16 v36, v65, s27, v36
    v_dot2_f32_bf16 v37, v65, v65, v37
    v_dot2_f32_bf16 v36, v66, s27, v36
    v_dot2_f32_bf16 v37, v66, v66, v37
    v_dot2_f32_bf16 v36, v67, s27, v36
    v_dot2_f32_bf16 v37, v67, v67, v37
    v_dot2_f32_bf16 v36, v68, s27, v36
    v_dot2_f32_bf16 v37, v68, v68, v37
    v_dot2_f32_bf16 v36, v69, s27, v36
    v_dot2_f32_bf16 v37, v69, v69, v37
    v_dot2_f32_bf16 v36, v70, s27, v36
    v_dot2_f32_bf16 v37, v70, v70, v37
    v_dot2_f32_bf16 v36, v71, s27, v36
    v_dot2_f32_bf16 v37, v71, v71, v37
    v_dot2_f32_bf16 v36, v72, s27, v36
    v_dot2_f32_bf16 v37, v72, v72, v37
    v_dot2_f32_bf16 v36, v73, s27, v36
    v_dot2_f32_bf16 v37, v73, v73, v37
    v_dot2_f32_bf16 v36, v74, s27, v36
    v_dot2_f32_bf16 v37, v74, v74, v37
    v_dot2_f32_bf16 v36, v75, s27, v36
    v_dot2_f32_bf16 v37, v75, v75, v37
    v_dot2_f32_bf16 v36, v76, s27, v36
    v_dot2_f32_bf16 v37, v76, v76, v37
    v_dot2_f32_bf16 v36, v77, s27, v36
    v_dot2_f32_bf16 v37, v77, v77, v37
    v_dot2_f32_bf16 v36, v78, s27, v36
    v_dot2_f32_bf16 v37, v78, v78, v37
    v_dot2_f32_bf16 v36, v79, s27, v36
    v_dot2_f32_bf16 v37, v79, v79, v37
    s_waitcnt vmcnt(12)
    v_dot2_f32_bf16 v36, v80, s27, v36
    v_dot2_f32_bf16 v37, v80, v80, v37
    v_dot2_f32_bf16 v36, v81, s27, v36
    v_dot2_f32_bf16 v37, v81, v81, v37
    v_dot2_f32_bf16 v36, v82, s27, v36
    v_dot2_f32_bf16 v37, v82, v82, v37
    v_dot2_f32_bf16 v36, v83, s27, v36
    v_dot2_f32_bf16 v37, v83, v83, v37
    v_dot2_f32_bf16 v36, v84, s27, v36
    v_dot2_f32_bf16 v37, v84, v84, v37
    v_dot2_f32_bf16 v36, v85, s27, v36
    v_dot2_f32_bf16 v37, v85, v85, v37
    v_dot2_f32_bf16 v36, v86, s27, v36
    v_dot2_f32_bf16 v37, v86, v86, v37
    v_dot2_f32_bf16 v36, v87, s27, v36
    v_dot2_f32_bf16 v37, v87, v87, v37
    v_dot2_f32_bf16 v36, v88, s27, v36
    v_dot2_f32_bf16 v37, v88, v88, v37
    v_dot2_f32_bf16 v36, v89, s27, v36
    v_dot2_f32_bf16 v37, v89, v89, v37
    v_dot2_f32_bf16 v36, v90, s27, v36
    v_dot2_f32_bf16 v37, v90, v90, v37
    v_dot2_f32_bf16 v36, v91, s27, v36
    v_dot2_f32_bf16 v37, v91, v91, v37
    v_dot2_f32_bf16 v36, v92, s27, v36
    v_dot2_f32_bf16 v37, v92, v92, v37
    v_dot2_f32_bf16 v36, v93, s27, v36
    v_dot2_f32_bf16 v37, v93, v93, v37
    v_dot2_f32_bf16 v36, v94, s27, v36
    v_dot2_f32_bf16 v37, v94, v94, v37
    v_dot2_f32_bf16 v36, v95, s27, v36
    v_dot2_f32_bf16 v37, v95, v95, v37
    s_waitcnt vmcnt(8)
    v_dot2_f32_bf16 v36, v96, s27, v36
    v_dot2_f32_bf16 v37, v96, v96, v37
    v_dot2_f32_bf16 v36, v97, s27, v36
    v_dot2_f32_bf16 v37, v97, v97, v37
    v_dot2_f32_bf16 v36, v98, s27, v36
    v_dot2_f32_bf16 v37, v98, v98, v37
    v_dot2_f32_bf16 v36, v99, s27, v36
    v_dot2_f32_bf16 v37, v99, v99, v37
    v_dot2_f32_bf16 v36, v100, s27, v36
    v_dot2_f32_bf16 v37, v100, v100, v37
    v_dot2_f32_bf16 v36, v101, s27, v36
    v_dot2_f32_bf16 v37, v101, v101, v37
    v_dot2_f32_bf16 v36, v102, s27, v36
    v_dot2_f32_bf16 v37, v102, v102, v37
    v_dot2_f32_bf16 v36, v103, s27, v36
    v_dot2_f32_bf16 v37, v103, v103, v37
    v_dot2_f32_bf16 v36, v104, s27, v36
    v_dot2_f32_bf16 v37, v104, v104, v37
    v_dot2_f32_bf16 v36, v105, s27, v36
    v_dot2_f32_bf16 v37, v105, v105, v37
    v_dot2_f32_bf16 v36, v106, s27, v36
    v_dot2_f32_bf16 v37, v106, v106, v37
    v_dot2_f32_bf16 v36, v107, s27, v36
    v_dot2_f32_bf16 v37, v107, v107, v37
    v_dot2_f32_bf16 v36, v108, s27, v36
    v_dot2_f32_bf16 v37, v108, v108, v37
    v_dot2_f32_bf16 v36, v109, s27, v36
    v_dot2_f32_bf16 v37, v109, v109, v37
    v_dot2_f32_bf16 v36, v110, s27, v36
    v_dot2_f32_bf16 v37, v110, v110, v37
    v_dot2_f32_bf16 v36, v111, s27, v36
    v_dot2_f32_bf16 v37, v111, v111, v37
    s_waitcnt vmcnt(4)
    v_dot2_f32_bf16 v36, v112, s27, v36
    v_dot2_f32_bf16 v37, v112, v112, v37
    v_dot2_f32_bf16 v36, v113, s27, v36
    v_dot2_f32_bf16 v37, v113, v113, v37
    v_dot2_f32_bf16 v36, v114, s27, v36
    v_dot2_f32_bf16 v37, v114, v114, v37
    v_dot2_f32_bf16 v36, v115, s27, v36
    v_dot2_f32_bf16 v37, v115, v115, v37
    v_dot2_f32_bf16 v36, v116, s27, v36
    v_dot2_f32_bf16 v37, v116, v116, v37
    v_dot2_f32_bf16 v36, v117, s27, v36
    v_dot2_f32_bf16 v37, v117, v117, v37
    v_dot2_f32_bf16 v36, v118, s27, v36
    v_dot2_f32_bf16 v37, v118, v118, v37
    v_dot2_f32_bf16 v36, v119, s27, v36
    v_dot2_f32_bf16 v37, v119, v119, v37
    v_dot2_f32_bf16 v36, v120, s27, v36
    v_dot2_f32_bf16 v37, v120, v120, v37
    v_dot2_f32_bf16 v36, v121, s27, v36
    v_dot2_f32_bf16 v37, v121, v121, v37
    v_dot2_f32_bf16 v36, v122, s27, v36
    v_dot2_f32_bf16 v37, v122, v122, v37
    v_dot2_f32_bf16 v36, v123, s27, v36
    v_dot2_f32_bf16 v37, v123, v123, v37
    v_dot2_f32_bf16 v36, v124, s27, v36
    v_dot2_f32_bf16 v37, v124, v124, v37
    v_dot2_f32_bf16 v36, v125, s27, v36
    v_dot2_f32_bf16 v37, v125, v125, v37
    v_dot2_f32_bf16 v36, v126, s27, v36
    v_dot2_f32_bf16 v37, v126, v126, v37
    v_dot2_f32_bf16 v36, v127, s27, v36
    v_dot2_f32_bf16 v37, v127, v127, v37
    s_waitcnt vmcnt(0)
    v_dot2_f32_bf16 v36, v128, s27, v36
    v_dot2_f32_bf16 v37, v128, v128, v37
    v_dot2_f32_bf16 v36, v129, s27, v36
    v_dot2_f32_bf16 v37, v129, v129, v37
    v_dot2_f32_bf16 v36, v130, s27, v36
    v_dot2_f32_bf16 v37, v130, v130, v37
    v_dot2_f32_bf16 v36, v131, s27, v36
    v_dot2_f32_bf16 v37, v131, v131, v37
    v_dot2_f32_bf16 v36, v132, s27, v36
    v_dot2_f32_bf16 v37, v132, v132, v37
    v_dot2_f32_bf16 v36, v133, s27, v36
    v_dot2_f32_bf16 v37, v133, v133, v37
    v_dot2_f32_bf16 v36, v134, s27, v36
    v_dot2_f32_bf16 v37, v134, v134, v37
    v_dot2_f32_bf16 v36, v135, s27, v36
    v_dot2_f32_bf16 v37, v135, v135, v37
    v_dot2_f32_bf16 v36, v136, s27, v36
    v_dot2_f32_bf16 v37, v136, v136, v37
    v_dot2_f32_bf16 v36, v137, s27, v36
    v_dot2_f32_bf16 v37, v137, v137, v37
    v_dot2_f32_bf16 v36, v138, s27, v36
    v_dot2_f32_bf16 v37, v138, v138, v37
    v_dot2_f32_bf16 v36, v139, s27, v36
    v_dot2_f32_bf16 v37, v139, v139, v37
    v_dot2_f32_bf16 v36, v140, s27, v36
    v_dot2_f32_bf16 v37, v140, v140, v37
    v_dot2_f32_bf16 v36, v141, s27, v36
    v_dot2_f32_bf16 v37, v141, v141, v37
    v_dot2_f32_bf16 v36, v142, s27, v36
    v_dot2_f32_bf16 v37, v142, v142, v37
    v_dot2_f32_bf16 v36, v143, s27, v36
    v_dot2_f32_bf16 v37, v143, v143, v37
    s_nop 1
    v_add_f32_dpp v36, v36, v36 quad_perm:[1,0,3,2] row_mask:0xf bank_mask:0xf
    v_add_f32_dpp v37, v37, v37 quad_perm:[1,0,3,2] row_mask:0xf bank_mask:0xf
    s_nop 0
    v_add_f32_dpp v36, v36, v36 quad_perm:[2,3,0,1] row_mask:0xf bank_mask:0xf
    v_add_f32_dpp v37, v37, v37 quad_perm:[2,3,0,1] row_mask:0xf bank_mask:0xf
    v_mul_f32 v36, 0x3acccccd, v36
    v_mul_f32 v37, 0x3acccccd, v37
    v_fma_f32 v37, -v36, v36, v37
    v_max_f32 v37, 0, v37
    v_add_f32 v37, 0x3727c5ac, v37
    v_rsq_f32 v37, v37
    v_lshlrev_b32 v32, 3, v32
    s_lshl_b32 s26, s26, 7
    s_add_u32 s26, s26, 21626880
    s_mov_b32 exec_lo, 0x11111111
    s_mov_b32 exec_hi, 0x11111111
    buffer_store_dwordx2 v[36:37], v32, s[16:19], s26 offen sc1
    s_mov_b64 exec, -1
    v_mov_b32 v34, 0
    v_lshrrev_b32 v33, 4, v1
    v_min_u32 v33, 2, v33
    v_lshlrev_b32 v35, 4, v33
    v_sub_u32 v35, v1, v35
    v_lshlrev_b32 v35, 7, v35
    v_lshl_add_u32 v35, v33, 15, v35
    v_lshrrev_b32 v33, 1, v33
    v_add_u32 v33, 11, v33
    v_mov_b32 v39, s21
    v_lshlrev_b32 v33, v33, v39
    v_add_u32 v35, v35, v33
    s_cmp_eq_u32 s20, 0
    s_mov_b32 s26, 2130706432
    s_cselect_b32 s26, 21757952, s26
    buffer_store_dword v34, v35, s[16:19], s26 offen sc1
    s_mov_b32 s48, s42
    s_and_b32 s49, s43, 0xffff
    s_mov_b32 s50, 819200
    s_mov_b32 s51, 0x00020000
    v_lshlrev_b32 v38, 4, v1
    s_mul_i32 s34, s21, 51200
    s_lshl_b32 s25, s20, 10
    s_add_u32 s34, s34, s25
    s_waitcnt vmcnt(0)
    s_barrier
    s_lshl_b32 s26, s21, 4
    s_cmp_eq_u32 s20, 0
    s_cselect_b32 s26, s26, 2130706432
    v_mov_b32 v32, 0
    v_mov_b32 v33, 1
    s_mov_b64 exec, 1
    buffer_store_dword v33, v32, s[44:47], s26 offen sc1
    s_mov_b64 exec, -1
    s_add_u32 m0, s25, 0
    s_nop 0
    buffer_load_dwordx4 v38, s[48:51], s34 offen lds
    s_add_u32 s34, s34, 8192
    s_add_u32 m0, s25, 8192
    s_nop 0
    buffer_load_dwordx4 v38, s[48:51], s34 offen lds
    s_add_u32 s34, s34, 8192
    s_add_u32 m0, s25, 16384
    s_nop 0
    buffer_load_dwordx4 v38, s[48:51], s34 offen lds
    s_add_u32 s34, s34, 8192
    s_add_u32 m0, s25, 24576
    s_nop 0
    buffer_load_dwordx4 v38, s[48:51], s34 offen lds
    s_add_u32 s34, s34, 8192
    s_add_u32 m0, s25, 32768
    s_nop 0
    buffer_load_dwordx4 v38, s[48:51], s34 offen lds
    s_add_u32 s34, s34, 8192
    s_add_u32 m0, s25, 40960
    s_nop 0
    buffer_load_dwordx4 v38, s[48:51], s34 offen lds
    s_add_u32 s34, s34, 8192
    s_add_u32 m0, s25, 49152
    s_nop 0
    buffer_load_dwordx4 v38, s[48:51], s34 offen lds
    s_add_u32 s34, s34, 8192
    v_bfe_u32 v32, v1, 2, 2
    v_mul_u32_u24 v32, 1280, v32
    v_lshrrev_b32 v33, 4, v1
    v_lshl_add_u32 v32, v33, 5, v32
    v_and_b32 v33, 3, v1
    v_lshl_add_u32 v32, v33, 3, v32
    s_lshr_b32 s26, s21, 2
    s_mul_i32 s26, s26, 20
    s_and_b32 s33, s21, 3
    s_add_u32 s38, s26, s33
    s_add_u32 s38, s38, 16
    s_mul_i32 s38, s38, 10240
    s_lshl_b32 s33, s33, 2
    s_add_u32 s39, s26, s33
    s_mul_i32 s39, s39, 10240
    v_and_b32 v34, 63, v0
    v_lshlrev_b32 v34, 4, v34
    s_mov_b32 exec_lo, 0xffff
    s_mov_b32 exec_hi, 0x0
    s_mov_b32 s61, 262144
Lg1:
    buffer_load_dword v35, v34, s[44:47], 0 offen sc1
    s_waitcnt vmcnt(0)
    v_cmp_gt_u32 vcc, 1, v35
    s_nop 4
    s_cbranch_vccz Lg1x
    s_sleep 2
    s_sub_u32 s61, s61, 1
    s_cmp_lg_u32 s61, 0
    s_cbranch_scc1 Lg1
Lg1x:
    s_mov_b64 exec, -1
    s_barrier
    s_add_u32 s26, s20, 0
    s_min_u32 s26, s26, 9
    s_lshl_b32 s33, s26, 7
    v_add_u32 v33, s33, v32
    ds_read_b64_tr_b16 v[64:65], v33 offset:0
    ds_read_b64_tr_b16 v[66:67], v33 offset:10240
    ds_read_b64_tr_b16 v[68:69], v33 offset:5120
    ds_read_b64_tr_b16 v[70:71], v33 offset:15360
    ds_read_b64_tr_b16 v[72:73], v33 offset:25600
    ds_read_b64_tr_b16 v[74:75], v33 offset:35840
    ds_read_b64_tr_b16 v[76:77], v33 offset:30720
    ds_read_b64_tr_b16 v[78:79], v33 offset:40960
    ds_read_b64_tr_b16 v[80:81], v33 offset:20480
    ds_read_b64_tr_b16 v[82:83], v33 offset:46080
    s_lshl_b32 s26, s26, 10
    s_add_u32 s26, s26, 20709376
    s_waitcnt lgkmcnt(0)
    s_add_u32 s33, s39, 0
    s_add_u32 s33, s33, s26
    buffer_store_dwordx4 v[64:67], v38, s[16:19], s33 offen sc1
    s_add_u32 s33, s39, 10240
    s_add_u32 s33, s33, s26
    buffer_store_dwordx4 v[68:71], v38, s[16:19], s33 offen sc1
    s_add_u32 s33, s39, 20480
    s_add_u32 s33, s33, s26
    buffer_store_dwordx4 v[72:75], v38, s[16:19], s33 offen sc1
    s_add_u32 s33, s39, 30720
    s_add_u32 s33, s33, s26
    buffer_store_dwordx4 v[76:79], v38, s[16:19], s33 offen sc1
    s_mov_b32 s33, s38
    s_add_u32 s33, s33, s26
    buffer_store_dwordx4 v[80:83], v38, s[16:19], s33 offen sc1
    s_cmp_ge_u32 s20, 2
    s_cbranch_scc1 parallel_sum__mha_block__mixer_token_mlp__prompt_kernel_rp
    s_add_u32 s26, s20, 8
    s_min_u32 s26, s26, 9
    s_lshl_b32 s33, s26, 7
    v_add_u32 v33, s33, v32
    ds_read_b64_tr_b16 v[84:85], v33 offset:0
    ds_read_b64_tr_b16 v[86:87], v33 offset:10240
    ds_read_b64_tr_b16 v[88:89], v33 offset:5120
    ds_read_b64_tr_b16 v[90:91], v33 offset:15360
    ds_read_b64_tr_b16 v[92:93], v33 offset:25600
    ds_read_b64_tr_b16 v[94:95], v33 offset:35840
    ds_read_b64_tr_b16 v[96:97], v33 offset:30720
    ds_read_b64_tr_b16 v[98:99], v33 offset:40960
    ds_read_b64_tr_b16 v[100:101], v33 offset:20480
    ds_read_b64_tr_b16 v[102:103], v33 offset:46080
    s_lshl_b32 s26, s26, 10
    s_add_u32 s26, s26, 20709376
    s_waitcnt lgkmcnt(0)
    s_add_u32 s33, s39, 0
    s_add_u32 s33, s33, s26
    buffer_store_dwordx4 v[84:87], v38, s[16:19], s33 offen sc1
    s_add_u32 s33, s39, 10240
    s_add_u32 s33, s33, s26
    buffer_store_dwordx4 v[88:91], v38, s[16:19], s33 offen sc1
    s_add_u32 s33, s39, 20480
    s_add_u32 s33, s33, s26
    buffer_store_dwordx4 v[92:95], v38, s[16:19], s33 offen sc1
    s_add_u32 s33, s39, 30720
    s_add_u32 s33, s33, s26
    buffer_store_dwordx4 v[96:99], v38, s[16:19], s33 offen sc1
    s_mov_b32 s33, s38
    s_add_u32 s33, s33, s26
    buffer_store_dwordx4 v[100:103], v38, s[16:19], s33 offen sc1
parallel_sum__mha_block__mixer_token_mlp__prompt_kernel_rp:
    s_lshl_b32 s23, s21, 4
    s_add_u32 s23, s23, s22
    s_lshl_b32 s23, s23, 7
    s_add_u32 s23, s23, 21757952
    s_mov_b64 exec, 1
    v_mov_b32 v32, 141780
    v_mov_b32 v33, 1
    s_waitcnt vmcnt(0)
    ds_add_rtn_u32 v32, v32, v33
    s_waitcnt lgkmcnt(0)
    v_readfirstlane_b32 s59, v32
    s_nop 0
    s_cmp_lg_u32 s59, 7
    s_cbranch_scc1 Lp2
    v_mov_b32 v32, 0
    buffer_store_dword v33, v32, s[16:19], s23 offen sc1
Lp2:
    s_mov_b64 exec, -1
    s_cmp_lt_u32 s20, 4
    s_cbranch_scc1 parallel_sum__mha_block__mixer_token_mlp__prompt_kernel_attA
    s_sub_u32 s20, s20, 4
    s_branch parallel_sum__mha_block__mixer_token_mlp__prompt_kernel_gemm
parallel_sum__mha_block__mixer_token_mlp__prompt_kernel_comp:
    v_bfe_u32 v32, v2, 1, 3
    v_xor_b32 v32, v32, v3
    v_lshlrev_b32 v32, 4, v32
    v_lshl_add_u32 v32, v2, 7, v32
    s_lshl_b32 s26, s28, 13
    v_add_u32 v32, s26, v32
    v_xor_b32 v4, 0, v32
    v_add_u32 v8, 0x10000, v4
    v_xor_b32 v5, 32, v32
    v_add_u32 v9, 0x10000, v5
    v_xor_b32 v6, 64, v32
    v_add_u32 v10, 0x10000, v6
    v_xor_b32 v7, 96, v32
    v_add_u32 v11, 0x10000, v7
    v_bfe_u32 v32, v1, 2, 2
    v_lshl_add_u32 v33, v3, 3, v32
    v_lshlrev_b32 v33, 8, v33
    s_lshl_b32 s26, s29, 1
    v_xor_b32 v32, s26, v32
    v_lshl_add_u32 v33, v32, 6, v33
    v_bfe_u32 v32, v1, 4, 1
    v_lshl_add_u32 v33, v32, 5, v33
    v_and_b32 v32, 3, v1
    v_lshl_add_u32 v33, v32, 3, v33
    v_add_u32 v20, 16384, v33
    v_xor_b32 v21, 64, v20
    v_add_u32 v22, 0x10000, v20
    v_add_u32 v23, 0x10000, v21
    s_load_dwordx2 s[40:41], s[0:1], 32
    s_load_dwordx2 s[42:43], s[0:1], 48
    s_waitcnt lgkmcnt(0)
    s_mov_b32 s16, s36
    s_and_b32 s17, s37, 0xffff
    s_mov_b32 s18, 24117248
    s_mov_b32 s19, 0x00020000
    v_lshlrev_b32 v32, 21, v0
    buffer_load_dword v39, v32, s[16:19], 0 offen sc1
    s_mov_b32 s48, s40
    s_and_b32 s49, s41, 0xffff
    s_mov_b32 s50, 7077888
    s_mov_b32 s51, 0x00020000
    buffer_load_dword v39, v32, s[48:51], 0 offen sc1
    s_mov_b32 s48, s42
    s_and_b32 s49, s43, 0xffff
    s_mov_b32 s50, 7077888
    s_mov_b32 s51, 0x00020000
    buffer_load_dword v39, v32, s[48:51], 0 offen sc1
    s_cmp_ge_u32 s22, 10
    s_cbranch_scc1 parallel_sum__mha_block__mixer_token_mlp__prompt_kernel_v
    s_cmp_ge_u32 s22, 5
    s_cselect_b32 s30, 1.0, 0x3ea52b5c
    s_movk_i32 s31, 1280
    s_cselect_b32 s31, 2560, s31
    s_cselect_b32 s32, 2621440, 0
    s_cselect_b32 s26, 5, 0
    s_sub_u32 s26, s22, s26
    s_lshl_b32 s26, s26, 5
    s_lshl_b32 s33, s29, 4
    s_add_u32 s26, s26, s33
    s_lshl_b32 s34, s31, 6
    s_sub_u32 s34, s34, 1280
    v_add_u32 v32, s26, v3
    v_lshlrev_b32 v34, 3, v2
    v_lshrrev_b32 v33, 1, v34
    v_xor_b32 v33, v33, v34
    s_cmp_ge_u32 s22, 5
    s_cselect_b32 s33, 32, 0
    v_and_b32 v33, s33, v33
    v_mul_u32_u24 v33, 3, v33
    v_xor_b32 v34, v34, v33
    v_mul_u32_u24 v33, 0xcccd, v32
    v_lshrrev_b32 v33, 18, v33
    v_mul_lo_u32 v33, v33, s34
    v_lshl_add_u32 v24, v32, 8, v34
    v_add_u32 v24, v24, v33
    v_add_u32 v32, 2, v32
    v_mul_u32_u24 v33, 0xcccd, v32
    v_lshrrev_b32 v33, 18, v33
    v_mul_lo_u32 v33, v33, s34
    v_lshl_add_u32 v25, v32, 8, v34
    v_add_u32 v25, v25, v33
    v_add_u32 v32, 2, v32
    v_mul_u32_u24 v33, 0xcccd, v32
    v_lshrrev_b32 v33, 18, v33
    v_mul_lo_u32 v33, v33, s34
    v_lshl_add_u32 v26, v32, 8, v34
    v_add_u32 v26, v26, v33
    v_add_u32 v32, 2, v32
    v_mul_u32_u24 v33, 0xcccd, v32
    v_lshrrev_b32 v33, 18, v33
    v_mul_lo_u32 v33, v33, s34
    v_lshl_add_u32 v27, v32, 8, v34
    v_add_u32 v27, v27, v33
    v_add_u32 v32, 2, v32
    v_mul_u32_u24 v33, 0xcccd, v32
    v_lshrrev_b32 v33, 18, v33
    v_mul_lo_u32 v33, v33, s34
    v_lshl_add_u32 v28, v32, 8, v34
    v_add_u32 v28, v28, v33
    v_add_u32 v32, 2, v32
    v_mul_u32_u24 v33, 0xcccd, v32
    v_lshrrev_b32 v33, 18, v33
    v_mul_lo_u32 v33, v33, s34
    v_lshl_add_u32 v29, v32, 8, v34
    v_add_u32 v29, v29, v33
    v_add_u32 v32, 2, v32
    v_mul_u32_u24 v33, 0xcccd, v32
    v_lshrrev_b32 v33, 18, v33
    v_mul_lo_u32 v33, v33, s34
    v_lshl_add_u32 v30, v32, 8, v34
    v_add_u32 v30, v30, v33
    v_add_u32 v32, 2, v32
    v_mul_u32_u24 v33, 0xcccd, v32
    v_lshrrev_b32 v33, 18, v33
    v_mul_lo_u32 v33, v33, s34
    v_lshl_add_u32 v31, v32, 8, v34
    v_add_u32 v31, v31, v33
    s_lshl_b32 s26, s28, 8
    s_add_u32 s26, s26, 141824
    v_lshl_add_u32 v12, v2, 2, s26
    s_lshl_b32 s26, s29, 8
    s_add_u32 s26, s26, 142848
    v_lshl_add_u32 v13, v3, 4, s26
    s_barrier
    ds_read_b128 v[104:107], v4 offset:0
    ds_read_b128 v[108:111], v4 offset:4096
    ds_read_b64_tr_b16 v[112:113], v20 offset:0
    ds_read_b64_tr_b16 v[114:115], v20 offset:1024
    ds_read_b64_tr_b16 v[116:117], v21 offset:0
    ds_read_b64_tr_b16 v[118:119], v21 offset:1024
    ds_read_b128 v[120:123], v5 offset:0
    ds_read_b128 v[124:127], v5 offset:4096
    ds_read_b64_tr_b16 v[128:129], v20 offset:4096
    ds_read_b64_tr_b16 v[130:131], v20 offset:5120
    ds_read_b64_tr_b16 v[132:133], v21 offset:4096
    ds_read_b64_tr_b16 v[134:135], v21 offset:5120
    s_waitcnt lgkmcnt(6)
    v_mfma_f32_32x32x16_bf16 v[40:55], v[112:115], v[104:107], 0
    ds_read_b128 v[136:139], v6 offset:0
    ds_read_b128 v[140:143], v6 offset:4096
    v_mfma_f32_32x32x16_bf16 v[56:71], v[116:119], v[104:107], 0
    ds_read_b64_tr_b16 v[144:145], v20 offset:8192
    ds_read_b64_tr_b16 v[146:147], v20 offset:9216
    v_mfma_f32_32x32x16_bf16 v[72:87], v[112:115], v[108:111], 0
    ds_read_b64_tr_b16 v[148:149], v21 offset:8192
    ds_read_b64_tr_b16 v[150:151], v21 offset:9216
    v_mfma_f32_32x32x16_bf16 v[88:103], v[116:119], v[108:111], 0
    s_waitcnt lgkmcnt(6)
    v_mfma_f32_32x32x16_bf16 v[40:55], v[128:131], v[120:123], v[40:55]
    ds_read_b128 v[104:107], v7 offset:0
    ds_read_b128 v[108:111], v7 offset:4096
    v_mfma_f32_32x32x16_bf16 v[56:71], v[132:135], v[120:123], v[56:71]
    ds_read_b64_tr_b16 v[112:113], v20 offset:12288
    ds_read_b64_tr_b16 v[114:115], v20 offset:13312
    v_mfma_f32_32x32x16_bf16 v[72:87], v[128:131], v[124:127], v[72:87]
    ds_read_b64_tr_b16 v[116:117], v21 offset:12288
    ds_read_b64_tr_b16 v[118:119], v21 offset:13312
    v_mfma_f32_32x32x16_bf16 v[88:103], v[132:135], v[124:127], v[88:103]
    s_waitcnt lgkmcnt(6)
    v_mfma_f32_32x32x16_bf16 v[40:55], v[144:147], v[136:139], v[40:55]
    s_barrier
    ds_read_b128 v[120:123], v4 offset:32768
    ds_read_b128 v[124:127], v4 offset:36864
    v_mfma_f32_32x32x16_bf16 v[56:71], v[148:151], v[136:139], v[56:71]
    ds_read_b64_tr_b16 v[128:129], v20 offset:32768
    ds_read_b64_tr_b16 v[130:131], v20 offset:33792
    v_mfma_f32_32x32x16_bf16 v[72:87], v[144:147], v[140:143], v[72:87]
    ds_read_b64_tr_b16 v[132:133], v21 offset:32768
    ds_read_b64_tr_b16 v[134:135], v21 offset:33792
    v_mfma_f32_32x32x16_bf16 v[88:103], v[148:151], v[140:143], v[88:103]
    s_waitcnt lgkmcnt(6)
    v_mfma_f32_32x32x16_bf16 v[40:55], v[112:115], v[104:107], v[40:55]
    ds_read_b128 v[136:139], v5 offset:32768
    ds_read_b128 v[140:143], v5 offset:36864
    v_mfma_f32_32x32x16_bf16 v[56:71], v[116:119], v[104:107], v[56:71]
    ds_read_b64_tr_b16 v[144:145], v20 offset:36864
    ds_read_b64_tr_b16 v[146:147], v20 offset:37888
    v_mfma_f32_32x32x16_bf16 v[72:87], v[112:115], v[108:111], v[72:87]
    ds_read_b64_tr_b16 v[148:149], v21 offset:36864
    ds_read_b64_tr_b16 v[150:151], v21 offset:37888
    v_mfma_f32_32x32x16_bf16 v[88:103], v[116:119], v[108:111], v[88:103]
    s_waitcnt lgkmcnt(6)
    v_mfma_f32_32x32x16_bf16 v[40:55], v[128:131], v[120:123], v[40:55]
    ds_read_b128 v[104:107], v6 offset:32768
    ds_read_b128 v[108:111], v6 offset:36864
    v_mfma_f32_32x32x16_bf16 v[56:71], v[132:135], v[120:123], v[56:71]
    ds_read_b64_tr_b16 v[112:113], v20 offset:40960
    ds_read_b64_tr_b16 v[114:115], v20 offset:41984
    v_mfma_f32_32x32x16_bf16 v[72:87], v[128:131], v[124:127], v[72:87]
    ds_read_b64_tr_b16 v[116:117], v21 offset:40960
    ds_read_b64_tr_b16 v[118:119], v21 offset:41984
    v_mfma_f32_32x32x16_bf16 v[88:103], v[132:135], v[124:127], v[88:103]
    s_waitcnt lgkmcnt(6)
    v_mfma_f32_32x32x16_bf16 v[40:55], v[144:147], v[136:139], v[40:55]
    ds_read_b128 v[120:123], v7 offset:32768
    ds_read_b128 v[124:127], v7 offset:36864
    v_mfma_f32_32x32x16_bf16 v[56:71], v[148:151], v[136:139], v[56:71]
    ds_read_b64_tr_b16 v[128:129], v20 offset:45056
    ds_read_b64_tr_b16 v[130:131], v20 offset:46080
    v_mfma_f32_32x32x16_bf16 v[72:87], v[144:147], v[140:143], v[72:87]
    ds_read_b64_tr_b16 v[132:133], v21 offset:45056
    ds_read_b64_tr_b16 v[134:135], v21 offset:46080
    v_mfma_f32_32x32x16_bf16 v[88:103], v[148:151], v[140:143], v[88:103]
    s_waitcnt lgkmcnt(6)
    v_mfma_f32_32x32x16_bf16 v[40:55], v[112:115], v[104:107], v[40:55]
    s_barrier
    ds_read_b128 v[136:139], v8 offset:0
    ds_read_b128 v[140:143], v8 offset:4096
    v_mfma_f32_32x32x16_bf16 v[56:71], v[116:119], v[104:107], v[56:71]
    ds_read_b64_tr_b16 v[144:145], v22 offset:0
    ds_read_b64_tr_b16 v[146:147], v22 offset:1024
    v_mfma_f32_32x32x16_bf16 v[72:87], v[112:115], v[108:111], v[72:87]
    ds_read_b64_tr_b16 v[148:149], v23 offset:0
    ds_read_b64_tr_b16 v[150:151], v23 offset:1024
    v_mfma_f32_32x32x16_bf16 v[88:103], v[116:119], v[108:111], v[88:103]
    s_waitcnt lgkmcnt(6)
    v_mfma_f32_32x32x16_bf16 v[40:55], v[128:131], v[120:123], v[40:55]
    ds_read_b128 v[104:107], v9 offset:0
    ds_read_b128 v[108:111], v9 offset:4096
    v_mfma_f32_32x32x16_bf16 v[56:71], v[132:135], v[120:123], v[56:71]
    ds_read_b64_tr_b16 v[112:113], v22 offset:4096
    ds_read_b64_tr_b16 v[114:115], v22 offset:5120
    v_mfma_f32_32x32x16_bf16 v[72:87], v[128:131], v[124:127], v[72:87]
    ds_read_b64_tr_b16 v[116:117], v23 offset:4096
    ds_read_b64_tr_b16 v[118:119], v23 offset:5120
    v_mfma_f32_32x32x16_bf16 v[88:103], v[132:135], v[124:127], v[88:103]
    s_waitcnt lgkmcnt(6)
    v_mfma_f32_32x32x16_bf16 v[40:55], v[144:147], v[136:139], v[40:55]
    ds_read_b128 v[120:123], v10 offset:0
    ds_read_b128 v[124:127], v10 offset:4096
    v_mfma_f32_32x32x16_bf16 v[56:71], v[148:151], v[136:139], v[56:71]
    ds_read_b64_tr_b16 v[128:129], v22 offset:8192
    ds_read_b64_tr_b16 v[130:131], v22 offset:9216
    v_mfma_f32_32x32x16_bf16 v[72:87], v[144:147], v[140:143], v[72:87]
    ds_read_b64_tr_b16 v[132:133], v23 offset:8192
    ds_read_b64_tr_b16 v[134:135], v23 offset:9216
    v_mfma_f32_32x32x16_bf16 v[88:103], v[148:151], v[140:143], v[88:103]
    s_waitcnt lgkmcnt(6)
    v_mfma_f32_32x32x16_bf16 v[40:55], v[112:115], v[104:107], v[40:55]
    ds_read_b128 v[136:139], v11 offset:0
    ds_read_b128 v[140:143], v11 offset:4096
    v_mfma_f32_32x32x16_bf16 v[56:71], v[116:119], v[104:107], v[56:71]
    ds_read_b64_tr_b16 v[144:145], v22 offset:12288
    ds_read_b64_tr_b16 v[146:147], v22 offset:13312
    v_mfma_f32_32x32x16_bf16 v[72:87], v[112:115], v[108:111], v[72:87]
    ds_read_b64_tr_b16 v[148:149], v23 offset:12288
    ds_read_b64_tr_b16 v[150:151], v23 offset:13312
    v_mfma_f32_32x32x16_bf16 v[88:103], v[116:119], v[108:111], v[88:103]
    s_waitcnt lgkmcnt(6)
    v_mfma_f32_32x32x16_bf16 v[40:55], v[128:131], v[120:123], v[40:55]
    s_barrier
    ds_read_b128 v[104:107], v8 offset:32768
    ds_read_b128 v[108:111], v8 offset:36864
    v_mfma_f32_32x32x16_bf16 v[56:71], v[132:135], v[120:123], v[56:71]
    ds_read_b64_tr_b16 v[112:113], v22 offset:32768
    ds_read_b64_tr_b16 v[114:115], v22 offset:33792
    v_mfma_f32_32x32x16_bf16 v[72:87], v[128:131], v[124:127], v[72:87]
    ds_read_b64_tr_b16 v[116:117], v23 offset:32768
    ds_read_b64_tr_b16 v[118:119], v23 offset:33792
    v_mfma_f32_32x32x16_bf16 v[88:103], v[132:135], v[124:127], v[88:103]
    s_waitcnt lgkmcnt(6)
    v_mfma_f32_32x32x16_bf16 v[40:55], v[144:147], v[136:139], v[40:55]
    ds_read_b128 v[120:123], v9 offset:32768
    ds_read_b128 v[124:127], v9 offset:36864
    v_mfma_f32_32x32x16_bf16 v[56:71], v[148:151], v[136:139], v[56:71]
    ds_read_b64_tr_b16 v[128:129], v22 offset:36864
    ds_read_b64_tr_b16 v[130:131], v22 offset:37888
    v_mfma_f32_32x32x16_bf16 v[72:87], v[144:147], v[140:143], v[72:87]
    ds_read_b64_tr_b16 v[132:133], v23 offset:36864
    ds_read_b64_tr_b16 v[134:135], v23 offset:37888
    v_mfma_f32_32x32x16_bf16 v[88:103], v[148:151], v[140:143], v[88:103]
    s_waitcnt lgkmcnt(6)
    v_mfma_f32_32x32x16_bf16 v[40:55], v[112:115], v[104:107], v[40:55]
    ds_read_b128 v[136:139], v10 offset:32768
    ds_read_b128 v[140:143], v10 offset:36864
    v_mfma_f32_32x32x16_bf16 v[56:71], v[116:119], v[104:107], v[56:71]
    ds_read_b64_tr_b16 v[144:145], v22 offset:40960
    ds_read_b64_tr_b16 v[146:147], v22 offset:41984
    v_mfma_f32_32x32x16_bf16 v[72:87], v[112:115], v[108:111], v[72:87]
    ds_read_b64_tr_b16 v[148:149], v23 offset:40960
    ds_read_b64_tr_b16 v[150:151], v23 offset:41984
    v_mfma_f32_32x32x16_bf16 v[88:103], v[116:119], v[108:111], v[88:103]
    s_waitcnt lgkmcnt(6)
    v_mfma_f32_32x32x16_bf16 v[40:55], v[128:131], v[120:123], v[40:55]
    ds_read_b128 v[104:107], v11 offset:32768
    ds_read_b128 v[108:111], v11 offset:36864
    v_mfma_f32_32x32x16_bf16 v[56:71], v[132:135], v[120:123], v[56:71]
    ds_read_b64_tr_b16 v[112:113], v22 offset:45056
    ds_read_b64_tr_b16 v[114:115], v22 offset:46080
    v_mfma_f32_32x32x16_bf16 v[72:87], v[128:131], v[124:127], v[72:87]
    ds_read_b64_tr_b16 v[116:117], v23 offset:45056
    ds_read_b64_tr_b16 v[118:119], v23 offset:46080
    v_mfma_f32_32x32x16_bf16 v[88:103], v[132:135], v[124:127], v[88:103]
    s_waitcnt lgkmcnt(6)
    v_mfma_f32_32x32x16_bf16 v[40:55], v[144:147], v[136:139], v[40:55]
    s_barrier
    ds_read_b128 v[120:123], v4 offset:0
    ds_read_b128 v[124:127], v4 offset:4096
    v_mfma_f32_32x32x16_bf16 v[56:71], v[148:151], v[136:139], v[56:71]
    ds_read_b64_tr_b16 v[128:129], v20 offset:0
    ds_read_b64_tr_b16 v[130:131], v20 offset:1024
    v_mfma_f32_32x32x16_bf16 v[72:87], v[144:147], v[140:143], v[72:87]
    ds_read_b64_tr_b16 v[132:133], v21 offset:0
    ds_read_b64_tr_b16 v[134:135], v21 offset:1024
    v_mfma_f32_32x32x16_bf16 v[88:103], v[148:151], v[140:143], v[88:103]
    s_waitcnt lgkmcnt(6)
    v_mfma_f32_32x32x16_bf16 v[40:55], v[112:115], v[104:107], v[40:55]
    ds_read_b128 v[136:139], v5 offset:0
    ds_read_b128 v[140:143], v5 offset:4096
    v_mfma_f32_32x32x16_bf16 v[56:71], v[116:119], v[104:107], v[56:71]
    ds_read_b64_tr_b16 v[144:145], v20 offset:4096
    ds_read_b64_tr_b16 v[146:147], v20 offset:5120
    v_mfma_f32_32x32x16_bf16 v[72:87], v[112:115], v[108:111], v[72:87]
    ds_read_b64_tr_b16 v[148:149], v21 offset:4096
    ds_read_b64_tr_b16 v[150:151], v21 offset:5120
    v_mfma_f32_32x32x16_bf16 v[88:103], v[116:119], v[108:111], v[88:103]
    s_waitcnt lgkmcnt(6)
    v_mfma_f32_32x32x16_bf16 v[40:55], v[128:131], v[120:123], v[40:55]
    ds_read_b128 v[104:107], v6 offset:0
    ds_read_b128 v[108:111], v6 offset:4096
    v_mfma_f32_32x32x16_bf16 v[56:71], v[132:135], v[120:123], v[56:71]
    ds_read_b64_tr_b16 v[112:113], v20 offset:8192
    ds_read_b64_tr_b16 v[114:115], v20 offset:9216
    v_mfma_f32_32x32x16_bf16 v[72:87], v[128:131], v[124:127], v[72:87]
    ds_read_b64_tr_b16 v[116:117], v21 offset:8192
    ds_read_b64_tr_b16 v[118:119], v21 offset:9216
    v_mfma_f32_32x32x16_bf16 v[88:103], v[132:135], v[124:127], v[88:103]
    s_waitcnt lgkmcnt(6)
    v_mfma_f32_32x32x16_bf16 v[40:55], v[144:147], v[136:139], v[40:55]
    ds_read_b128 v[120:123], v7 offset:0
    ds_read_b128 v[124:127], v7 offset:4096
    v_mfma_f32_32x32x16_bf16 v[56:71], v[148:151], v[136:139], v[56:71]
    ds_read_b64_tr_b16 v[128:129], v20 offset:12288
    ds_read_b64_tr_b16 v[130:131], v20 offset:13312
    v_mfma_f32_32x32x16_bf16 v[72:87], v[144:147], v[140:143], v[72:87]
    ds_read_b64_tr_b16 v[132:133], v21 offset:12288
    ds_read_b64_tr_b16 v[134:135], v21 offset:13312
    v_mfma_f32_32x32x16_bf16 v[88:103], v[148:151], v[140:143], v[88:103]
    s_waitcnt lgkmcnt(6)
    v_mfma_f32_32x32x16_bf16 v[40:55], v[112:115], v[104:107], v[40:55]
    s_barrier
    ds_read_b128 v[136:139], v4 offset:32768
    ds_read_b128 v[140:143], v4 offset:36864
    v_mfma_f32_32x32x16_bf16 v[56:71], v[116:119], v[104:107], v[56:71]
    ds_read_b64_tr_b16 v[144:145], v20 offset:32768
    ds_read_b64_tr_b16 v[146:147], v20 offset:33792
    v_mfma_f32_32x32x16_bf16 v[72:87], v[112:115], v[108:111], v[72:87]
    ds_read_b64_tr_b16 v[148:149], v21 offset:32768
    ds_read_b64_tr_b16 v[150:151], v21 offset:33792
    v_mfma_f32_32x32x16_bf16 v[88:103], v[116:119], v[108:111], v[88:103]
    s_waitcnt lgkmcnt(6)
    v_mfma_f32_32x32x16_bf16 v[40:55], v[128:131], v[120:123], v[40:55]
    ds_read_b128 v[104:107], v5 offset:32768
    ds_read_b128 v[108:111], v5 offset:36864
    v_mfma_f32_32x32x16_bf16 v[56:71], v[132:135], v[120:123], v[56:71]
    ds_read_b64_tr_b16 v[112:113], v20 offset:36864
    ds_read_b64_tr_b16 v[114:115], v20 offset:37888
    v_mfma_f32_32x32x16_bf16 v[72:87], v[128:131], v[124:127], v[72:87]
    ds_read_b64_tr_b16 v[116:117], v21 offset:36864
    ds_read_b64_tr_b16 v[118:119], v21 offset:37888
    v_mfma_f32_32x32x16_bf16 v[88:103], v[132:135], v[124:127], v[88:103]
    s_waitcnt lgkmcnt(6)
    v_mfma_f32_32x32x16_bf16 v[40:55], v[144:147], v[136:139], v[40:55]
    ds_read_b128 v[120:123], v6 offset:32768
    ds_read_b128 v[124:127], v6 offset:36864
    v_mfma_f32_32x32x16_bf16 v[56:71], v[148:151], v[136:139], v[56:71]
    ds_read_b64_tr_b16 v[128:129], v20 offset:40960
    ds_read_b64_tr_b16 v[130:131], v20 offset:41984
    v_mfma_f32_32x32x16_bf16 v[72:87], v[144:147], v[140:143], v[72:87]
    ds_read_b64_tr_b16 v[132:133], v21 offset:40960
    ds_read_b64_tr_b16 v[134:135], v21 offset:41984
    v_mfma_f32_32x32x16_bf16 v[88:103], v[148:151], v[140:143], v[88:103]
    s_waitcnt lgkmcnt(6)
    v_mfma_f32_32x32x16_bf16 v[40:55], v[112:115], v[104:107], v[40:55]
    ds_read_b128 v[136:139], v7 offset:32768
    ds_read_b128 v[140:143], v7 offset:36864
    v_mfma_f32_32x32x16_bf16 v[56:71], v[116:119], v[104:107], v[56:71]
    ds_read_b64_tr_b16 v[144:145], v20 offset:45056
    ds_read_b64_tr_b16 v[146:147], v20 offset:46080
    v_mfma_f32_32x32x16_bf16 v[72:87], v[112:115], v[108:111], v[72:87]
    ds_read_b64_tr_b16 v[148:149], v21 offset:45056
    ds_read_b64_tr_b16 v[150:151], v21 offset:46080
    v_mfma_f32_32x32x16_bf16 v[88:103], v[116:119], v[108:111], v[88:103]
    s_waitcnt lgkmcnt(6)
    v_mfma_f32_32x32x16_bf16 v[40:55], v[128:131], v[120:123], v[40:55]
    s_barrier
    ds_read_b128 v[104:107], v8 offset:0
    ds_read_b128 v[108:111], v8 offset:4096
    v_mfma_f32_32x32x16_bf16 v[56:71], v[132:135], v[120:123], v[56:71]
    ds_read_b64_tr_b16 v[112:113], v22 offset:0
    ds_read_b64_tr_b16 v[114:115], v22 offset:1024
    v_mfma_f32_32x32x16_bf16 v[72:87], v[128:131], v[124:127], v[72:87]
    ds_read_b64_tr_b16 v[116:117], v23 offset:0
    ds_read_b64_tr_b16 v[118:119], v23 offset:1024
    v_mfma_f32_32x32x16_bf16 v[88:103], v[132:135], v[124:127], v[88:103]
    s_waitcnt lgkmcnt(6)
    v_mfma_f32_32x32x16_bf16 v[40:55], v[144:147], v[136:139], v[40:55]
    ds_read_b128 v[120:123], v9 offset:0
    ds_read_b128 v[124:127], v9 offset:4096
    v_mfma_f32_32x32x16_bf16 v[56:71], v[148:151], v[136:139], v[56:71]
    ds_read_b64_tr_b16 v[128:129], v22 offset:4096
    ds_read_b64_tr_b16 v[130:131], v22 offset:5120
    v_mfma_f32_32x32x16_bf16 v[72:87], v[144:147], v[140:143], v[72:87]
    ds_read_b64_tr_b16 v[132:133], v23 offset:4096
    ds_read_b64_tr_b16 v[134:135], v23 offset:5120
    v_mfma_f32_32x32x16_bf16 v[88:103], v[148:151], v[140:143], v[88:103]
    s_waitcnt lgkmcnt(6)
    v_mfma_f32_32x32x16_bf16 v[40:55], v[112:115], v[104:107], v[40:55]
    ds_read_b128 v[136:139], v10 offset:0
    ds_read_b128 v[140:143], v10 offset:4096
    v_mfma_f32_32x32x16_bf16 v[56:71], v[116:119], v[104:107], v[56:71]
    ds_read_b64_tr_b16 v[144:145], v22 offset:8192
    ds_read_b64_tr_b16 v[146:147], v22 offset:9216
    v_mfma_f32_32x32x16_bf16 v[72:87], v[112:115], v[108:111], v[72:87]
    ds_read_b64_tr_b16 v[148:149], v23 offset:8192
    ds_read_b64_tr_b16 v[150:151], v23 offset:9216
    v_mfma_f32_32x32x16_bf16 v[88:103], v[116:119], v[108:111], v[88:103]
    s_waitcnt lgkmcnt(6)
    v_mfma_f32_32x32x16_bf16 v[40:55], v[128:131], v[120:123], v[40:55]
    ds_read_b128 v[104:107], v11 offset:0
    ds_read_b128 v[108:111], v11 offset:4096
    v_mfma_f32_32x32x16_bf16 v[56:71], v[132:135], v[120:123], v[56:71]
    ds_read_b64_tr_b16 v[112:113], v22 offset:12288
    ds_read_b64_tr_b16 v[114:115], v22 offset:13312
    v_mfma_f32_32x32x16_bf16 v[72:87], v[128:131], v[124:127], v[72:87]
    ds_read_b64_tr_b16 v[116:117], v23 offset:12288
    ds_read_b64_tr_b16 v[118:119], v23 offset:13312
    v_mfma_f32_32x32x16_bf16 v[88:103], v[132:135], v[124:127], v[88:103]
    s_waitcnt lgkmcnt(6)
    v_mfma_f32_32x32x16_bf16 v[40:55], v[144:147], v[136:139], v[40:55]
    s_barrier
    ds_read_b128 v[120:123], v8 offset:32768
    ds_read_b128 v[124:127], v8 offset:36864
    v_mfma_f32_32x32x16_bf16 v[56:71], v[148:151], v[136:139], v[56:71]
    ds_read_b64_tr_b16 v[128:129], v22 offset:32768
    ds_read_b64_tr_b16 v[130:131], v22 offset:33792
    v_mfma_f32_32x32x16_bf16 v[72:87], v[144:147], v[140:143], v[72:87]
    ds_read_b64_tr_b16 v[132:133], v23 offset:32768
    ds_read_b64_tr_b16 v[134:135], v23 offset:33792
    v_mfma_f32_32x32x16_bf16 v[88:103], v[148:151], v[140:143], v[88:103]
    s_waitcnt lgkmcnt(6)
    v_mfma_f32_32x32x16_bf16 v[40:55], v[112:115], v[104:107], v[40:55]
    ds_read_b128 v[136:139], v9 offset:32768
    ds_read_b128 v[140:143], v9 offset:36864
    v_mfma_f32_32x32x16_bf16 v[56:71], v[116:119], v[104:107], v[56:71]
    ds_read_b64_tr_b16 v[144:145], v22 offset:36864
    ds_read_b64_tr_b16 v[146:147], v22 offset:37888
    v_mfma_f32_32x32x16_bf16 v[72:87], v[112:115], v[108:111], v[72:87]
    ds_read_b64_tr_b16 v[148:149], v23 offset:36864
    ds_read_b64_tr_b16 v[150:151], v23 offset:37888
    v_mfma_f32_32x32x16_bf16 v[88:103], v[116:119], v[108:111], v[88:103]
    s_waitcnt lgkmcnt(6)
    v_mfma_f32_32x32x16_bf16 v[40:55], v[128:131], v[120:123], v[40:55]
    ds_read_b128 v[104:107], v10 offset:32768
    ds_read_b128 v[108:111], v10 offset:36864
    v_mfma_f32_32x32x16_bf16 v[56:71], v[132:135], v[120:123], v[56:71]
    ds_read_b64_tr_b16 v[112:113], v22 offset:40960
    ds_read_b64_tr_b16 v[114:115], v22 offset:41984
    v_mfma_f32_32x32x16_bf16 v[72:87], v[128:131], v[124:127], v[72:87]
    ds_read_b64_tr_b16 v[116:117], v23 offset:40960
    ds_read_b64_tr_b16 v[118:119], v23 offset:41984
    v_mfma_f32_32x32x16_bf16 v[88:103], v[132:135], v[124:127], v[88:103]
    s_waitcnt lgkmcnt(6)
    v_mfma_f32_32x32x16_bf16 v[40:55], v[144:147], v[136:139], v[40:55]
    ds_read_b128 v[120:123], v11 offset:32768
    ds_read_b128 v[124:127], v11 offset:36864
    v_mfma_f32_32x32x16_bf16 v[56:71], v[148:151], v[136:139], v[56:71]
    ds_read_b64_tr_b16 v[128:129], v22 offset:45056
    ds_read_b64_tr_b16 v[130:131], v22 offset:46080
    v_mfma_f32_32x32x16_bf16 v[72:87], v[144:147], v[140:143], v[72:87]
    ds_read_b64_tr_b16 v[132:133], v23 offset:45056
    ds_read_b64_tr_b16 v[134:135], v23 offset:46080
    v_mfma_f32_32x32x16_bf16 v[88:103], v[148:151], v[140:143], v[88:103]
    s_waitcnt lgkmcnt(6)
    v_mfma_f32_32x32x16_bf16 v[40:55], v[112:115], v[104:107], v[40:55]
    s_barrier
    ds_read_b128 v[136:139], v4 offset:0
    ds_read_b128 v[140:143], v4 offset:4096
    v_mfma_f32_32x32x16_bf16 v[56:71], v[116:119], v[104:107], v[56:71]
    ds_read_b64_tr_b16 v[144:145], v20 offset:0
    ds_read_b64_tr_b16 v[146:147], v20 offset:1024
    v_mfma_f32_32x32x16_bf16 v[72:87], v[112:115], v[108:111], v[72:87]
    ds_read_b64_tr_b16 v[148:149], v21 offset:0
    ds_read_b64_tr_b16 v[150:151], v21 offset:1024
    v_mfma_f32_32x32x16_bf16 v[88:103], v[116:119], v[108:111], v[88:103]
    s_waitcnt lgkmcnt(6)
    v_mfma_f32_32x32x16_bf16 v[40:55], v[128:131], v[120:123], v[40:55]
    ds_read_b128 v[104:107], v5 offset:0
    ds_read_b128 v[108:111], v5 offset:4096
    v_mfma_f32_32x32x16_bf16 v[56:71], v[132:135], v[120:123], v[56:71]
    ds_read_b64_tr_b16 v[112:113], v20 offset:4096
    ds_read_b64_tr_b16 v[114:115], v20 offset:5120
    v_mfma_f32_32x32x16_bf16 v[72:87], v[128:131], v[124:127], v[72:87]
    ds_read_b64_tr_b16 v[116:117], v21 offset:4096
    ds_read_b64_tr_b16 v[118:119], v21 offset:5120
    v_mfma_f32_32x32x16_bf16 v[88:103], v[132:135], v[124:127], v[88:103]
    s_waitcnt lgkmcnt(6)
    v_mfma_f32_32x32x16_bf16 v[40:55], v[144:147], v[136:139], v[40:55]
    ds_read_b128 v[120:123], v6 offset:0
    ds_read_b128 v[124:127], v6 offset:4096
    v_mfma_f32_32x32x16_bf16 v[56:71], v[148:151], v[136:139], v[56:71]
    ds_read_b64_tr_b16 v[128:129], v20 offset:8192
    ds_read_b64_tr_b16 v[130:131], v20 offset:9216
    v_mfma_f32_32x32x16_bf16 v[72:87], v[144:147], v[140:143], v[72:87]
    ds_read_b64_tr_b16 v[132:133], v21 offset:8192
    ds_read_b64_tr_b16 v[134:135], v21 offset:9216
    v_mfma_f32_32x32x16_bf16 v[88:103], v[148:151], v[140:143], v[88:103]
    s_waitcnt lgkmcnt(6)
    v_mfma_f32_32x32x16_bf16 v[40:55], v[112:115], v[104:107], v[40:55]
    ds_read_b128 v[136:139], v7 offset:0
    ds_read_b128 v[140:143], v7 offset:4096
    v_mfma_f32_32x32x16_bf16 v[56:71], v[116:119], v[104:107], v[56:71]
    ds_read_b64_tr_b16 v[144:145], v20 offset:12288
    ds_read_b64_tr_b16 v[146:147], v20 offset:13312
    v_mfma_f32_32x32x16_bf16 v[72:87], v[112:115], v[108:111], v[72:87]
    ds_read_b64_tr_b16 v[148:149], v21 offset:12288
    ds_read_b64_tr_b16 v[150:151], v21 offset:13312
    v_mfma_f32_32x32x16_bf16 v[88:103], v[116:119], v[108:111], v[88:103]
    s_waitcnt lgkmcnt(6)
    v_mfma_f32_32x32x16_bf16 v[40:55], v[128:131], v[120:123], v[40:55]
    s_barrier
    ds_read_b128 v[104:107], v4 offset:32768
    ds_read_b128 v[108:111], v4 offset:36864
    v_mfma_f32_32x32x16_bf16 v[56:71], v[132:135], v[120:123], v[56:71]
    ds_read_b64_tr_b16 v[112:113], v20 offset:32768
    ds_read_b64_tr_b16 v[114:115], v20 offset:33792
    v_mfma_f32_32x32x16_bf16 v[72:87], v[128:131], v[124:127], v[72:87]
    ds_read_b64_tr_b16 v[116:117], v21 offset:32768
    ds_read_b64_tr_b16 v[118:119], v21 offset:33792
    v_mfma_f32_32x32x16_bf16 v[88:103], v[132:135], v[124:127], v[88:103]
    s_waitcnt lgkmcnt(6)
    v_mfma_f32_32x32x16_bf16 v[40:55], v[144:147], v[136:139], v[40:55]
    ds_read_b128 v[120:123], v5 offset:32768
    ds_read_b128 v[124:127], v5 offset:36864
    v_mfma_f32_32x32x16_bf16 v[56:71], v[148:151], v[136:139], v[56:71]
    ds_read_b64_tr_b16 v[128:129], v20 offset:36864
    ds_read_b64_tr_b16 v[130:131], v20 offset:37888
    v_mfma_f32_32x32x16_bf16 v[72:87], v[144:147], v[140:143], v[72:87]
    ds_read_b64_tr_b16 v[132:133], v21 offset:36864
    ds_read_b64_tr_b16 v[134:135], v21 offset:37888
    v_mfma_f32_32x32x16_bf16 v[88:103], v[148:151], v[140:143], v[88:103]
    s_waitcnt lgkmcnt(6)
    v_mfma_f32_32x32x16_bf16 v[40:55], v[112:115], v[104:107], v[40:55]
    ds_read_b128 v[136:139], v6 offset:32768
    ds_read_b128 v[140:143], v6 offset:36864
    v_mfma_f32_32x32x16_bf16 v[56:71], v[116:119], v[104:107], v[56:71]
    ds_read_b64_tr_b16 v[144:145], v20 offset:40960
    ds_read_b64_tr_b16 v[146:147], v20 offset:41984
    v_mfma_f32_32x32x16_bf16 v[72:87], v[112:115], v[108:111], v[72:87]
    ds_read_b64_tr_b16 v[148:149], v21 offset:40960
    ds_read_b64_tr_b16 v[150:151], v21 offset:41984
    v_mfma_f32_32x32x16_bf16 v[88:103], v[116:119], v[108:111], v[88:103]
    s_waitcnt lgkmcnt(6)
    v_mfma_f32_32x32x16_bf16 v[40:55], v[128:131], v[120:123], v[40:55]
    ds_read_b128 v[104:107], v7 offset:32768
    ds_read_b128 v[108:111], v7 offset:36864
    v_mfma_f32_32x32x16_bf16 v[56:71], v[132:135], v[120:123], v[56:71]
    ds_read_b64_tr_b16 v[112:113], v20 offset:45056
    ds_read_b64_tr_b16 v[114:115], v20 offset:46080
    v_mfma_f32_32x32x16_bf16 v[72:87], v[128:131], v[124:127], v[72:87]
    ds_read_b64_tr_b16 v[116:117], v21 offset:45056
    ds_read_b64_tr_b16 v[118:119], v21 offset:46080
    v_mfma_f32_32x32x16_bf16 v[88:103], v[132:135], v[124:127], v[88:103]
    s_waitcnt lgkmcnt(6)
    v_mfma_f32_32x32x16_bf16 v[40:55], v[144:147], v[136:139], v[40:55]
    s_barrier
    v_mfma_f32_32x32x16_bf16 v[56:71], v[148:151], v[136:139], v[56:71]
    v_mfma_f32_32x32x16_bf16 v[72:87], v[144:147], v[140:143], v[72:87]
    v_mfma_f32_32x32x16_bf16 v[88:103], v[148:151], v[140:143], v[88:103]
    s_waitcnt lgkmcnt(0)
    v_mfma_f32_32x32x16_bf16 v[40:55], v[112:115], v[104:107], v[40:55]
    v_mfma_f32_32x32x16_bf16 v[56:71], v[116:119], v[104:107], v[56:71]
    v_mfma_f32_32x32x16_bf16 v[72:87], v[112:115], v[108:111], v[72:87]
    v_mfma_f32_32x32x16_bf16 v[88:103], v[116:119], v[108:111], v[88:103]
    s_barrier
    ds_read_b32 v36, v12
    ds_read_b32 v37, v12 offset:512
    ds_read_b32 v38, v12 offset:128
    ds_read_b32 v39, v12 offset:640
    ds_read_b128 v[104:107], v13 offset:0
    ds_read_b128 v[108:111], v13 offset:32
    ds_read_b128 v[112:115], v13 offset:64
    ds_read_b128 v[116:119], v13 offset:96
    ds_read_b128 v[120:123], v13 offset:128
    ds_read_b128 v[124:127], v13 offset:160
    ds_read_b128 v[128:131], v13 offset:192
    ds_read_b128 v[132:135], v13 offset:224
    s_waitcnt lgkmcnt(4)
    v_mul_f32 v37, s30, v37
    v_mul_f32 v39, s30, v39
    s_lshl_b32 s26, s21, 2
    s_lshl_b32 s33, s28, 1
    s_add_u32 s26, s26, s33
    s_mul_i32 s26, s26, s31
    s_add_u32 s26, s26, s32
    v_pk_fma_f32 v[40:41], v[36:37], v[104:105], v[40:41] op_sel_hi:[0,1,1] neg_lo:[1,0,0] neg_hi:[1,0,0]
    v_pk_fma_f32 v[42:43], v[36:37], v[106:107], v[42:43] op_sel_hi:[0,1,1] neg_lo:[1,0,0] neg_hi:[1,0,0]
    v_pk_fma_f32 v[44:45], v[36:37], v[108:109], v[44:45] op_sel_hi:[0,1,1] neg_lo:[1,0,0] neg_hi:[1,0,0]
    v_pk_fma_f32 v[46:47], v[36:37], v[110:111], v[46:47] op_sel_hi:[0,1,1] neg_lo:[1,0,0] neg_hi:[1,0,0]
    v_pk_fma_f32 v[48:49], v[36:37], v[112:113], v[48:49] op_sel_hi:[0,1,1] neg_lo:[1,0,0] neg_hi:[1,0,0]
    v_pk_fma_f32 v[50:51], v[36:37], v[114:115], v[50:51] op_sel_hi:[0,1,1] neg_lo:[1,0,0] neg_hi:[1,0,0]
    v_pk_fma_f32 v[52:53], v[36:37], v[116:117], v[52:53] op_sel_hi:[0,1,1] neg_lo:[1,0,0] neg_hi:[1,0,0]
    v_pk_fma_f32 v[54:55], v[36:37], v[118:119], v[54:55] op_sel_hi:[0,1,1] neg_lo:[1,0,0] neg_hi:[1,0,0]
    v_pk_mul_f32 v[40:41], v[40:41], v[36:37] op_sel:[0,1] op_sel_hi:[1,1]
    v_pk_mul_f32 v[42:43], v[42:43], v[36:37] op_sel:[0,1] op_sel_hi:[1,1]
    v_pk_mul_f32 v[44:45], v[44:45], v[36:37] op_sel:[0,1] op_sel_hi:[1,1]
    v_pk_mul_f32 v[46:47], v[46:47], v[36:37] op_sel:[0,1] op_sel_hi:[1,1]
    v_pk_mul_f32 v[48:49], v[48:49], v[36:37] op_sel:[0,1] op_sel_hi:[1,1]
    v_pk_mul_f32 v[50:51], v[50:51], v[36:37] op_sel:[0,1] op_sel_hi:[1,1]
    v_pk_mul_f32 v[52:53], v[52:53], v[36:37] op_sel:[0,1] op_sel_hi:[1,1]
    v_pk_mul_f32 v[54:55], v[54:55], v[36:37] op_sel:[0,1] op_sel_hi:[1,1]
    v_cvt_pk_bf16_f32 v40, v40, v41
    v_cvt_pk_bf16_f32 v41, v42, v43
    buffer_store_dwordx2 v[40:41], v24, s[16:19], s26 offen sc1
    v_cvt_pk_bf16_f32 v44, v44, v45
    v_cvt_pk_bf16_f32 v45, v46, v47
    buffer_store_dwordx2 v[44:45], v25, s[16:19], s26 offen sc1
    v_cvt_pk_bf16_f32 v48, v48, v49
    v_cvt_pk_bf16_f32 v49, v50, v51
    buffer_store_dwordx2 v[48:49], v26, s[16:19], s26 offen sc1
    v_cvt_pk_bf16_f32 v52, v52, v53
    v_cvt_pk_bf16_f32 v53, v54, v55
    buffer_store_dwordx2 v[52:53], v27, s[16:19], s26 offen sc1
    s_lshl_b32 s26, s21, 2
    s_lshl_b32 s33, s28, 1
    s_add_u32 s26, s26, s33
    s_add_u32 s26, s26, 1
    s_mul_i32 s26, s26, s31
    s_add_u32 s26, s26, s32
    v_pk_fma_f32 v[72:73], v[38:39], v[104:105], v[72:73] op_sel_hi:[0,1,1] neg_lo:[1,0,0] neg_hi:[1,0,0]
    v_pk_fma_f32 v[74:75], v[38:39], v[106:107], v[74:75] op_sel_hi:[0,1,1] neg_lo:[1,0,0] neg_hi:[1,0,0]
    v_pk_fma_f32 v[76:77], v[38:39], v[108:109], v[76:77] op_sel_hi:[0,1,1] neg_lo:[1,0,0] neg_hi:[1,0,0]
    v_pk_fma_f32 v[78:79], v[38:39], v[110:111], v[78:79] op_sel_hi:[0,1,1] neg_lo:[1,0,0] neg_hi:[1,0,0]
    v_pk_fma_f32 v[80:81], v[38:39], v[112:113], v[80:81] op_sel_hi:[0,1,1] neg_lo:[1,0,0] neg_hi:[1,0,0]
    v_pk_fma_f32 v[82:83], v[38:39], v[114:115], v[82:83] op_sel_hi:[0,1,1] neg_lo:[1,0,0] neg_hi:[1,0,0]
    v_pk_fma_f32 v[84:85], v[38:39], v[116:117], v[84:85] op_sel_hi:[0,1,1] neg_lo:[1,0,0] neg_hi:[1,0,0]
    v_pk_fma_f32 v[86:87], v[38:39], v[118:119], v[86:87] op_sel_hi:[0,1,1] neg_lo:[1,0,0] neg_hi:[1,0,0]
    v_pk_mul_f32 v[72:73], v[72:73], v[38:39] op_sel:[0,1] op_sel_hi:[1,1]
    v_pk_mul_f32 v[74:75], v[74:75], v[38:39] op_sel:[0,1] op_sel_hi:[1,1]
    v_pk_mul_f32 v[76:77], v[76:77], v[38:39] op_sel:[0,1] op_sel_hi:[1,1]
    v_pk_mul_f32 v[78:79], v[78:79], v[38:39] op_sel:[0,1] op_sel_hi:[1,1]
    v_pk_mul_f32 v[80:81], v[80:81], v[38:39] op_sel:[0,1] op_sel_hi:[1,1]
    v_pk_mul_f32 v[82:83], v[82:83], v[38:39] op_sel:[0,1] op_sel_hi:[1,1]
    v_pk_mul_f32 v[84:85], v[84:85], v[38:39] op_sel:[0,1] op_sel_hi:[1,1]
    v_pk_mul_f32 v[86:87], v[86:87], v[38:39] op_sel:[0,1] op_sel_hi:[1,1]
    v_cvt_pk_bf16_f32 v72, v72, v73
    v_cvt_pk_bf16_f32 v73, v74, v75
    buffer_store_dwordx2 v[72:73], v24, s[16:19], s26 offen sc1
    v_cvt_pk_bf16_f32 v76, v76, v77
    v_cvt_pk_bf16_f32 v77, v78, v79
    buffer_store_dwordx2 v[76:77], v25, s[16:19], s26 offen sc1
    v_cvt_pk_bf16_f32 v80, v80, v81
    v_cvt_pk_bf16_f32 v81, v82, v83
    buffer_store_dwordx2 v[80:81], v26, s[16:19], s26 offen sc1
    v_cvt_pk_bf16_f32 v84, v84, v85
    v_cvt_pk_bf16_f32 v85, v86, v87
    buffer_store_dwordx2 v[84:85], v27, s[16:19], s26 offen sc1
    s_waitcnt lgkmcnt(0)
    s_lshl_b32 s26, s21, 2
    s_lshl_b32 s33, s28, 1
    s_add_u32 s26, s26, s33
    s_mul_i32 s26, s26, s31
    s_add_u32 s26, s26, s32
    v_pk_fma_f32 v[56:57], v[36:37], v[120:121], v[56:57] op_sel_hi:[0,1,1] neg_lo:[1,0,0] neg_hi:[1,0,0]
    v_pk_fma_f32 v[58:59], v[36:37], v[122:123], v[58:59] op_sel_hi:[0,1,1] neg_lo:[1,0,0] neg_hi:[1,0,0]
    v_pk_fma_f32 v[60:61], v[36:37], v[124:125], v[60:61] op_sel_hi:[0,1,1] neg_lo:[1,0,0] neg_hi:[1,0,0]
    v_pk_fma_f32 v[62:63], v[36:37], v[126:127], v[62:63] op_sel_hi:[0,1,1] neg_lo:[1,0,0] neg_hi:[1,0,0]
    v_pk_fma_f32 v[64:65], v[36:37], v[128:129], v[64:65] op_sel_hi:[0,1,1] neg_lo:[1,0,0] neg_hi:[1,0,0]
    v_pk_fma_f32 v[66:67], v[36:37], v[130:131], v[66:67] op_sel_hi:[0,1,1] neg_lo:[1,0,0] neg_hi:[1,0,0]
    v_pk_fma_f32 v[68:69], v[36:37], v[132:133], v[68:69] op_sel_hi:[0,1,1] neg_lo:[1,0,0] neg_hi:[1,0,0]
    v_pk_fma_f32 v[70:71], v[36:37], v[134:135], v[70:71] op_sel_hi:[0,1,1] neg_lo:[1,0,0] neg_hi:[1,0,0]
    v_pk_mul_f32 v[56:57], v[56:57], v[36:37] op_sel:[0,1] op_sel_hi:[1,1]
    v_pk_mul_f32 v[58:59], v[58:59], v[36:37] op_sel:[0,1] op_sel_hi:[1,1]
    v_pk_mul_f32 v[60:61], v[60:61], v[36:37] op_sel:[0,1] op_sel_hi:[1,1]
    v_pk_mul_f32 v[62:63], v[62:63], v[36:37] op_sel:[0,1] op_sel_hi:[1,1]
    v_pk_mul_f32 v[64:65], v[64:65], v[36:37] op_sel:[0,1] op_sel_hi:[1,1]
    v_pk_mul_f32 v[66:67], v[66:67], v[36:37] op_sel:[0,1] op_sel_hi:[1,1]
    v_pk_mul_f32 v[68:69], v[68:69], v[36:37] op_sel:[0,1] op_sel_hi:[1,1]
    v_pk_mul_f32 v[70:71], v[70:71], v[36:37] op_sel:[0,1] op_sel_hi:[1,1]
    v_cvt_pk_bf16_f32 v56, v56, v57
    v_cvt_pk_bf16_f32 v57, v58, v59
    buffer_store_dwordx2 v[56:57], v28, s[16:19], s26 offen sc1
    v_cvt_pk_bf16_f32 v60, v60, v61
    v_cvt_pk_bf16_f32 v61, v62, v63
    buffer_store_dwordx2 v[60:61], v29, s[16:19], s26 offen sc1
    v_cvt_pk_bf16_f32 v64, v64, v65
    v_cvt_pk_bf16_f32 v65, v66, v67
    buffer_store_dwordx2 v[64:65], v30, s[16:19], s26 offen sc1
    v_cvt_pk_bf16_f32 v68, v68, v69
    v_cvt_pk_bf16_f32 v69, v70, v71
    buffer_store_dwordx2 v[68:69], v31, s[16:19], s26 offen sc1
    s_lshl_b32 s26, s21, 2
    s_lshl_b32 s33, s28, 1
    s_add_u32 s26, s26, s33
    s_add_u32 s26, s26, 1
    s_mul_i32 s26, s26, s31
    s_add_u32 s26, s26, s32
    v_pk_fma_f32 v[88:89], v[38:39], v[120:121], v[88:89] op_sel_hi:[0,1,1] neg_lo:[1,0,0] neg_hi:[1,0,0]
    v_pk_fma_f32 v[90:91], v[38:39], v[122:123], v[90:91] op_sel_hi:[0,1,1] neg_lo:[1,0,0] neg_hi:[1,0,0]
    v_pk_fma_f32 v[92:93], v[38:39], v[124:125], v[92:93] op_sel_hi:[0,1,1] neg_lo:[1,0,0] neg_hi:[1,0,0]
    v_pk_fma_f32 v[94:95], v[38:39], v[126:127], v[94:95] op_sel_hi:[0,1,1] neg_lo:[1,0,0] neg_hi:[1,0,0]
    v_pk_fma_f32 v[96:97], v[38:39], v[128:129], v[96:97] op_sel_hi:[0,1,1] neg_lo:[1,0,0] neg_hi:[1,0,0]
    v_pk_fma_f32 v[98:99], v[38:39], v[130:131], v[98:99] op_sel_hi:[0,1,1] neg_lo:[1,0,0] neg_hi:[1,0,0]
    v_pk_fma_f32 v[100:101], v[38:39], v[132:133], v[100:101] op_sel_hi:[0,1,1] neg_lo:[1,0,0] neg_hi:[1,0,0]
    v_pk_fma_f32 v[102:103], v[38:39], v[134:135], v[102:103] op_sel_hi:[0,1,1] neg_lo:[1,0,0] neg_hi:[1,0,0]
    v_pk_mul_f32 v[88:89], v[88:89], v[38:39] op_sel:[0,1] op_sel_hi:[1,1]
    v_pk_mul_f32 v[90:91], v[90:91], v[38:39] op_sel:[0,1] op_sel_hi:[1,1]
    v_pk_mul_f32 v[92:93], v[92:93], v[38:39] op_sel:[0,1] op_sel_hi:[1,1]
    v_pk_mul_f32 v[94:95], v[94:95], v[38:39] op_sel:[0,1] op_sel_hi:[1,1]
    v_pk_mul_f32 v[96:97], v[96:97], v[38:39] op_sel:[0,1] op_sel_hi:[1,1]
    v_pk_mul_f32 v[98:99], v[98:99], v[38:39] op_sel:[0,1] op_sel_hi:[1,1]
    v_pk_mul_f32 v[100:101], v[100:101], v[38:39] op_sel:[0,1] op_sel_hi:[1,1]
    v_pk_mul_f32 v[102:103], v[102:103], v[38:39] op_sel:[0,1] op_sel_hi:[1,1]
    v_cvt_pk_bf16_f32 v88, v88, v89
    v_cvt_pk_bf16_f32 v89, v90, v91
    buffer_store_dwordx2 v[88:89], v28, s[16:19], s26 offen sc1
    v_cvt_pk_bf16_f32 v92, v92, v93
    v_cvt_pk_bf16_f32 v93, v94, v95
    buffer_store_dwordx2 v[92:93], v29, s[16:19], s26 offen sc1
    v_cvt_pk_bf16_f32 v96, v96, v97
    v_cvt_pk_bf16_f32 v97, v98, v99
    buffer_store_dwordx2 v[96:97], v30, s[16:19], s26 offen sc1
    v_cvt_pk_bf16_f32 v100, v100, v101
    v_cvt_pk_bf16_f32 v101, v102, v103
    buffer_store_dwordx2 v[100:101], v31, s[16:19], s26 offen sc1
    s_branch parallel_sum__mha_block__mixer_token_mlp__prompt_kernel_cpub
parallel_sum__mha_block__mixer_token_mlp__prompt_kernel_v:
    s_sub_u32 s26, s22, 10
    s_lshl_b32 s26, s26, 7
    s_lshl_b32 s33, s29, 6
    s_add_u32 s26, s26, s33
    s_mov_b32 s34, 163520
    v_add_u32 v32, s26, v2
    v_mul_u32_u24 v34, 320, v3
    v_mul_u32_u24 v33, 0xcccd, v32
    v_lshrrev_b32 v33, 20, v33
    v_mul_lo_u32 v33, v33, s34
    v_lshl_add_u32 v24, v32, 4, v34
    v_add_u32 v24, v24, v33
    v_add_u32 v32, 32, v32
    v_mul_u32_u24 v33, 0xcccd, v32
    v_lshrrev_b32 v33, 20, v33
    v_mul_lo_u32 v33, v33, s34
    v_lshl_add_u32 v25, v32, 4, v34
    v_add_u32 v25, v25, v33
    s_lshl_b32 s26, s28, 8
    s_add_u32 s26, s26, 141824
    v_lshl_add_u32 v12, v3, 4, s26
    s_lshl_b32 s26, s29, 8
    s_add_u32 s26, s26, 142848
    v_lshl_add_u32 v13, v2, 2, s26
    s_barrier
    ds_read_b128 v[104:107], v4 offset:0
    ds_read_b128 v[108:111], v4 offset:4096
    ds_read_b64_tr_b16 v[112:113], v20 offset:0
    ds_read_b64_tr_b16 v[114:115], v20 offset:1024
    ds_read_b64_tr_b16 v[116:117], v21 offset:0
    ds_read_b64_tr_b16 v[118:119], v21 offset:1024
    ds_read_b128 v[120:123], v5 offset:0
    ds_read_b128 v[124:127], v5 offset:4096
    ds_read_b64_tr_b16 v[128:129], v20 offset:4096
    ds_read_b64_tr_b16 v[130:131], v20 offset:5120
    ds_read_b64_tr_b16 v[132:133], v21 offset:4096
    ds_read_b64_tr_b16 v[134:135], v21 offset:5120
    s_waitcnt lgkmcnt(6)
    v_mfma_f32_32x32x16_bf16 v[40:55], v[104:107], v[112:115], 0
    ds_read_b128 v[136:139], v6 offset:0
    ds_read_b128 v[140:143], v6 offset:4096
    v_mfma_f32_32x32x16_bf16 v[56:71], v[104:107], v[116:119], 0
    ds_read_b64_tr_b16 v[144:145], v20 offset:8192
    ds_read_b64_tr_b16 v[146:147], v20 offset:9216
    v_mfma_f32_32x32x16_bf16 v[72:87], v[108:111], v[112:115], 0
    ds_read_b64_tr_b16 v[148:149], v21 offset:8192
    ds_read_b64_tr_b16 v[150:151], v21 offset:9216
    v_mfma_f32_32x32x16_bf16 v[88:103], v[108:111], v[116:119], 0
    s_waitcnt lgkmcnt(6)
    v_mfma_f32_32x32x16_bf16 v[40:55], v[120:123], v[128:131], v[40:55]
    ds_read_b128 v[104:107], v7 offset:0
    ds_read_b128 v[108:111], v7 offset:4096
    v_mfma_f32_32x32x16_bf16 v[56:71], v[120:123], v[132:135], v[56:71]
    ds_read_b64_tr_b16 v[112:113], v20 offset:12288
    ds_read_b64_tr_b16 v[114:115], v20 offset:13312
    v_mfma_f32_32x32x16_bf16 v[72:87], v[124:127], v[128:131], v[72:87]
    ds_read_b64_tr_b16 v[116:117], v21 offset:12288
    ds_read_b64_tr_b16 v[118:119], v21 offset:13312
    v_mfma_f32_32x32x16_bf16 v[88:103], v[124:127], v[132:135], v[88:103]
    s_waitcnt lgkmcnt(6)
    v_mfma_f32_32x32x16_bf16 v[40:55], v[136:139], v[144:147], v[40:55]
    s_barrier
    ds_read_b128 v[120:123], v4 offset:32768
    ds_read_b128 v[124:127], v4 offset:36864
    v_mfma_f32_32x32x16_bf16 v[56:71], v[136:139], v[148:151], v[56:71]
    ds_read_b64_tr_b16 v[128:129], v20 offset:32768
    ds_read_b64_tr_b16 v[130:131], v20 offset:33792
    v_mfma_f32_32x32x16_bf16 v[72:87], v[140:143], v[144:147], v[72:87]
    ds_read_b64_tr_b16 v[132:133], v21 offset:32768
    ds_read_b64_tr_b16 v[134:135], v21 offset:33792
    v_mfma_f32_32x32x16_bf16 v[88:103], v[140:143], v[148:151], v[88:103]
    s_waitcnt lgkmcnt(6)
    v_mfma_f32_32x32x16_bf16 v[40:55], v[104:107], v[112:115], v[40:55]
    ds_read_b128 v[136:139], v5 offset:32768
    ds_read_b128 v[140:143], v5 offset:36864
    v_mfma_f32_32x32x16_bf16 v[56:71], v[104:107], v[116:119], v[56:71]
    ds_read_b64_tr_b16 v[144:145], v20 offset:36864
    ds_read_b64_tr_b16 v[146:147], v20 offset:37888
    v_mfma_f32_32x32x16_bf16 v[72:87], v[108:111], v[112:115], v[72:87]
    ds_read_b64_tr_b16 v[148:149], v21 offset:36864
    ds_read_b64_tr_b16 v[150:151], v21 offset:37888
    v_mfma_f32_32x32x16_bf16 v[88:103], v[108:111], v[116:119], v[88:103]
    s_waitcnt lgkmcnt(6)
    v_mfma_f32_32x32x16_bf16 v[40:55], v[120:123], v[128:131], v[40:55]
    ds_read_b128 v[104:107], v6 offset:32768
    ds_read_b128 v[108:111], v6 offset:36864
    v_mfma_f32_32x32x16_bf16 v[56:71], v[120:123], v[132:135], v[56:71]
    ds_read_b64_tr_b16 v[112:113], v20 offset:40960
    ds_read_b64_tr_b16 v[114:115], v20 offset:41984
    v_mfma_f32_32x32x16_bf16 v[72:87], v[124:127], v[128:131], v[72:87]
    ds_read_b64_tr_b16 v[116:117], v21 offset:40960
    ds_read_b64_tr_b16 v[118:119], v21 offset:41984
    v_mfma_f32_32x32x16_bf16 v[88:103], v[124:127], v[132:135], v[88:103]
    s_waitcnt lgkmcnt(6)
    v_mfma_f32_32x32x16_bf16 v[40:55], v[136:139], v[144:147], v[40:55]
    ds_read_b128 v[120:123], v7 offset:32768
    ds_read_b128 v[124:127], v7 offset:36864
    v_mfma_f32_32x32x16_bf16 v[56:71], v[136:139], v[148:151], v[56:71]
    ds_read_b64_tr_b16 v[128:129], v20 offset:45056
    ds_read_b64_tr_b16 v[130:131], v20 offset:46080
    v_mfma_f32_32x32x16_bf16 v[72:87], v[140:143], v[144:147], v[72:87]
    ds_read_b64_tr_b16 v[132:133], v21 offset:45056
    ds_read_b64_tr_b16 v[134:135], v21 offset:46080
    v_mfma_f32_32x32x16_bf16 v[88:103], v[140:143], v[148:151], v[88:103]
    s_waitcnt lgkmcnt(6)
    v_mfma_f32_32x32x16_bf16 v[40:55], v[104:107], v[112:115], v[40:55]
    s_barrier
    ds_read_b128 v[136:139], v8 offset:0
    ds_read_b128 v[140:143], v8 offset:4096
    v_mfma_f32_32x32x16_bf16 v[56:71], v[104:107], v[116:119], v[56:71]
    ds_read_b64_tr_b16 v[144:145], v22 offset:0
    ds_read_b64_tr_b16 v[146:147], v22 offset:1024
    v_mfma_f32_32x32x16_bf16 v[72:87], v[108:111], v[112:115], v[72:87]
    ds_read_b64_tr_b16 v[148:149], v23 offset:0
    ds_read_b64_tr_b16 v[150:151], v23 offset:1024
    v_mfma_f32_32x32x16_bf16 v[88:103], v[108:111], v[116:119], v[88:103]
    s_waitcnt lgkmcnt(6)
    v_mfma_f32_32x32x16_bf16 v[40:55], v[120:123], v[128:131], v[40:55]
    ds_read_b128 v[104:107], v9 offset:0
    ds_read_b128 v[108:111], v9 offset:4096
    v_mfma_f32_32x32x16_bf16 v[56:71], v[120:123], v[132:135], v[56:71]
    ds_read_b64_tr_b16 v[112:113], v22 offset:4096
    ds_read_b64_tr_b16 v[114:115], v22 offset:5120
    v_mfma_f32_32x32x16_bf16 v[72:87], v[124:127], v[128:131], v[72:87]
    ds_read_b64_tr_b16 v[116:117], v23 offset:4096
    ds_read_b64_tr_b16 v[118:119], v23 offset:5120
    v_mfma_f32_32x32x16_bf16 v[88:103], v[124:127], v[132:135], v[88:103]
    s_waitcnt lgkmcnt(6)
    v_mfma_f32_32x32x16_bf16 v[40:55], v[136:139], v[144:147], v[40:55]
    ds_read_b128 v[120:123], v10 offset:0
    ds_read_b128 v[124:127], v10 offset:4096
    v_mfma_f32_32x32x16_bf16 v[56:71], v[136:139], v[148:151], v[56:71]
    ds_read_b64_tr_b16 v[128:129], v22 offset:8192
    ds_read_b64_tr_b16 v[130:131], v22 offset:9216
    v_mfma_f32_32x32x16_bf16 v[72:87], v[140:143], v[144:147], v[72:87]
    ds_read_b64_tr_b16 v[132:133], v23 offset:8192
    ds_read_b64_tr_b16 v[134:135], v23 offset:9216
    v_mfma_f32_32x32x16_bf16 v[88:103], v[140:143], v[148:151], v[88:103]
    s_waitcnt lgkmcnt(6)
    v_mfma_f32_32x32x16_bf16 v[40:55], v[104:107], v[112:115], v[40:55]
    ds_read_b128 v[136:139], v11 offset:0
    ds_read_b128 v[140:143], v11 offset:4096
    v_mfma_f32_32x32x16_bf16 v[56:71], v[104:107], v[116:119], v[56:71]
    ds_read_b64_tr_b16 v[144:145], v22 offset:12288
    ds_read_b64_tr_b16 v[146:147], v22 offset:13312
    v_mfma_f32_32x32x16_bf16 v[72:87], v[108:111], v[112:115], v[72:87]
    ds_read_b64_tr_b16 v[148:149], v23 offset:12288
    ds_read_b64_tr_b16 v[150:151], v23 offset:13312
    v_mfma_f32_32x32x16_bf16 v[88:103], v[108:111], v[116:119], v[88:103]
    s_waitcnt lgkmcnt(6)
    v_mfma_f32_32x32x16_bf16 v[40:55], v[120:123], v[128:131], v[40:55]
    s_barrier
    ds_read_b128 v[104:107], v8 offset:32768
    ds_read_b128 v[108:111], v8 offset:36864
    v_mfma_f32_32x32x16_bf16 v[56:71], v[120:123], v[132:135], v[56:71]
    ds_read_b64_tr_b16 v[112:113], v22 offset:32768
    ds_read_b64_tr_b16 v[114:115], v22 offset:33792
    v_mfma_f32_32x32x16_bf16 v[72:87], v[124:127], v[128:131], v[72:87]
    ds_read_b64_tr_b16 v[116:117], v23 offset:32768
    ds_read_b64_tr_b16 v[118:119], v23 offset:33792
    v_mfma_f32_32x32x16_bf16 v[88:103], v[124:127], v[132:135], v[88:103]
    s_waitcnt lgkmcnt(6)
    v_mfma_f32_32x32x16_bf16 v[40:55], v[136:139], v[144:147], v[40:55]
    ds_read_b128 v[120:123], v9 offset:32768
    ds_read_b128 v[124:127], v9 offset:36864
    v_mfma_f32_32x32x16_bf16 v[56:71], v[136:139], v[148:151], v[56:71]
    ds_read_b64_tr_b16 v[128:129], v22 offset:36864
    ds_read_b64_tr_b16 v[130:131], v22 offset:37888
    v_mfma_f32_32x32x16_bf16 v[72:87], v[140:143], v[144:147], v[72:87]
    ds_read_b64_tr_b16 v[132:133], v23 offset:36864
    ds_read_b64_tr_b16 v[134:135], v23 offset:37888
    v_mfma_f32_32x32x16_bf16 v[88:103], v[140:143], v[148:151], v[88:103]
    s_waitcnt lgkmcnt(6)
    v_mfma_f32_32x32x16_bf16 v[40:55], v[104:107], v[112:115], v[40:55]
    ds_read_b128 v[136:139], v10 offset:32768
    ds_read_b128 v[140:143], v10 offset:36864
    v_mfma_f32_32x32x16_bf16 v[56:71], v[104:107], v[116:119], v[56:71]
    ds_read_b64_tr_b16 v[144:145], v22 offset:40960
    ds_read_b64_tr_b16 v[146:147], v22 offset:41984
    v_mfma_f32_32x32x16_bf16 v[72:87], v[108:111], v[112:115], v[72:87]
    ds_read_b64_tr_b16 v[148:149], v23 offset:40960
    ds_read_b64_tr_b16 v[150:151], v23 offset:41984
    v_mfma_f32_32x32x16_bf16 v[88:103], v[108:111], v[116:119], v[88:103]
    s_waitcnt lgkmcnt(6)
    v_mfma_f32_32x32x16_bf16 v[40:55], v[120:123], v[128:131], v[40:55]
    ds_read_b128 v[104:107], v11 offset:32768
    ds_read_b128 v[108:111], v11 offset:36864
    v_mfma_f32_32x32x16_bf16 v[56:71], v[120:123], v[132:135], v[56:71]
    ds_read_b64_tr_b16 v[112:113], v22 offset:45056
    ds_read_b64_tr_b16 v[114:115], v22 offset:46080
    v_mfma_f32_32x32x16_bf16 v[72:87], v[124:127], v[128:131], v[72:87]
    ds_read_b64_tr_b16 v[116:117], v23 offset:45056
    ds_read_b64_tr_b16 v[118:119], v23 offset:46080
    v_mfma_f32_32x32x16_bf16 v[88:103], v[124:127], v[132:135], v[88:103]
    s_waitcnt lgkmcnt(6)
    v_mfma_f32_32x32x16_bf16 v[40:55], v[136:139], v[144:147], v[40:55]
    s_barrier
    ds_read_b128 v[120:123], v4 offset:0
    ds_read_b128 v[124:127], v4 offset:4096
    v_mfma_f32_32x32x16_bf16 v[56:71], v[136:139], v[148:151], v[56:71]
    ds_read_b64_tr_b16 v[128:129], v20 offset:0
    ds_read_b64_tr_b16 v[130:131], v20 offset:1024
    v_mfma_f32_32x32x16_bf16 v[72:87], v[140:143], v[144:147], v[72:87]
    ds_read_b64_tr_b16 v[132:133], v21 offset:0
    ds_read_b64_tr_b16 v[134:135], v21 offset:1024
    v_mfma_f32_32x32x16_bf16 v[88:103], v[140:143], v[148:151], v[88:103]
    s_waitcnt lgkmcnt(6)
    v_mfma_f32_32x32x16_bf16 v[40:55], v[104:107], v[112:115], v[40:55]
    ds_read_b128 v[136:139], v5 offset:0
    ds_read_b128 v[140:143], v5 offset:4096
    v_mfma_f32_32x32x16_bf16 v[56:71], v[104:107], v[116:119], v[56:71]
    ds_read_b64_tr_b16 v[144:145], v20 offset:4096
    ds_read_b64_tr_b16 v[146:147], v20 offset:5120
    v_mfma_f32_32x32x16_bf16 v[72:87], v[108:111], v[112:115], v[72:87]
    ds_read_b64_tr_b16 v[148:149], v21 offset:4096
    ds_read_b64_tr_b16 v[150:151], v21 offset:5120
    v_mfma_f32_32x32x16_bf16 v[88:103], v[108:111], v[116:119], v[88:103]
    s_waitcnt lgkmcnt(6)
    v_mfma_f32_32x32x16_bf16 v[40:55], v[120:123], v[128:131], v[40:55]
    ds_read_b128 v[104:107], v6 offset:0
    ds_read_b128 v[108:111], v6 offset:4096
    v_mfma_f32_32x32x16_bf16 v[56:71], v[120:123], v[132:135], v[56:71]
    ds_read_b64_tr_b16 v[112:113], v20 offset:8192
    ds_read_b64_tr_b16 v[114:115], v20 offset:9216
    v_mfma_f32_32x32x16_bf16 v[72:87], v[124:127], v[128:131], v[72:87]
    ds_read_b64_tr_b16 v[116:117], v21 offset:8192
    ds_read_b64_tr_b16 v[118:119], v21 offset:9216
    v_mfma_f32_32x32x16_bf16 v[88:103], v[124:127], v[132:135], v[88:103]
    s_waitcnt lgkmcnt(6)
    v_mfma_f32_32x32x16_bf16 v[40:55], v[136:139], v[144:147], v[40:55]
    ds_read_b128 v[120:123], v7 offset:0
    ds_read_b128 v[124:127], v7 offset:4096
    v_mfma_f32_32x32x16_bf16 v[56:71], v[136:139], v[148:151], v[56:71]
    ds_read_b64_tr_b16 v[128:129], v20 offset:12288
    ds_read_b64_tr_b16 v[130:131], v20 offset:13312
    v_mfma_f32_32x32x16_bf16 v[72:87], v[140:143], v[144:147], v[72:87]
    ds_read_b64_tr_b16 v[132:133], v21 offset:12288
    ds_read_b64_tr_b16 v[134:135], v21 offset:13312
    v_mfma_f32_32x32x16_bf16 v[88:103], v[140:143], v[148:151], v[88:103]
    s_waitcnt lgkmcnt(6)
    v_mfma_f32_32x32x16_bf16 v[40:55], v[104:107], v[112:115], v[40:55]
    s_barrier
    ds_read_b128 v[136:139], v4 offset:32768
    ds_read_b128 v[140:143], v4 offset:36864
    v_mfma_f32_32x32x16_bf16 v[56:71], v[104:107], v[116:119], v[56:71]
    ds_read_b64_tr_b16 v[144:145], v20 offset:32768
    ds_read_b64_tr_b16 v[146:147], v20 offset:33792
    v_mfma_f32_32x32x16_bf16 v[72:87], v[108:111], v[112:115], v[72:87]
    ds_read_b64_tr_b16 v[148:149], v21 offset:32768
    ds_read_b64_tr_b16 v[150:151], v21 offset:33792
    v_mfma_f32_32x32x16_bf16 v[88:103], v[108:111], v[116:119], v[88:103]
    s_waitcnt lgkmcnt(6)
    v_mfma_f32_32x32x16_bf16 v[40:55], v[120:123], v[128:131], v[40:55]
    ds_read_b128 v[104:107], v5 offset:32768
    ds_read_b128 v[108:111], v5 offset:36864
    v_mfma_f32_32x32x16_bf16 v[56:71], v[120:123], v[132:135], v[56:71]
    ds_read_b64_tr_b16 v[112:113], v20 offset:36864
    ds_read_b64_tr_b16 v[114:115], v20 offset:37888
    v_mfma_f32_32x32x16_bf16 v[72:87], v[124:127], v[128:131], v[72:87]
    ds_read_b64_tr_b16 v[116:117], v21 offset:36864
    ds_read_b64_tr_b16 v[118:119], v21 offset:37888
    v_mfma_f32_32x32x16_bf16 v[88:103], v[124:127], v[132:135], v[88:103]
    s_waitcnt lgkmcnt(6)
    v_mfma_f32_32x32x16_bf16 v[40:55], v[136:139], v[144:147], v[40:55]
    ds_read_b128 v[120:123], v6 offset:32768
    ds_read_b128 v[124:127], v6 offset:36864
    v_mfma_f32_32x32x16_bf16 v[56:71], v[136:139], v[148:151], v[56:71]
    ds_read_b64_tr_b16 v[128:129], v20 offset:40960
    ds_read_b64_tr_b16 v[130:131], v20 offset:41984
    v_mfma_f32_32x32x16_bf16 v[72:87], v[140:143], v[144:147], v[72:87]
    ds_read_b64_tr_b16 v[132:133], v21 offset:40960
    ds_read_b64_tr_b16 v[134:135], v21 offset:41984
    v_mfma_f32_32x32x16_bf16 v[88:103], v[140:143], v[148:151], v[88:103]
    s_waitcnt lgkmcnt(6)
    v_mfma_f32_32x32x16_bf16 v[40:55], v[104:107], v[112:115], v[40:55]
    ds_read_b128 v[136:139], v7 offset:32768
    ds_read_b128 v[140:143], v7 offset:36864
    v_mfma_f32_32x32x16_bf16 v[56:71], v[104:107], v[116:119], v[56:71]
    ds_read_b64_tr_b16 v[144:145], v20 offset:45056
    ds_read_b64_tr_b16 v[146:147], v20 offset:46080
    v_mfma_f32_32x32x16_bf16 v[72:87], v[108:111], v[112:115], v[72:87]
    ds_read_b64_tr_b16 v[148:149], v21 offset:45056
    ds_read_b64_tr_b16 v[150:151], v21 offset:46080
    v_mfma_f32_32x32x16_bf16 v[88:103], v[108:111], v[116:119], v[88:103]
    s_waitcnt lgkmcnt(6)
    v_mfma_f32_32x32x16_bf16 v[40:55], v[120:123], v[128:131], v[40:55]
    s_barrier
    ds_read_b128 v[104:107], v8 offset:0
    ds_read_b128 v[108:111], v8 offset:4096
    v_mfma_f32_32x32x16_bf16 v[56:71], v[120:123], v[132:135], v[56:71]
    ds_read_b64_tr_b16 v[112:113], v22 offset:0
    ds_read_b64_tr_b16 v[114:115], v22 offset:1024
    v_mfma_f32_32x32x16_bf16 v[72:87], v[124:127], v[128:131], v[72:87]
    ds_read_b64_tr_b16 v[116:117], v23 offset:0
    ds_read_b64_tr_b16 v[118:119], v23 offset:1024
    v_mfma_f32_32x32x16_bf16 v[88:103], v[124:127], v[132:135], v[88:103]
    s_waitcnt lgkmcnt(6)
    v_mfma_f32_32x32x16_bf16 v[40:55], v[136:139], v[144:147], v[40:55]
    ds_read_b128 v[120:123], v9 offset:0
    ds_read_b128 v[124:127], v9 offset:4096
    v_mfma_f32_32x32x16_bf16 v[56:71], v[136:139], v[148:151], v[56:71]
    ds_read_b64_tr_b16 v[128:129], v22 offset:4096
    ds_read_b64_tr_b16 v[130:131], v22 offset:5120
    v_mfma_f32_32x32x16_bf16 v[72:87], v[140:143], v[144:147], v[72:87]
    ds_read_b64_tr_b16 v[132:133], v23 offset:4096
    ds_read_b64_tr_b16 v[134:135], v23 offset:5120
    v_mfma_f32_32x32x16_bf16 v[88:103], v[140:143], v[148:151], v[88:103]
    s_waitcnt lgkmcnt(6)
    v_mfma_f32_32x32x16_bf16 v[40:55], v[104:107], v[112:115], v[40:55]
    ds_read_b128 v[136:139], v10 offset:0
    ds_read_b128 v[140:143], v10 offset:4096
    v_mfma_f32_32x32x16_bf16 v[56:71], v[104:107], v[116:119], v[56:71]
    ds_read_b64_tr_b16 v[144:145], v22 offset:8192
    ds_read_b64_tr_b16 v[146:147], v22 offset:9216
    v_mfma_f32_32x32x16_bf16 v[72:87], v[108:111], v[112:115], v[72:87]
    ds_read_b64_tr_b16 v[148:149], v23 offset:8192
    ds_read_b64_tr_b16 v[150:151], v23 offset:9216
    v_mfma_f32_32x32x16_bf16 v[88:103], v[108:111], v[116:119], v[88:103]
    s_waitcnt lgkmcnt(6)
    v_mfma_f32_32x32x16_bf16 v[40:55], v[120:123], v[128:131], v[40:55]
    ds_read_b128 v[104:107], v11 offset:0
    ds_read_b128 v[108:111], v11 offset:4096
    v_mfma_f32_32x32x16_bf16 v[56:71], v[120:123], v[132:135], v[56:71]
    ds_read_b64_tr_b16 v[112:113], v22 offset:12288
    ds_read_b64_tr_b16 v[114:115], v22 offset:13312
    v_mfma_f32_32x32x16_bf16 v[72:87], v[124:127], v[128:131], v[72:87]
    ds_read_b64_tr_b16 v[116:117], v23 offset:12288
    ds_read_b64_tr_b16 v[118:119], v23 offset:13312
    v_mfma_f32_32x32x16_bf16 v[88:103], v[124:127], v[132:135], v[88:103]
    s_waitcnt lgkmcnt(6)
    v_mfma_f32_32x32x16_bf16 v[40:55], v[136:139], v[144:147], v[40:55]
    s_barrier
    ds_read_b128 v[120:123], v8 offset:32768
    ds_read_b128 v[124:127], v8 offset:36864
    v_mfma_f32_32x32x16_bf16 v[56:71], v[136:139], v[148:151], v[56:71]
    ds_read_b64_tr_b16 v[128:129], v22 offset:32768
    ds_read_b64_tr_b16 v[130:131], v22 offset:33792
    v_mfma_f32_32x32x16_bf16 v[72:87], v[140:143], v[144:147], v[72:87]
    ds_read_b64_tr_b16 v[132:133], v23 offset:32768
    ds_read_b64_tr_b16 v[134:135], v23 offset:33792
    v_mfma_f32_32x32x16_bf16 v[88:103], v[140:143], v[148:151], v[88:103]
    s_waitcnt lgkmcnt(6)
    v_mfma_f32_32x32x16_bf16 v[40:55], v[104:107], v[112:115], v[40:55]
    ds_read_b128 v[136:139], v9 offset:32768
    ds_read_b128 v[140:143], v9 offset:36864
    v_mfma_f32_32x32x16_bf16 v[56:71], v[104:107], v[116:119], v[56:71]
    ds_read_b64_tr_b16 v[144:145], v22 offset:36864
    ds_read_b64_tr_b16 v[146:147], v22 offset:37888
    v_mfma_f32_32x32x16_bf16 v[72:87], v[108:111], v[112:115], v[72:87]
    ds_read_b64_tr_b16 v[148:149], v23 offset:36864
    ds_read_b64_tr_b16 v[150:151], v23 offset:37888
    v_mfma_f32_32x32x16_bf16 v[88:103], v[108:111], v[116:119], v[88:103]
    s_waitcnt lgkmcnt(6)
    v_mfma_f32_32x32x16_bf16 v[40:55], v[120:123], v[128:131], v[40:55]
    ds_read_b128 v[104:107], v10 offset:32768
    ds_read_b128 v[108:111], v10 offset:36864
    v_mfma_f32_32x32x16_bf16 v[56:71], v[120:123], v[132:135], v[56:71]
    ds_read_b64_tr_b16 v[112:113], v22 offset:40960
    ds_read_b64_tr_b16 v[114:115], v22 offset:41984
    v_mfma_f32_32x32x16_bf16 v[72:87], v[124:127], v[128:131], v[72:87]
    ds_read_b64_tr_b16 v[116:117], v23 offset:40960
    ds_read_b64_tr_b16 v[118:119], v23 offset:41984
    v_mfma_f32_32x32x16_bf16 v[88:103], v[124:127], v[132:135], v[88:103]
    s_waitcnt lgkmcnt(6)
    v_mfma_f32_32x32x16_bf16 v[40:55], v[136:139], v[144:147], v[40:55]
    ds_read_b128 v[120:123], v11 offset:32768
    ds_read_b128 v[124:127], v11 offset:36864
    v_mfma_f32_32x32x16_bf16 v[56:71], v[136:139], v[148:151], v[56:71]
    ds_read_b64_tr_b16 v[128:129], v22 offset:45056
    ds_read_b64_tr_b16 v[130:131], v22 offset:46080
    v_mfma_f32_32x32x16_bf16 v[72:87], v[140:143], v[144:147], v[72:87]
    ds_read_b64_tr_b16 v[132:133], v23 offset:45056
    ds_read_b64_tr_b16 v[134:135], v23 offset:46080
    v_mfma_f32_32x32x16_bf16 v[88:103], v[140:143], v[148:151], v[88:103]
    s_waitcnt lgkmcnt(6)
    v_mfma_f32_32x32x16_bf16 v[40:55], v[104:107], v[112:115], v[40:55]
    s_barrier
    ds_read_b128 v[136:139], v4 offset:0
    ds_read_b128 v[140:143], v4 offset:4096
    v_mfma_f32_32x32x16_bf16 v[56:71], v[104:107], v[116:119], v[56:71]
    ds_read_b64_tr_b16 v[144:145], v20 offset:0
    ds_read_b64_tr_b16 v[146:147], v20 offset:1024
    v_mfma_f32_32x32x16_bf16 v[72:87], v[108:111], v[112:115], v[72:87]
    ds_read_b64_tr_b16 v[148:149], v21 offset:0
    ds_read_b64_tr_b16 v[150:151], v21 offset:1024
    v_mfma_f32_32x32x16_bf16 v[88:103], v[108:111], v[116:119], v[88:103]
    s_waitcnt lgkmcnt(6)
    v_mfma_f32_32x32x16_bf16 v[40:55], v[120:123], v[128:131], v[40:55]
    ds_read_b128 v[104:107], v5 offset:0
    ds_read_b128 v[108:111], v5 offset:4096
    v_mfma_f32_32x32x16_bf16 v[56:71], v[120:123], v[132:135], v[56:71]
    ds_read_b64_tr_b16 v[112:113], v20 offset:4096
    ds_read_b64_tr_b16 v[114:115], v20 offset:5120
    v_mfma_f32_32x32x16_bf16 v[72:87], v[124:127], v[128:131], v[72:87]
    ds_read_b64_tr_b16 v[116:117], v21 offset:4096
    ds_read_b64_tr_b16 v[118:119], v21 offset:5120
    v_mfma_f32_32x32x16_bf16 v[88:103], v[124:127], v[132:135], v[88:103]
    s_waitcnt lgkmcnt(6)
    v_mfma_f32_32x32x16_bf16 v[40:55], v[136:139], v[144:147], v[40:55]
    ds_read_b128 v[120:123], v6 offset:0
    ds_read_b128 v[124:127], v6 offset:4096
    v_mfma_f32_32x32x16_bf16 v[56:71], v[136:139], v[148:151], v[56:71]
    ds_read_b64_tr_b16 v[128:129], v20 offset:8192
    ds_read_b64_tr_b16 v[130:131], v20 offset:9216
    v_mfma_f32_32x32x16_bf16 v[72:87], v[140:143], v[144:147], v[72:87]
    ds_read_b64_tr_b16 v[132:133], v21 offset:8192
    ds_read_b64_tr_b16 v[134:135], v21 offset:9216
    v_mfma_f32_32x32x16_bf16 v[88:103], v[140:143], v[148:151], v[88:103]
    s_waitcnt lgkmcnt(6)
    v_mfma_f32_32x32x16_bf16 v[40:55], v[104:107], v[112:115], v[40:55]
    ds_read_b128 v[136:139], v7 offset:0
    ds_read_b128 v[140:143], v7 offset:4096
    v_mfma_f32_32x32x16_bf16 v[56:71], v[104:107], v[116:119], v[56:71]
    ds_read_b64_tr_b16 v[144:145], v20 offset:12288
    ds_read_b64_tr_b16 v[146:147], v20 offset:13312
    v_mfma_f32_32x32x16_bf16 v[72:87], v[108:111], v[112:115], v[72:87]
    ds_read_b64_tr_b16 v[148:149], v21 offset:12288
    ds_read_b64_tr_b16 v[150:151], v21 offset:13312
    v_mfma_f32_32x32x16_bf16 v[88:103], v[108:111], v[116:119], v[88:103]
    s_waitcnt lgkmcnt(6)
    v_mfma_f32_32x32x16_bf16 v[40:55], v[120:123], v[128:131], v[40:55]
    s_barrier
    ds_read_b128 v[104:107], v4 offset:32768
    ds_read_b128 v[108:111], v4 offset:36864
    v_mfma_f32_32x32x16_bf16 v[56:71], v[120:123], v[132:135], v[56:71]
    ds_read_b64_tr_b16 v[112:113], v20 offset:32768
    ds_read_b64_tr_b16 v[114:115], v20 offset:33792
    v_mfma_f32_32x32x16_bf16 v[72:87], v[124:127], v[128:131], v[72:87]
    ds_read_b64_tr_b16 v[116:117], v21 offset:32768
    ds_read_b64_tr_b16 v[118:119], v21 offset:33792
    v_mfma_f32_32x32x16_bf16 v[88:103], v[124:127], v[132:135], v[88:103]
    s_waitcnt lgkmcnt(6)
    v_mfma_f32_32x32x16_bf16 v[40:55], v[136:139], v[144:147], v[40:55]
    ds_read_b128 v[120:123], v5 offset:32768
    ds_read_b128 v[124:127], v5 offset:36864
    v_mfma_f32_32x32x16_bf16 v[56:71], v[136:139], v[148:151], v[56:71]
    ds_read_b64_tr_b16 v[128:129], v20 offset:36864
    ds_read_b64_tr_b16 v[130:131], v20 offset:37888
    v_mfma_f32_32x32x16_bf16 v[72:87], v[140:143], v[144:147], v[72:87]
    ds_read_b64_tr_b16 v[132:133], v21 offset:36864
    ds_read_b64_tr_b16 v[134:135], v21 offset:37888
    v_mfma_f32_32x32x16_bf16 v[88:103], v[140:143], v[148:151], v[88:103]
    s_waitcnt lgkmcnt(6)
    v_mfma_f32_32x32x16_bf16 v[40:55], v[104:107], v[112:115], v[40:55]
    ds_read_b128 v[136:139], v6 offset:32768
    ds_read_b128 v[140:143], v6 offset:36864
    v_mfma_f32_32x32x16_bf16 v[56:71], v[104:107], v[116:119], v[56:71]
    ds_read_b64_tr_b16 v[144:145], v20 offset:40960
    ds_read_b64_tr_b16 v[146:147], v20 offset:41984
    v_mfma_f32_32x32x16_bf16 v[72:87], v[108:111], v[112:115], v[72:87]
    ds_read_b64_tr_b16 v[148:149], v21 offset:40960
    ds_read_b64_tr_b16 v[150:151], v21 offset:41984
    v_mfma_f32_32x32x16_bf16 v[88:103], v[108:111], v[116:119], v[88:103]
    s_waitcnt lgkmcnt(6)
    v_mfma_f32_32x32x16_bf16 v[40:55], v[120:123], v[128:131], v[40:55]
    ds_read_b128 v[104:107], v7 offset:32768
    ds_read_b128 v[108:111], v7 offset:36864
    v_mfma_f32_32x32x16_bf16 v[56:71], v[120:123], v[132:135], v[56:71]
    ds_read_b64_tr_b16 v[112:113], v20 offset:45056
    ds_read_b64_tr_b16 v[114:115], v20 offset:46080
    v_mfma_f32_32x32x16_bf16 v[72:87], v[124:127], v[128:131], v[72:87]
    ds_read_b64_tr_b16 v[116:117], v21 offset:45056
    ds_read_b64_tr_b16 v[118:119], v21 offset:46080
    v_mfma_f32_32x32x16_bf16 v[88:103], v[124:127], v[132:135], v[88:103]
    s_waitcnt lgkmcnt(6)
    v_mfma_f32_32x32x16_bf16 v[40:55], v[136:139], v[144:147], v[40:55]
    s_barrier
    v_mfma_f32_32x32x16_bf16 v[56:71], v[136:139], v[148:151], v[56:71]
    v_mfma_f32_32x32x16_bf16 v[72:87], v[140:143], v[144:147], v[72:87]
    v_mfma_f32_32x32x16_bf16 v[88:103], v[140:143], v[148:151], v[88:103]
    s_waitcnt lgkmcnt(0)
    v_mfma_f32_32x32x16_bf16 v[40:55], v[104:107], v[112:115], v[40:55]
    v_mfma_f32_32x32x16_bf16 v[56:71], v[104:107], v[116:119], v[56:71]
    v_mfma_f32_32x32x16_bf16 v[72:87], v[108:111], v[112:115], v[72:87]
    v_mfma_f32_32x32x16_bf16 v[88:103], v[108:111], v[116:119], v[88:103]
    s_barrier
    ds_read_b32 v36, v13
    ds_read_b32 v37, v13 offset:128
    ds_read_b128 v[104:107], v12 offset:0
    ds_read_b128 v[136:139], v12 offset:512
    ds_read_b128 v[108:111], v12 offset:32
    ds_read_b128 v[140:143], v12 offset:544
    ds_read_b128 v[112:115], v12 offset:64
    ds_read_b128 v[144:147], v12 offset:576
    ds_read_b128 v[116:119], v12 offset:96
    ds_read_b128 v[148:151], v12 offset:608
    s_waitcnt lgkmcnt(4)
    ds_read_b128 v[120:123], v12 offset:128
    ds_read_b128 v[152:155], v12 offset:640
    ds_read_b128 v[124:127], v12 offset:160
    ds_read_b128 v[156:159], v12 offset:672
    ds_read_b128 v[128:131], v12 offset:192
    ds_read_b128 v[160:163], v12 offset:704
    ds_read_b128 v[132:135], v12 offset:224
    ds_read_b128 v[164:167], v12 offset:736
    s_waitcnt lgkmcnt(8)
    s_lshl_b32 s26, s21, 2
    s_lshl_b32 s33, s28, 1
    s_add_u32 s26, s26, s33
    s_mul_i32 s26, s26, 2560
    s_add_u32 s26, s26, 2622720
    v_pk_fma_f32 v[40:41], v[104:105], v[36:37], v[40:41] op_sel:[0,0,0] op_sel_hi:[1,0,1] neg_lo:[1,0,0] neg_hi:[1,0,0]
    v_pk_fma_f32 v[42:43], v[106:107], v[36:37], v[42:43] op_sel:[0,0,0] op_sel_hi:[1,0,1] neg_lo:[1,0,0] neg_hi:[1,0,0]
    v_pk_fma_f32 v[44:45], v[108:109], v[36:37], v[44:45] op_sel:[0,0,0] op_sel_hi:[1,0,1] neg_lo:[1,0,0] neg_hi:[1,0,0]
    v_pk_fma_f32 v[46:47], v[110:111], v[36:37], v[46:47] op_sel:[0,0,0] op_sel_hi:[1,0,1] neg_lo:[1,0,0] neg_hi:[1,0,0]
    v_pk_fma_f32 v[48:49], v[112:113], v[36:37], v[48:49] op_sel:[0,0,0] op_sel_hi:[1,0,1] neg_lo:[1,0,0] neg_hi:[1,0,0]
    v_pk_fma_f32 v[50:51], v[114:115], v[36:37], v[50:51] op_sel:[0,0,0] op_sel_hi:[1,0,1] neg_lo:[1,0,0] neg_hi:[1,0,0]
    v_pk_fma_f32 v[52:53], v[116:117], v[36:37], v[52:53] op_sel:[0,0,0] op_sel_hi:[1,0,1] neg_lo:[1,0,0] neg_hi:[1,0,0]
    v_pk_fma_f32 v[54:55], v[118:119], v[36:37], v[54:55] op_sel:[0,0,0] op_sel_hi:[1,0,1] neg_lo:[1,0,0] neg_hi:[1,0,0]
    v_pk_mul_f32 v[40:41], v[40:41], v[136:137]
    v_pk_mul_f32 v[42:43], v[42:43], v[138:139]
    v_pk_mul_f32 v[44:45], v[44:45], v[140:141]
    v_pk_mul_f32 v[46:47], v[46:47], v[142:143]
    v_pk_mul_f32 v[48:49], v[48:49], v[144:145]
    v_pk_mul_f32 v[50:51], v[50:51], v[146:147]
    v_pk_mul_f32 v[52:53], v[52:53], v[148:149]
    v_pk_mul_f32 v[54:55], v[54:55], v[150:151]
    v_cvt_pk_bf16_f32 v40, v40, v41
    v_cvt_pk_bf16_f32 v41, v42, v43
    v_cvt_pk_bf16_f32 v42, v44, v45
    v_cvt_pk_bf16_f32 v43, v46, v47
    buffer_store_dwordx4 v[40:43], v24, s[16:19], s26 offen offset:0 sc1
    v_cvt_pk_bf16_f32 v48, v48, v49
    v_cvt_pk_bf16_f32 v49, v50, v51
    v_cvt_pk_bf16_f32 v50, v52, v53
    v_cvt_pk_bf16_f32 v51, v54, v55
    buffer_store_dwordx4 v[48:51], v24, s[16:19], s26 offen offset:640 sc1
    v_pk_fma_f32 v[56:57], v[104:105], v[36:37], v[56:57] op_sel:[0,1,0] op_sel_hi:[1,1,1] neg_lo:[1,0,0] neg_hi:[1,0,0]
    v_pk_fma_f32 v[58:59], v[106:107], v[36:37], v[58:59] op_sel:[0,1,0] op_sel_hi:[1,1,1] neg_lo:[1,0,0] neg_hi:[1,0,0]
    v_pk_fma_f32 v[60:61], v[108:109], v[36:37], v[60:61] op_sel:[0,1,0] op_sel_hi:[1,1,1] neg_lo:[1,0,0] neg_hi:[1,0,0]
    v_pk_fma_f32 v[62:63], v[110:111], v[36:37], v[62:63] op_sel:[0,1,0] op_sel_hi:[1,1,1] neg_lo:[1,0,0] neg_hi:[1,0,0]
    v_pk_fma_f32 v[64:65], v[112:113], v[36:37], v[64:65] op_sel:[0,1,0] op_sel_hi:[1,1,1] neg_lo:[1,0,0] neg_hi:[1,0,0]
    v_pk_fma_f32 v[66:67], v[114:115], v[36:37], v[66:67] op_sel:[0,1,0] op_sel_hi:[1,1,1] neg_lo:[1,0,0] neg_hi:[1,0,0]
    v_pk_fma_f32 v[68:69], v[116:117], v[36:37], v[68:69] op_sel:[0,1,0] op_sel_hi:[1,1,1] neg_lo:[1,0,0] neg_hi:[1,0,0]
    v_pk_fma_f32 v[70:71], v[118:119], v[36:37], v[70:71] op_sel:[0,1,0] op_sel_hi:[1,1,1] neg_lo:[1,0,0] neg_hi:[1,0,0]
    v_pk_mul_f32 v[56:57], v[56:57], v[136:137]
    v_pk_mul_f32 v[58:59], v[58:59], v[138:139]
    v_pk_mul_f32 v[60:61], v[60:61], v[140:141]
    v_pk_mul_f32 v[62:63], v[62:63], v[142:143]
    v_pk_mul_f32 v[64:65], v[64:65], v[144:145]
    v_pk_mul_f32 v[66:67], v[66:67], v[146:147]
    v_pk_mul_f32 v[68:69], v[68:69], v[148:149]
    v_pk_mul_f32 v[70:71], v[70:71], v[150:151]
    v_cvt_pk_bf16_f32 v56, v56, v57
    v_cvt_pk_bf16_f32 v57, v58, v59
    v_cvt_pk_bf16_f32 v58, v60, v61
    v_cvt_pk_bf16_f32 v59, v62, v63
    buffer_store_dwordx4 v[56:59], v25, s[16:19], s26 offen offset:0 sc1
    v_cvt_pk_bf16_f32 v64, v64, v65
    v_cvt_pk_bf16_f32 v65, v66, v67
    v_cvt_pk_bf16_f32 v66, v68, v69
    v_cvt_pk_bf16_f32 v67, v70, v71
    buffer_store_dwordx4 v[64:67], v25, s[16:19], s26 offen offset:640 sc1
    s_waitcnt lgkmcnt(0)
    s_lshl_b32 s26, s21, 2
    s_lshl_b32 s33, s28, 1
    s_add_u32 s26, s26, s33
    s_add_u32 s26, s26, 1
    s_mul_i32 s26, s26, 2560
    s_add_u32 s26, s26, 2622720
    v_pk_fma_f32 v[72:73], v[120:121], v[36:37], v[72:73] op_sel:[0,0,0] op_sel_hi:[1,0,1] neg_lo:[1,0,0] neg_hi:[1,0,0]
    v_pk_fma_f32 v[74:75], v[122:123], v[36:37], v[74:75] op_sel:[0,0,0] op_sel_hi:[1,0,1] neg_lo:[1,0,0] neg_hi:[1,0,0]
    v_pk_fma_f32 v[76:77], v[124:125], v[36:37], v[76:77] op_sel:[0,0,0] op_sel_hi:[1,0,1] neg_lo:[1,0,0] neg_hi:[1,0,0]
    v_pk_fma_f32 v[78:79], v[126:127], v[36:37], v[78:79] op_sel:[0,0,0] op_sel_hi:[1,0,1] neg_lo:[1,0,0] neg_hi:[1,0,0]
    v_pk_fma_f32 v[80:81], v[128:129], v[36:37], v[80:81] op_sel:[0,0,0] op_sel_hi:[1,0,1] neg_lo:[1,0,0] neg_hi:[1,0,0]
    v_pk_fma_f32 v[82:83], v[130:131], v[36:37], v[82:83] op_sel:[0,0,0] op_sel_hi:[1,0,1] neg_lo:[1,0,0] neg_hi:[1,0,0]
    v_pk_fma_f32 v[84:85], v[132:133], v[36:37], v[84:85] op_sel:[0,0,0] op_sel_hi:[1,0,1] neg_lo:[1,0,0] neg_hi:[1,0,0]
    v_pk_fma_f32 v[86:87], v[134:135], v[36:37], v[86:87] op_sel:[0,0,0] op_sel_hi:[1,0,1] neg_lo:[1,0,0] neg_hi:[1,0,0]
    v_pk_mul_f32 v[72:73], v[72:73], v[152:153]
    v_pk_mul_f32 v[74:75], v[74:75], v[154:155]
    v_pk_mul_f32 v[76:77], v[76:77], v[156:157]
    v_pk_mul_f32 v[78:79], v[78:79], v[158:159]
    v_pk_mul_f32 v[80:81], v[80:81], v[160:161]
    v_pk_mul_f32 v[82:83], v[82:83], v[162:163]
    v_pk_mul_f32 v[84:85], v[84:85], v[164:165]
    v_pk_mul_f32 v[86:87], v[86:87], v[166:167]
    v_cvt_pk_bf16_f32 v72, v72, v73
    v_cvt_pk_bf16_f32 v73, v74, v75
    v_cvt_pk_bf16_f32 v74, v76, v77
    v_cvt_pk_bf16_f32 v75, v78, v79
    buffer_store_dwordx4 v[72:75], v24, s[16:19], s26 offen offset:0 sc1
    v_cvt_pk_bf16_f32 v80, v80, v81
    v_cvt_pk_bf16_f32 v81, v82, v83
    v_cvt_pk_bf16_f32 v82, v84, v85
    v_cvt_pk_bf16_f32 v83, v86, v87
    buffer_store_dwordx4 v[80:83], v24, s[16:19], s26 offen offset:640 sc1
    v_pk_fma_f32 v[88:89], v[120:121], v[36:37], v[88:89] op_sel:[0,1,0] op_sel_hi:[1,1,1] neg_lo:[1,0,0] neg_hi:[1,0,0]
    v_pk_fma_f32 v[90:91], v[122:123], v[36:37], v[90:91] op_sel:[0,1,0] op_sel_hi:[1,1,1] neg_lo:[1,0,0] neg_hi:[1,0,0]
    v_pk_fma_f32 v[92:93], v[124:125], v[36:37], v[92:93] op_sel:[0,1,0] op_sel_hi:[1,1,1] neg_lo:[1,0,0] neg_hi:[1,0,0]
    v_pk_fma_f32 v[94:95], v[126:127], v[36:37], v[94:95] op_sel:[0,1,0] op_sel_hi:[1,1,1] neg_lo:[1,0,0] neg_hi:[1,0,0]
    v_pk_fma_f32 v[96:97], v[128:129], v[36:37], v[96:97] op_sel:[0,1,0] op_sel_hi:[1,1,1] neg_lo:[1,0,0] neg_hi:[1,0,0]
    v_pk_fma_f32 v[98:99], v[130:131], v[36:37], v[98:99] op_sel:[0,1,0] op_sel_hi:[1,1,1] neg_lo:[1,0,0] neg_hi:[1,0,0]
    v_pk_fma_f32 v[100:101], v[132:133], v[36:37], v[100:101] op_sel:[0,1,0] op_sel_hi:[1,1,1] neg_lo:[1,0,0] neg_hi:[1,0,0]
    v_pk_fma_f32 v[102:103], v[134:135], v[36:37], v[102:103] op_sel:[0,1,0] op_sel_hi:[1,1,1] neg_lo:[1,0,0] neg_hi:[1,0,0]
    v_pk_mul_f32 v[88:89], v[88:89], v[152:153]
    v_pk_mul_f32 v[90:91], v[90:91], v[154:155]
    v_pk_mul_f32 v[92:93], v[92:93], v[156:157]
    v_pk_mul_f32 v[94:95], v[94:95], v[158:159]
    v_pk_mul_f32 v[96:97], v[96:97], v[160:161]
    v_pk_mul_f32 v[98:99], v[98:99], v[162:163]
    v_pk_mul_f32 v[100:101], v[100:101], v[164:165]
    v_pk_mul_f32 v[102:103], v[102:103], v[166:167]
    v_cvt_pk_bf16_f32 v88, v88, v89
    v_cvt_pk_bf16_f32 v89, v90, v91
    v_cvt_pk_bf16_f32 v90, v92, v93
    v_cvt_pk_bf16_f32 v91, v94, v95
    buffer_store_dwordx4 v[88:91], v25, s[16:19], s26 offen offset:0 sc1
    v_cvt_pk_bf16_f32 v96, v96, v97
    v_cvt_pk_bf16_f32 v97, v98, v99
    v_cvt_pk_bf16_f32 v98, v100, v101
    v_cvt_pk_bf16_f32 v99, v102, v103
    buffer_store_dwordx4 v[96:99], v25, s[16:19], s26 offen offset:640 sc1
parallel_sum__mha_block__mixer_token_mlp__prompt_kernel_cpub:
    s_lshl_b32 s23, s21, 4
    s_add_u32 s23, s23, s22
    s_lshl_b32 s23, s23, 7
    s_add_u32 s23, s23, 21757952
    s_mov_b64 exec, 1
    v_mov_b32 v32, 141780
    v_mov_b32 v33, 1
    s_waitcnt vmcnt(0)
    ds_add_rtn_u32 v32, v32, v33
    s_waitcnt lgkmcnt(0)
    v_readfirstlane_b32 s59, v32
    s_nop 0
    s_cmp_lg_u32 s59, 3
    s_cbranch_scc1 Lp3
    v_mov_b32 v32, 0
    buffer_store_dword v33, v32, s[16:19], s23 offen sc1
Lp3:
    s_mov_b64 exec, -1
parallel_sum__mha_block__mixer_token_mlp__prompt_kernel_attA:
    s_mov_b32 s52, 0
    s_mov_b32 s48, 0
    s_mov_b32 s49, 20480
    s_mov_b32 s50, 141760
    s_mov_b32 s51, 141788
    s_branch parallel_sum__mha_block__mixer_token_mlp__prompt_kernel_a_in
parallel_sum__mha_block__mixer_token_mlp__prompt_kernel_attB:
    s_mov_b32 s52, 1
    s_mov_b32 s48, 10240
    s_mov_b32 s49, 102400
    s_mov_b32 s50, 141768
    s_mov_b32 s51, 141792
    s_add_u32 s2, s2, 256
parallel_sum__mha_block__mixer_token_mlp__prompt_kernel_a_in:
    s_mov_b32 s8, s36
    s_and_b32 s9, s37, 0xffff
    s_mov_b32 s10, 24117248
    s_mov_b32 s11, 0x00020000
    v_lshlrev_b32 v4, 4, v1
    v_lshlrev_b32 v5, 3, v1
    s_and_b32 s21, s2, 7
    s_lshl_b32 s21, s21, 2
    s_bfe_u32 s24, s2, 0x20003
    s_add_u32 s21, s21, s24
    s_lshr_b32 s22, s2, 5
    s_mov_b32 s30, 0x000fffff
    s_mov_b32 s31, 0x000fffff
    s_mov_b32 s32, -1
    s_mov_b32 s33, 0
    s_mov_b32 s34, 0
    s_mov_b32 s35, -1
    s_lshl_b32 s24, s21, 6
    s_lshl_b32 s25, s22, 2
    s_add_u32 s25, s25, s24
    s_mul_i32 s28, s25, 1280
    s_mul_i32 s40, s24, 2560
    s_add_u32 s40, s40, 2621440
    s_mul_i32 s24, s20, 40960
    s_add_u32 s23, s40, s24
    s_mul_i32 s24, s22, 2560
    s_add_u32 s27, s40, s24
    s_mul_i32 s38, s20, 20480
    s_cmp_eq_u32 s20, 3
    s_cselect_b32 s38, 143360, s38
    s_mov_b32 s37, s22
    s_mov_b32 s39, 0
    s_lshl_b32 s37, s22, 1
    s_lshl_b32 s39, s52, 4
    s_lshl_b32 s24, s20, 2
    s_lshl_b32 s25, s52, 4
    s_add_u32 s24, s24, 140416
    s_add_u32 s56, s24, s25
    s_xor_b32 s25, s25, 16
    s_add_u32 s57, s24, s25
    s_mov_b32 s53, 2
    s_add_u32 s41, s52, 16
    s_mov_b32 s55, 0
    v_mov_b32 v28, 0
    v_mov_b32 v29, 0
    v_mov_b32 v30, 0
    v_mov_b32 v31, 0
    v_mov_b32 v32, 0
    v_mov_b32 v33, 0
    v_mov_b32 v34, 0
    v_mov_b32 v35, 0
    v_mov_b32 v158, 0x3f803f80
    v_mov_b32 v159, 0x3f80
    v_lshrrev_b32 v3, 5, v1
    v_mul_u32_u24 v6, 320, v3
    v_lshl_add_u32 v6, v2, 4, v6
    v_add_u32 v164, s38, v4
    v_add_u32 v164, s48, v164
    v_add_u32 v165, s38, v5
    v_add_u32 v166, s38, v6
    v_cmp_eq_u32 vcc, 20, v2
    v_mov_b32 v7, 0x3f803f80
    v_mov_b32 v144, 0x3f803f80
    v_mov_b32 v145, 0x3f80
    v_cndmask_b32 v136, 0, v7, vcc
    v_cndmask_b32 v137, 0, v7, vcc
    v_cndmask_b32 v138, 0, v7, vcc
    v_cndmask_b32 v139, 0, v7, vcc
    v_cndmask_b32 v140, 0, v7, vcc
    v_cndmask_b32 v141, 0, v7, vcc
    v_cndmask_b32 v142, 0, v7, vcc
    v_cndmask_b32 v143, 0, v7, vcc
    v_cndmask_b32 v150, 0, v7, vcc
    v_cndmask_b32 v151, 0, v7, vcc
    v_cndmask_b32 v152, 0, v7, vcc
    v_cndmask_b32 v153, 0, v7, vcc
    v_cndmask_b32 v154, 0, v7, vcc
    v_cndmask_b32 v155, 0, v7, vcc
    v_cndmask_b32 v156, 0, v7, vcc
    v_cndmask_b32 v157, 0, v7, vcc
    v_mov_b32 v124, 0
    v_mov_b32 v125, 0
    v_mov_b32 v126, 0
    v_mov_b32 v127, 0
    v_mov_b32 v128, 0
    v_mov_b32 v129, 0
    v_mov_b32 v130, 0
    v_mov_b32 v131, 0
    v_mov_b32 v167, 0xdddddddd
    s_lshr_b32 s24, s2, 8
    s_mul_i32 s44, s24, 5120
    s_add_u32 s44, s44, 131072
    s_mul_i32 s45, s24, 1280
    s_add_u32 s45, s45, 61440
    s_xor_b32 s24, s20, 0
    s_mul_i32 s24, s24, 1280
    s_add_u32 s24, s24, s44
    v_add_u32 v100, s24, v5
    s_xor_b32 s24, s20, 1
    s_mul_i32 s24, s24, 1280
    s_add_u32 s24, s24, s44
    v_add_u32 v101, s24, v5
    s_xor_b32 s24, s20, 2
    s_mul_i32 s24, s24, 1280
    s_add_u32 s24, s24, s44
    v_add_u32 v102, s24, v5
    s_xor_b32 s24, s20, 3
    s_mul_i32 s24, s24, 1280
    s_add_u32 s24, s24, s44
    v_add_u32 v103, s24, v5
    v_add_u32 v104, s45, v5
    s_lshr_b32 s24, s2, 8
    s_cmp_lg_u32 s24, 1
    s_cbranch_scc1 parallel_sum__mha_block__mixer_token_mlp__prompt_kernel_a_np
    s_cmp_lg_u32 s20, 0
    s_cbranch_scc1 parallel_sum__mha_block__mixer_token_mlp__prompt_kernel_a_np
    s_mov_b64 exec, 1
    v_mov_b32 v7, 141780
    s_mov_b32 s61, 1048576
Lw4:
    ds_read_b32 v8, v7
    s_waitcnt lgkmcnt(0)
    v_readfirstlane_b32 s59, v8
    s_nop 0
    s_cmp_ge_u32 s59, s58
    s_cbranch_scc1 Lw4x
    s_sleep 1
    s_sub_u32 s61, s61, 1
    s_cmp_lg_u32 s61, 0
    s_cbranch_scc1 Lw4
Lw4x:
    s_mov_b64 exec, -1
    s_mul_i32 s24, s21, 20
    v_bfe_u32 v7, v1, 4, 1
    v_mul_u32_u24 v7, 19, v7
    v_add_u32 v7, s24, v7
    v_lshrrev_b32 v9, 7, v7
    v_mul_u32_u24 v7, 5, v3
    v_add3_u32 v7, v7, v9, 5
    v_and_b32 v8, 15, v1
    v_lshl_add_u32 v7, v8, 4, v7
    v_lshlrev_b32 v7, 7, v7
    s_mov_b32 s24, 21757952
    v_lshlrev_b32 v8, 3, v3
    v_sub_u32 v8, s22, v8
    v_lshl_add_u32 v9, v8, 4, v9
    v_lshlrev_b32 v9, 7, v9
    s_mov_b32 exec_lo, 0xffffffff
    s_mov_b32 exec_hi, 0xffffffff
    s_mov_b32 s61, 262144
Lg5:
    buffer_load_dword v8, v7, s[8:11], s24 offen sc1
    buffer_load_dword v10, v9, s[8:11], s24 offen sc1
    s_waitcnt vmcnt(0)
    v_min_u32 v8, v8, v10
    v_cmp_gt_u32 vcc, 1, v8
    s_nop 4
    s_cbranch_vccz Lg5x
    s_sleep 2
    s_sub_u32 s61, s61, 1
    s_cmp_lg_u32 s61, 0
    s_cbranch_scc1 Lg5
Lg5x:
    s_mov_b64 exec, -1
    s_mov_b64 exec, 1
    v_mov_b32 v7, 141772
    v_mov_b32 v8, 1
    ds_add_u32 v7, v8
    s_mov_b64 exec, -1
parallel_sum__mha_block__mixer_token_mlp__prompt_kernel_a_np:
    s_mov_b64 exec, 1
    v_mov_b32 v7, 141772
    s_mov_b32 s61, 1048576
Lw6:
    ds_read_b32 v8, v7
    s_waitcnt lgkmcnt(0)
    v_readfirstlane_b32 s59, v8
    s_nop 0
    s_cmp_ge_u32 s59, 1
    s_cbranch_scc1 Lw6x
    s_sleep 1
    s_sub_u32 s61, s61, 1
    s_cmp_lg_u32 s61, 0
    s_cbranch_scc1 Lw6
Lw6x:
    s_mov_b64 exec, -1
    s_setprio 3
    buffer_load_dwordx2 v[146:147], v5, s[8:11], s27 offen sc1
    buffer_load_dwordx2 v[148:149], v5, s[8:11], s27 offen offset:512 sc1
    s_mov_b64 exec, s[32:33]
    buffer_load_dwordx2 v[158:159], v5, s[8:11], s27 offen offset:1024 sc1
    s_mov_b64 exec, -1
    s_xor_b32 s44, s20, 0
    s_mul_i32 s44, s44, 1280
    s_add_u32 s44, s44, s28
    buffer_load_dwordx2 v[12:13], v5, s[8:11], s44 offen sc1
    buffer_load_dwordx2 v[14:15], v5, s[8:11], s44 offen offset:512 sc1
    s_xor_b32 s45, s20, 1
    s_mul_i32 s45, s45, 1280
    s_add_u32 s45, s45, s28
    buffer_load_dwordx2 v[16:17], v5, s[8:11], s45 offen sc1
    buffer_load_dwordx2 v[18:19], v5, s[8:11], s45 offen offset:512 sc1
    s_xor_b32 s46, s20, 2
    s_mul_i32 s46, s46, 1280
    s_add_u32 s46, s46, s28
    buffer_load_dwordx2 v[20:21], v5, s[8:11], s46 offen sc1
    buffer_load_dwordx2 v[22:23], v5, s[8:11], s46 offen offset:512 sc1
    s_xor_b32 s47, s20, 3
    s_mul_i32 s47, s47, 1280
    s_add_u32 s47, s47, s28
    buffer_load_dwordx2 v[24:25], v5, s[8:11], s47 offen sc1
    buffer_load_dwordx2 v[26:27], v5, s[8:11], s47 offen offset:512 sc1
    s_mov_b64 exec, s[32:33]
    buffer_load_dwordx2 v[28:29], v5, s[8:11], s44 offen offset:1024 sc1
    buffer_load_dwordx2 v[30:31], v5, s[8:11], s45 offen offset:1024 sc1
    buffer_load_dwordx2 v[32:33], v5, s[8:11], s46 offen offset:1024 sc1
    buffer_load_dwordx2 v[34:35], v5, s[8:11], s47 offen offset:1024 sc1
    s_mov_b64 exec, -1
    s_cmp_eq_u32 s52, 0
    s_cbranch_scc1 parallel_sum__mha_block__mixer_token_mlp__prompt_kernel_a_fa
    s_mov_b64 exec, 1
    v_mov_b32 v7, 141800
    v_mov_b32 v8, 1
    ds_add_u32 v7, v8
    s_mov_b64 exec, -1
    s_waitcnt vmcnt(0)
    s_branch parallel_sum__mha_block__mixer_token_mlp__prompt_kernel_a_fb
parallel_sum__mha_block__mixer_token_mlp__prompt_kernel_a_fa:
    s_mul_i32 s36, s37, 2560
    s_add_u32 s36, s36, s23
    s_add_u32 m0, s38, 0
    s_add_u32 s37, s37, 1
    buffer_load_dwordx4 v4, s[8:11], s36 offen sc1 lds
    buffer_load_dwordx4 v4, s[8:11], s36 offen offset:1024 sc1 lds
    s_mov_b64 exec, s[32:33]
    buffer_load_dwordx4 v4, s[8:11], s36 offen offset:2048 sc1 lds
    s_mov_b64 exec, -1
    s_and_b32 s37, s37, 15
    s_add_u32 s39, s39, 1
    s_mul_i32 s36, s37, 2560
    s_add_u32 s36, s36, s23
    s_add_u32 m0, s38, 2560
    s_add_u32 s37, s37, 1
    buffer_load_dwordx4 v4, s[8:11], s36 offen sc1 lds
    buffer_load_dwordx4 v4, s[8:11], s36 offen offset:1024 sc1 lds
    s_mov_b64 exec, s[32:33]
    buffer_load_dwordx4 v4, s[8:11], s36 offen offset:2048 sc1 lds
    s_mov_b64 exec, -1
    s_and_b32 s37, s37, 15
    s_add_u32 s39, s39, 1
    s_mul_i32 s36, s37, 2560
    s_add_u32 s36, s36, s23
    s_add_u32 m0, s38, 5120
    s_add_u32 s37, s37, 1
    buffer_load_dwordx4 v4, s[8:11], s36 offen sc1 lds
    buffer_load_dwordx4 v4, s[8:11], s36 offen offset:1024 sc1 lds
    s_mov_b64 exec, s[32:33]
    buffer_load_dwordx4 v4, s[8:11], s36 offen offset:2048 sc1 lds
    s_mov_b64 exec, -1
    s_and_b32 s37, s37, 15
    s_add_u32 s39, s39, 1
    s_mul_i32 s36, s37, 2560
    s_add_u32 s36, s36, s23
    s_add_u32 m0, s38, 7680
    s_add_u32 s37, s37, 1
    buffer_load_dwordx4 v4, s[8:11], s36 offen sc1 lds
    buffer_load_dwordx4 v4, s[8:11], s36 offen offset:1024 sc1 lds
    s_mov_b64 exec, s[32:33]
    buffer_load_dwordx4 v4, s[8:11], s36 offen offset:2048 sc1 lds
    s_mov_b64 exec, -1
    s_and_b32 s37, s37, 15
    s_add_u32 s39, s39, 1
    s_mov_b64 exec, 1
    v_mov_b32 v7, 141800
    v_mov_b32 v8, 1
    ds_add_u32 v7, v8
    s_mov_b64 exec, -1
    s_waitcnt vmcnt(12)
parallel_sum__mha_block__mixer_token_mlp__prompt_kernel_a_fb:
    v_mfma_f32_32x32x16_bf16 v[36:51], v[146:149], v[12:15], 0
    v_mfma_f32_32x32x16_bf16 v[52:67], v[146:149], v[16:19], 0
    v_mfma_f32_32x32x16_bf16 v[68:83], v[146:149], v[20:23], 0
    v_mfma_f32_32x32x16_bf16 v[84:99], v[146:149], v[24:27], 0
    v_mfma_f32_32x32x8bf16_1k v[36:51], v[158:159], v[28:29], v[36:51]
    v_mfma_f32_32x32x8bf16_1k v[52:67], v[158:159], v[30:31], v[52:67]
    v_mfma_f32_32x32x8bf16_1k v[68:83], v[158:159], v[32:33], v[68:83]
    v_mfma_f32_32x32x8bf16_1k v[84:99], v[158:159], v[34:35], v[84:99]
    s_cmp_eq_u32 s52, 0
    s_cbranch_scc1 parallel_sum__mha_block__mixer_token_mlp__prompt_kernel_a_ga
    s_mov_b64 exec, 1
    v_mov_b32 v7, s57
    s_mov_b32 s61, 1048576
Lw7:
    ds_read_b32 v8, v7
    s_waitcnt lgkmcnt(0)
    v_readfirstlane_b32 s59, v8
    s_nop 0
    s_cmp_ge_u32 s59, 1
    s_cbranch_scc1 Lw7x
    s_sleep 1
    s_sub_u32 s61, s61, 1
    s_cmp_lg_u32 s61, 0
    s_cbranch_scc1 Lw7
Lw7x:
    s_mov_b64 exec, -1
    s_branch parallel_sum__mha_block__mixer_token_mlp__prompt_kernel_a_gb
parallel_sum__mha_block__mixer_token_mlp__prompt_kernel_a_ga:
    s_waitcnt vmcnt(9)
    s_mov_b64 exec, 1
    v_mov_b32 v8, 1
    v_mov_b32 v7, s56
    ds_write_b32 v7, v8
    s_mov_b64 exec, -1
parallel_sum__mha_block__mixer_token_mlp__prompt_kernel_a_gb:
    ds_read2st64_b64 v[132:135], v165 offset0:0 offset1:1
    s_mov_b64 exec, s[32:33]
    ds_read_b64 v[144:145], v165 offset:1024
    s_mov_b64 exec, s[30:31]
    ds_read_b128 v[136:139], v166 offset:1280
    ds_read_b128 v[140:143], v166 offset:1920
    s_mov_b64 exec, -1
    v_max3_f32 v160, v36, v37, v38
    v_max3_f32 v160, v160, v39, v40
    v_max3_f32 v160, v160, v41, v42
    v_max3_f32 v160, v160, v43, v44
    v_max3_f32 v160, v160, v45, v46
    v_max3_f32 v160, v160, v47, v48
    v_max3_f32 v160, v160, v49, v50
    v_max_f32 v160, v160, v51
    v_max3_f32 v161, v52, v53, v54
    v_max3_f32 v161, v161, v55, v56
    v_max3_f32 v161, v161, v57, v58
    v_max3_f32 v161, v161, v59, v60
    v_max3_f32 v161, v161, v61, v62
    v_max3_f32 v161, v161, v63, v64
    v_max3_f32 v161, v161, v65, v66
    v_max_f32 v161, v161, v67
    v_max3_f32 v162, v68, v69, v70
    v_max3_f32 v162, v162, v71, v72
    v_max3_f32 v162, v162, v73, v74
    v_max3_f32 v162, v162, v75, v76
    v_max3_f32 v162, v162, v77, v78
    v_max3_f32 v162, v162, v79, v80
    v_max3_f32 v162, v162, v81, v82
    v_max_f32 v162, v162, v83
    v_max3_f32 v163, v84, v85, v86
    v_max3_f32 v163, v163, v87, v88
    v_max3_f32 v163, v163, v89, v90
    v_max3_f32 v163, v163, v91, v92
    v_max3_f32 v163, v163, v93, v94
    v_max3_f32 v163, v163, v95, v96
    v_max3_f32 v163, v163, v97, v98
    v_max_f32 v163, v163, v99
    v_mov_b32 v100, v160
    v_mov_b32 v101, v161
    v_mov_b32 v102, v162
    v_mov_b32 v103, v163
    v_permlane32_swap_b32 v160, v100
    v_permlane32_swap_b32 v161, v101
    v_permlane32_swap_b32 v162, v102
    v_permlane32_swap_b32 v163, v103
    s_mov_b64 exec, s[34:35]
    v_max_f32 v160, v160, v100
    v_sub_f32 v7, 0, v160
    v_cvt_pk_bf16_f32 v8, v7, v7
    v_and_b32 v9, 0xffff0000, v8
    v_sub_f32 v7, v7, v9
    v_cvt_pk_bf16_f32 v28, v9, v7
    v_and_b32 v9, 0xffff0000, v28
    v_sub_f32 v7, v7, v9
    v_cvt_pk_bf16_f32 v29, v7, 0
    v_max_f32 v161, v161, v101
    v_sub_f32 v7, 0, v161
    v_cvt_pk_bf16_f32 v8, v7, v7
    v_and_b32 v9, 0xffff0000, v8
    v_sub_f32 v7, v7, v9
    v_cvt_pk_bf16_f32 v30, v9, v7
    v_and_b32 v9, 0xffff0000, v30
    v_sub_f32 v7, v7, v9
    v_cvt_pk_bf16_f32 v31, v7, 0
    v_max_f32 v162, v162, v102
    v_sub_f32 v7, 0, v162
    v_cvt_pk_bf16_f32 v8, v7, v7
    v_and_b32 v9, 0xffff0000, v8
    v_sub_f32 v7, v7, v9
    v_cvt_pk_bf16_f32 v32, v9, v7
    v_and_b32 v9, 0xffff0000, v32
    v_sub_f32 v7, v7, v9
    v_cvt_pk_bf16_f32 v33, v7, 0
    v_max_f32 v163, v163, v103
    v_sub_f32 v7, 0, v163
    v_cvt_pk_bf16_f32 v8, v7, v7
    v_and_b32 v9, 0xffff0000, v8
    v_sub_f32 v7, v7, v9
    v_cvt_pk_bf16_f32 v34, v9, v7
    v_and_b32 v9, 0xffff0000, v34
    v_sub_f32 v7, v7, v9
    v_cvt_pk_bf16_f32 v35, v7, 0
    s_mov_b64 exec, -1
    s_waitcnt lgkmcnt(0)
    v_mfma_f32_32x32x16_bf16 v[100:115], v[132:135], v[12:15], 0
    v_mfma_f32_32x32x8bf16_1k v[100:115], v[144:145], v[28:29], v[100:115]
    v_mov_b32 v161, s57
    v_mov_b32 v160, s56
    v_mov_b32 v162, 1
    s_cmp_eq_u32 s52, 0
    s_cbranch_scc1 parallel_sum__mha_block__mixer_token_mlp__prompt_kernel_a_ha
    s_mov_b64 exec, 1
    v_mov_b32 v8, 1
    v_mov_b32 v7, s56
    ds_write_b32 v7, v8
    s_mov_b64 exec, -1
    s_nop 3
    s_branch parallel_sum__mha_block__mixer_token_mlp__prompt_kernel_a_hb
parallel_sum__mha_block__mixer_token_mlp__prompt_kernel_a_ha:
    s_mul_i32 s36, s37, 2560
    s_add_u32 s36, s36, s23
    s_add_u32 m0, s38, 10240
    s_add_u32 s37, s37, 1
    buffer_load_dwordx4 v4, s[8:11], s36 offen sc1 lds
    buffer_load_dwordx4 v4, s[8:11], s36 offen offset:1024 sc1 lds
    s_mov_b64 exec, s[32:33]
    buffer_load_dwordx4 v4, s[8:11], s36 offen offset:2048 sc1 lds
    s_mov_b64 exec, -1
    s_and_b32 s37, s37, 15
    s_add_u32 s39, s39, 1
    s_mul_i32 s36, s37, 2560
    s_add_u32 s36, s36, s23
    s_add_u32 m0, s38, 12800
    s_add_u32 s37, s37, 1
    buffer_load_dwordx4 v4, s[8:11], s36 offen sc1 lds
    buffer_load_dwordx4 v4, s[8:11], s36 offen offset:1024 sc1 lds
    s_mov_b64 exec, s[32:33]
    buffer_load_dwordx4 v4, s[8:11], s36 offen offset:2048 sc1 lds
    s_mov_b64 exec, -1
    s_and_b32 s37, s37, 15
    s_add_u32 s39, s39, 1
    s_mul_i32 s36, s37, 2560
    s_add_u32 s36, s36, s23
    s_add_u32 m0, s38, 15360
    s_add_u32 s37, s37, 1
    buffer_load_dwordx4 v4, s[8:11], s36 offen sc1 lds
    buffer_load_dwordx4 v4, s[8:11], s36 offen offset:1024 sc1 lds
    s_mov_b64 exec, s[32:33]
    buffer_load_dwordx4 v4, s[8:11], s36 offen offset:2048 sc1 lds
    s_mov_b64 exec, -1
    s_and_b32 s37, s37, 15
    s_add_u32 s39, s39, 1
parallel_sum__mha_block__mixer_token_mlp__prompt_kernel_a_hb:
    v_mfma_f32_32x32x8bf16_1k v[36:51], v[124:125], v[124:125], 0
    v_mfma_f32_32x32x8bf16_1k v[52:67], v[124:125], v[124:125], 0
    v_mfma_f32_32x32x8bf16_1k v[68:83], v[124:125], v[124:125], 0
    v_mfma_f32_32x32x8bf16_1k v[84:99], v[124:125], v[124:125], 0
    s_mov_b32 s26, 2
    s_setprio 3
.p2align 6
parallel_sum__mha_block__mixer_token_mlp__prompt_kernel_a_loop:
    v_exp_f32 v100, v100
    v_exp_f32 v101, v101
    v_smfmac_f32_32x32x32_bf16 v[84:99], v[154:157], v[124:131], v167
    v_exp_f32 v102, v102
    v_exp_f32 v103, v103
    v_exp_f32 v104, v104
    v_mfma_f32_32x32x16_bf16 v[116:131], v[132:135], v[16:19], 0
    v_exp_f32 v105, v105
    v_exp_f32 v106, v106
    v_exp_f32 v107, v107
    v_exp_f32 v108, v108
    v_mfma_f32_32x32x8bf16_1k v[116:131], v[144:145], v[30:31], v[116:131]
    v_exp_f32 v109, v109
    v_exp_f32 v110, v110
    v_exp_f32 v111, v111
    v_exp_f32 v112, v112
    v_smfmac_f32_32x32x32_bf16 v[36:51], v[136:139], v[100:107], v167
    v_exp_f32 v113, v113
    v_exp_f32 v114, v114
    v_exp_f32 v115, v115
    s_nop 3
    v_exp_f32 v116, v116
    v_exp_f32 v117, v117
    v_smfmac_f32_32x32x32_bf16 v[36:51], v[140:143], v[108:115], v167
    v_exp_f32 v118, v118
    v_exp_f32 v119, v119
    v_exp_f32 v120, v120
    v_mfma_f32_32x32x16_bf16 v[100:115], v[132:135], v[20:23], 0
    v_exp_f32 v121, v121
    v_exp_f32 v122, v122
    v_exp_f32 v123, v123
    v_exp_f32 v124, v124
    v_mfma_f32_32x32x8bf16_1k v[100:115], v[144:145], v[32:33], v[100:115]
    s_cmp_eq_u32 s52, 1
    s_cbranch_scc1 parallel_sum__mha_block__mixer_token_mlp__prompt_kernel_a_s0b
    s_waitcnt vmcnt(9)
    s_mov_b64 exec, 1
    ds_add_u32 v160, v162
    s_mov_b64 exec, -1
    s_branch parallel_sum__mha_block__mixer_token_mlp__prompt_kernel_a_s0r
parallel_sum__mha_block__mixer_token_mlp__prompt_kernel_a_s0b:
    s_sub_u32 s24, s53, 2
    s_max_u32 s24, s24, 2
    s_min_u32 s24, s24, 14
    s_cmp_ge_u32 s55, s24
    s_cbranch_scc1 parallel_sum__mha_block__mixer_token_mlp__prompt_kernel_a_s0r
    s_mov_b64 exec, 1
    v_mov_b32 v7, s57
    s_mov_b32 s61, 1048576
Lw8:
    ds_read_b32 v8, v7
    s_waitcnt lgkmcnt(0)
    v_readfirstlane_b32 s59, v8
    s_nop 0
    s_cmp_ge_u32 s59, s24
    s_cbranch_scc1 Lw8x
    s_sleep 1
    s_sub_u32 s61, s61, 1
    s_cmp_lg_u32 s61, 0
    s_cbranch_scc1 Lw8
Lw8x:
    s_mov_b64 exec, -1
parallel_sum__mha_block__mixer_token_mlp__prompt_kernel_a_s0r:
    ds_read2st64_b64 v[146:149], v165 offset0:5 offset1:6
    s_mov_b64 exec, s[32:33]
    ds_read_b64 v[158:159], v165 offset:3584
    s_mov_b64 exec, s[30:31]
    ds_read_b128 v[150:153], v166 offset:3840
    ds_read_b128 v[154:157], v166 offset:4480
    ds_read_b32 v163, v161
    s_mov_b64 exec, -1
    v_exp_f32 v125, v125
    v_exp_f32 v126, v126
    v_exp_f32 v127, v127
    v_exp_f32 v128, v128
    v_smfmac_f32_32x32x32_bf16 v[52:67], v[136:139], v[116:123], v167
    v_exp_f32 v129, v129
    v_exp_f32 v130, v130
    v_exp_f32 v131, v131
    v_exp_f32 v100, v100
    v_exp_f32 v101, v101
    v_smfmac_f32_32x32x32_bf16 v[52:67], v[140:143], v[124:131], v167
    v_exp_f32 v102, v102
    v_exp_f32 v103, v103
    v_exp_f32 v104, v104
    v_mfma_f32_32x32x16_bf16 v[116:131], v[132:135], v[24:27], 0
    v_exp_f32 v105, v105
    v_exp_f32 v106, v106
    v_exp_f32 v107, v107
    v_exp_f32 v108, v108
    v_mfma_f32_32x32x8bf16_1k v[116:131], v[144:145], v[34:35], v[116:131]
    v_exp_f32 v109, v109
    v_exp_f32 v110, v110
    v_exp_f32 v111, v111
    v_exp_f32 v112, v112
    v_smfmac_f32_32x32x32_bf16 v[68:83], v[136:139], v[100:107], v167
    v_exp_f32 v113, v113
    v_exp_f32 v114, v114
    v_exp_f32 v115, v115
    s_nop 3
    v_exp_f32 v116, v116
    v_exp_f32 v117, v117
    v_smfmac_f32_32x32x32_bf16 v[68:83], v[140:143], v[108:115], v167
    v_exp_f32 v118, v118
    v_exp_f32 v119, v119
    v_exp_f32 v120, v120
    s_waitcnt lgkmcnt(0)
    v_mfma_f32_32x32x16_bf16 v[100:115], v[146:149], v[12:15], 0
    v_exp_f32 v121, v121
    v_exp_f32 v122, v122
    v_exp_f32 v123, v123
    v_exp_f32 v124, v124
    v_mfma_f32_32x32x8bf16_1k v[100:115], v[158:159], v[28:29], v[100:115]
    v_readfirstlane_b32 s55, v163
    s_sub_u32 s24, s53, 2
    s_cmp_eq_u32 s52, 0
    s_cbranch_scc1 parallel_sum__mha_block__mixer_token_mlp__prompt_kernel_a_s0a
    s_mov_b64 exec, 1
    ds_add_u32 v160, v162
    s_mov_b64 exec, -1
    s_branch parallel_sum__mha_block__mixer_token_mlp__prompt_kernel_a_s0p
parallel_sum__mha_block__mixer_token_mlp__prompt_kernel_a_s0a:
    s_cmp_ge_u32 s39, 16
    s_cbranch_scc1 parallel_sum__mha_block__mixer_token_mlp__prompt_kernel_a_s0p
    s_cmp_ge_u32 s55, s24
    s_cbranch_scc1 parallel_sum__mha_block__mixer_token_mlp__prompt_kernel_a_s0d
    s_mov_b64 exec, 1
    v_mov_b32 v7, s57
    s_mov_b32 s61, 1048576
Lw9:
    ds_read_b32 v8, v7
    s_waitcnt lgkmcnt(0)
    v_readfirstlane_b32 s59, v8
    s_nop 0
    s_cmp_ge_u32 s59, s24
    s_cbranch_scc1 Lw9x
    s_sleep 1
    s_sub_u32 s61, s61, 1
    s_cmp_lg_u32 s61, 0
    s_cbranch_scc1 Lw9
Lw9x:
    s_mov_b64 exec, -1
parallel_sum__mha_block__mixer_token_mlp__prompt_kernel_a_s0d:
    s_mul_i32 s36, s37, 2560
    s_add_u32 s36, s36, s23
    s_add_u32 m0, s38, 17920
    s_add_u32 s37, s37, 1
    buffer_load_dwordx4 v4, s[8:11], s36 offen sc1 lds
    buffer_load_dwordx4 v4, s[8:11], s36 offen offset:1024 sc1 lds
    s_mov_b64 exec, s[32:33]
    buffer_load_dwordx4 v4, s[8:11], s36 offen offset:2048 sc1 lds
    s_mov_b64 exec, -1
    s_and_b32 s37, s37, 15
    s_add_u32 s39, s39, 1
parallel_sum__mha_block__mixer_token_mlp__prompt_kernel_a_s0p:
    s_cmp_eq_u32 s26, 1
    s_cbranch_scc1 parallel_sum__mha_block__mixer_token_mlp__prompt_kernel_a_s0q
    s_cmp_ge_u32 s55, s53
    s_setprio 3
    s_cbranch_scc1 parallel_sum__mha_block__mixer_token_mlp__prompt_kernel_a_s0e
    s_setprio 2
    s_branch parallel_sum__mha_block__mixer_token_mlp__prompt_kernel_a_s0e
parallel_sum__mha_block__mixer_token_mlp__prompt_kernel_a_s0q:
    s_cmp_ge_u32 s55, s53
    s_setprio 2
    s_cbranch_scc1 parallel_sum__mha_block__mixer_token_mlp__prompt_kernel_a_s0e
    s_setprio 0
parallel_sum__mha_block__mixer_token_mlp__prompt_kernel_a_s0e:
    s_add_u32 s53, s53, 1
    v_exp_f32 v125, v125
    v_exp_f32 v126, v126
    v_exp_f32 v127, v127
    v_exp_f32 v128, v128
    v_smfmac_f32_32x32x32_bf16 v[84:99], v[136:139], v[116:123], v167
    v_exp_f32 v129, v129
    v_exp_f32 v130, v130
    v_exp_f32 v131, v131
    v_exp_f32 v100, v100
    v_exp_f32 v101, v101
    v_smfmac_f32_32x32x32_bf16 v[84:99], v[140:143], v[124:131], v167
    v_exp_f32 v102, v102
    v_exp_f32 v103, v103
    v_exp_f32 v104, v104
    v_mfma_f32_32x32x16_bf16 v[116:131], v[146:149], v[16:19], 0
    v_exp_f32 v105, v105
    v_exp_f32 v106, v106
    v_exp_f32 v107, v107
    v_exp_f32 v108, v108
    v_mfma_f32_32x32x8bf16_1k v[116:131], v[158:159], v[30:31], v[116:131]
    v_exp_f32 v109, v109
    v_exp_f32 v110, v110
    v_exp_f32 v111, v111
    v_exp_f32 v112, v112
    v_smfmac_f32_32x32x32_bf16 v[36:51], v[150:153], v[100:107], v167
    v_exp_f32 v113, v113
    v_exp_f32 v114, v114
    v_exp_f32 v115, v115
    s_nop 3
    v_exp_f32 v116, v116
    v_exp_f32 v117, v117
    v_smfmac_f32_32x32x32_bf16 v[36:51], v[154:157], v[108:115], v167
    v_exp_f32 v118, v118
    v_exp_f32 v119, v119
    v_exp_f32 v120, v120
    v_mfma_f32_32x32x16_bf16 v[100:115], v[146:149], v[20:23], 0
    v_exp_f32 v121, v121
    v_exp_f32 v122, v122
    v_exp_f32 v123, v123
    v_exp_f32 v124, v124
    v_mfma_f32_32x32x8bf16_1k v[100:115], v[158:159], v[32:33], v[100:115]
    s_cmp_eq_u32 s52, 1
    s_cbranch_scc1 parallel_sum__mha_block__mixer_token_mlp__prompt_kernel_a_s1b
    s_waitcnt vmcnt(9)
    s_mov_b64 exec, 1
    ds_add_u32 v160, v162
    s_mov_b64 exec, -1
    s_branch parallel_sum__mha_block__mixer_token_mlp__prompt_kernel_a_s1r
parallel_sum__mha_block__mixer_token_mlp__prompt_kernel_a_s1b:
    s_sub_u32 s24, s53, 2
    s_max_u32 s24, s24, 2
    s_min_u32 s24, s24, 14
    s_cmp_ge_u32 s55, s24
    s_cbranch_scc1 parallel_sum__mha_block__mixer_token_mlp__prompt_kernel_a_s1r
    s_mov_b64 exec, 1
    v_mov_b32 v7, s57
    s_mov_b32 s61, 1048576
Lw10:
    ds_read_b32 v8, v7
    s_waitcnt lgkmcnt(0)
    v_readfirstlane_b32 s59, v8
    s_nop 0
    s_cmp_ge_u32 s59, s24
    s_cbranch_scc1 Lw10x
    s_sleep 1
    s_sub_u32 s61, s61, 1
    s_cmp_lg_u32 s61, 0
    s_cbranch_scc1 Lw10
Lw10x:
    s_mov_b64 exec, -1
parallel_sum__mha_block__mixer_token_mlp__prompt_kernel_a_s1r:
    ds_read2st64_b64 v[132:135], v165 offset0:10 offset1:11
    s_mov_b64 exec, s[32:33]
    ds_read_b64 v[144:145], v165 offset:6144
    s_mov_b64 exec, s[30:31]
    ds_read_b128 v[136:139], v166 offset:6400
    ds_read_b128 v[140:143], v166 offset:7040
    ds_read_b32 v163, v161
    s_mov_b64 exec, -1
    v_exp_f32 v125, v125
    v_exp_f32 v126, v126
    v_exp_f32 v127, v127
    v_exp_f32 v128, v128
    v_smfmac_f32_32x32x32_bf16 v[52:67], v[150:153], v[116:123], v167
    v_exp_f32 v129, v129
    v_exp_f32 v130, v130
    v_exp_f32 v131, v131
    v_exp_f32 v100, v100
    v_exp_f32 v101, v101
    v_smfmac_f32_32x32x32_bf16 v[52:67], v[154:157], v[124:131], v167
    v_exp_f32 v102, v102
    v_exp_f32 v103, v103
    v_exp_f32 v104, v104
    v_mfma_f32_32x32x16_bf16 v[116:131], v[146:149], v[24:27], 0
    v_exp_f32 v105, v105
    v_exp_f32 v106, v106
    v_exp_f32 v107, v107
    v_exp_f32 v108, v108
    v_mfma_f32_32x32x8bf16_1k v[116:131], v[158:159], v[34:35], v[116:131]
    v_exp_f32 v109, v109
    v_exp_f32 v110, v110
    v_exp_f32 v111, v111
    v_exp_f32 v112, v112
    v_smfmac_f32_32x32x32_bf16 v[68:83], v[150:153], v[100:107], v167
    v_exp_f32 v113, v113
    v_exp_f32 v114, v114
    v_exp_f32 v115, v115
    s_nop 3
    v_exp_f32 v116, v116
    v_exp_f32 v117, v117
    v_smfmac_f32_32x32x32_bf16 v[68:83], v[154:157], v[108:115], v167
    v_exp_f32 v118, v118
    v_exp_f32 v119, v119
    v_exp_f32 v120, v120
    s_waitcnt lgkmcnt(0)
    v_mfma_f32_32x32x16_bf16 v[100:115], v[132:135], v[12:15], 0
    v_exp_f32 v121, v121
    v_exp_f32 v122, v122
    v_exp_f32 v123, v123
    v_exp_f32 v124, v124
    v_mfma_f32_32x32x8bf16_1k v[100:115], v[144:145], v[28:29], v[100:115]
    v_readfirstlane_b32 s55, v163
    s_sub_u32 s24, s53, 2
    s_cmp_eq_u32 s52, 0
    s_cbranch_scc1 parallel_sum__mha_block__mixer_token_mlp__prompt_kernel_a_s1a
    s_mov_b64 exec, 1
    ds_add_u32 v160, v162
    s_mov_b64 exec, -1
    s_branch parallel_sum__mha_block__mixer_token_mlp__prompt_kernel_a_s1p
parallel_sum__mha_block__mixer_token_mlp__prompt_kernel_a_s1a:
    s_cmp_ge_u32 s39, 16
    s_cbranch_scc1 parallel_sum__mha_block__mixer_token_mlp__prompt_kernel_a_s1p
    s_cmp_ge_u32 s55, s24
    s_cbranch_scc1 parallel_sum__mha_block__mixer_token_mlp__prompt_kernel_a_s1d
    s_mov_b64 exec, 1
    v_mov_b32 v7, s57
    s_mov_b32 s61, 1048576
Lw11:
    ds_read_b32 v8, v7
    s_waitcnt lgkmcnt(0)
    v_readfirstlane_b32 s59, v8
    s_nop 0
    s_cmp_ge_u32 s59, s24
    s_cbranch_scc1 Lw11x
    s_sleep 1
    s_sub_u32 s61, s61, 1
    s_cmp_lg_u32 s61, 0
    s_cbranch_scc1 Lw11
Lw11x:
    s_mov_b64 exec, -1
parallel_sum__mha_block__mixer_token_mlp__prompt_kernel_a_s1d:
    s_mul_i32 s36, s37, 2560
    s_add_u32 s36, s36, s23
    s_add_u32 m0, s38, 0
    s_add_u32 s37, s37, 1
    buffer_load_dwordx4 v4, s[8:11], s36 offen sc1 lds
    buffer_load_dwordx4 v4, s[8:11], s36 offen offset:1024 sc1 lds
    s_mov_b64 exec, s[32:33]
    buffer_load_dwordx4 v4, s[8:11], s36 offen offset:2048 sc1 lds
    s_mov_b64 exec, -1
    s_and_b32 s37, s37, 15
    s_add_u32 s39, s39, 1
parallel_sum__mha_block__mixer_token_mlp__prompt_kernel_a_s1p:
    s_cmp_eq_u32 s26, 1
    s_cbranch_scc1 parallel_sum__mha_block__mixer_token_mlp__prompt_kernel_a_s1q
    s_cmp_ge_u32 s55, s53
    s_setprio 3
    s_cbranch_scc1 parallel_sum__mha_block__mixer_token_mlp__prompt_kernel_a_s1e
    s_setprio 2
    s_branch parallel_sum__mha_block__mixer_token_mlp__prompt_kernel_a_s1e
parallel_sum__mha_block__mixer_token_mlp__prompt_kernel_a_s1q:
    s_cmp_ge_u32 s55, s53
    s_setprio 2
    s_cbranch_scc1 parallel_sum__mha_block__mixer_token_mlp__prompt_kernel_a_s1e
    s_setprio 0
parallel_sum__mha_block__mixer_token_mlp__prompt_kernel_a_s1e:
    s_add_u32 s53, s53, 1
    v_exp_f32 v125, v125
    v_exp_f32 v126, v126
    v_exp_f32 v127, v127
    v_exp_f32 v128, v128
    v_smfmac_f32_32x32x32_bf16 v[84:99], v[150:153], v[116:123], v167
    v_exp_f32 v129, v129
    v_exp_f32 v130, v130
    v_exp_f32 v131, v131
    v_exp_f32 v100, v100
    v_exp_f32 v101, v101
    v_smfmac_f32_32x32x32_bf16 v[84:99], v[154:157], v[124:131], v167
    v_exp_f32 v102, v102
    v_exp_f32 v103, v103
    v_exp_f32 v104, v104
    v_mfma_f32_32x32x16_bf16 v[116:131], v[132:135], v[16:19], 0
    v_exp_f32 v105, v105
    v_exp_f32 v106, v106
    v_exp_f32 v107, v107
    v_exp_f32 v108, v108
    v_mfma_f32_32x32x8bf16_1k v[116:131], v[144:145], v[30:31], v[116:131]
    v_exp_f32 v109, v109
    v_exp_f32 v110, v110
    v_exp_f32 v111, v111
    v_exp_f32 v112, v112
    v_smfmac_f32_32x32x32_bf16 v[36:51], v[136:139], v[100:107], v167
    v_exp_f32 v113, v113
    v_exp_f32 v114, v114
    v_exp_f32 v115, v115
    s_nop 3
    v_exp_f32 v116, v116
    v_exp_f32 v117, v117
    v_smfmac_f32_32x32x32_bf16 v[36:51], v[140:143], v[108:115], v167
    v_exp_f32 v118, v118
    v_exp_f32 v119, v119
    v_exp_f32 v120, v120
    v_mfma_f32_32x32x16_bf16 v[100:115], v[132:135], v[20:23], 0
    v_exp_f32 v121, v121
    v_exp_f32 v122, v122
    v_exp_f32 v123, v123
    v_exp_f32 v124, v124
    v_mfma_f32_32x32x8bf16_1k v[100:115], v[144:145], v[32:33], v[100:115]
    s_cmp_eq_u32 s52, 1
    s_cbranch_scc1 parallel_sum__mha_block__mixer_token_mlp__prompt_kernel_a_s2b
    s_cmp_eq_u32 s26, 1
    s_cbranch_scc0 parallel_sum__mha_block__mixer_token_mlp__prompt_kernel_a_s2w
    s_waitcnt vmcnt(6)
parallel_sum__mha_block__mixer_token_mlp__prompt_kernel_a_s2w:
    s_waitcnt vmcnt(9)
    s_mov_b64 exec, 1
    ds_add_u32 v160, v162
    s_mov_b64 exec, -1
    s_branch parallel_sum__mha_block__mixer_token_mlp__prompt_kernel_a_s2r
parallel_sum__mha_block__mixer_token_mlp__prompt_kernel_a_s2b:
    s_sub_u32 s24, s53, 2
    s_max_u32 s24, s24, 2
    s_min_u32 s24, s24, 14
    s_cmp_ge_u32 s55, s24
    s_cbranch_scc1 parallel_sum__mha_block__mixer_token_mlp__prompt_kernel_a_s2r
    s_mov_b64 exec, 1
    v_mov_b32 v7, s57
    s_mov_b32 s61, 1048576
Lw12:
    ds_read_b32 v8, v7
    s_waitcnt lgkmcnt(0)
    v_readfirstlane_b32 s59, v8
    s_nop 0
    s_cmp_ge_u32 s59, s24
    s_cbranch_scc1 Lw12x
    s_sleep 1
    s_sub_u32 s61, s61, 1
    s_cmp_lg_u32 s61, 0
    s_cbranch_scc1 Lw12
Lw12x:
    s_mov_b64 exec, -1
parallel_sum__mha_block__mixer_token_mlp__prompt_kernel_a_s2r:
    ds_read2st64_b64 v[146:149], v165 offset0:15 offset1:16
    s_mov_b64 exec, s[32:33]
    ds_read_b64 v[158:159], v165 offset:8704
    s_mov_b64 exec, s[30:31]
    ds_read_b128 v[150:153], v166 offset:8960
    ds_read_b128 v[154:157], v166 offset:9600
    ds_read_b32 v163, v161
    s_mov_b64 exec, -1
    v_exp_f32 v125, v125
    v_exp_f32 v126, v126
    v_exp_f32 v127, v127
    v_exp_f32 v128, v128
    v_smfmac_f32_32x32x32_bf16 v[52:67], v[136:139], v[116:123], v167
    v_exp_f32 v129, v129
    v_exp_f32 v130, v130
    v_exp_f32 v131, v131
    v_exp_f32 v100, v100
    v_exp_f32 v101, v101
    v_smfmac_f32_32x32x32_bf16 v[52:67], v[140:143], v[124:131], v167
    v_exp_f32 v102, v102
    v_exp_f32 v103, v103
    v_exp_f32 v104, v104
    v_mfma_f32_32x32x16_bf16 v[116:131], v[132:135], v[24:27], 0
    v_exp_f32 v105, v105
    v_exp_f32 v106, v106
    v_exp_f32 v107, v107
    v_exp_f32 v108, v108
    v_mfma_f32_32x32x8bf16_1k v[116:131], v[144:145], v[34:35], v[116:131]
    v_exp_f32 v109, v109
    v_exp_f32 v110, v110
    v_exp_f32 v111, v111
    v_exp_f32 v112, v112
    v_smfmac_f32_32x32x32_bf16 v[68:83], v[136:139], v[100:107], v167
    v_exp_f32 v113, v113
    v_exp_f32 v114, v114
    v_exp_f32 v115, v115
    s_nop 3
    v_exp_f32 v116, v116
    v_exp_f32 v117, v117
    v_smfmac_f32_32x32x32_bf16 v[68:83], v[140:143], v[108:115], v167
    v_exp_f32 v118, v118
    v_exp_f32 v119, v119
    v_exp_f32 v120, v120
    s_waitcnt lgkmcnt(0)
    v_mfma_f32_32x32x16_bf16 v[100:115], v[146:149], v[12:15], 0
    v_exp_f32 v121, v121
    v_exp_f32 v122, v122
    v_exp_f32 v123, v123
    v_exp_f32 v124, v124
    v_mfma_f32_32x32x8bf16_1k v[100:115], v[158:159], v[28:29], v[100:115]
    v_readfirstlane_b32 s55, v163
    s_sub_u32 s24, s53, 2
    s_cmp_eq_u32 s52, 0
    s_cbranch_scc1 parallel_sum__mha_block__mixer_token_mlp__prompt_kernel_a_s2a
    s_mov_b64 exec, 1
    ds_add_u32 v160, v162
    s_mov_b64 exec, -1
    s_branch parallel_sum__mha_block__mixer_token_mlp__prompt_kernel_a_s2p
parallel_sum__mha_block__mixer_token_mlp__prompt_kernel_a_s2a:
    s_cmp_ge_u32 s39, 16
    s_cbranch_scc1 parallel_sum__mha_block__mixer_token_mlp__prompt_kernel_a_s2p
    s_cmp_ge_u32 s55, s24
    s_cbranch_scc1 parallel_sum__mha_block__mixer_token_mlp__prompt_kernel_a_s2d
    s_mov_b64 exec, 1
    v_mov_b32 v7, s57
    s_mov_b32 s61, 1048576
Lw13:
    ds_read_b32 v8, v7
    s_waitcnt lgkmcnt(0)
    v_readfirstlane_b32 s59, v8
    s_nop 0
    s_cmp_ge_u32 s59, s24
    s_cbranch_scc1 Lw13x
    s_sleep 1
    s_sub_u32 s61, s61, 1
    s_cmp_lg_u32 s61, 0
    s_cbranch_scc1 Lw13
Lw13x:
    s_mov_b64 exec, -1
parallel_sum__mha_block__mixer_token_mlp__prompt_kernel_a_s2d:
    s_mul_i32 s36, s37, 2560
    s_add_u32 s36, s36, s23
    s_add_u32 m0, s38, 2560
    s_add_u32 s37, s37, 1
    buffer_load_dwordx4 v4, s[8:11], s36 offen sc1 lds
    buffer_load_dwordx4 v4, s[8:11], s36 offen offset:1024 sc1 lds
    s_mov_b64 exec, s[32:33]
    buffer_load_dwordx4 v4, s[8:11], s36 offen offset:2048 sc1 lds
    s_mov_b64 exec, -1
    s_and_b32 s37, s37, 15
    s_add_u32 s39, s39, 1
parallel_sum__mha_block__mixer_token_mlp__prompt_kernel_a_s2p:
    s_cmp_eq_u32 s26, 1
    s_cbranch_scc1 parallel_sum__mha_block__mixer_token_mlp__prompt_kernel_a_s2q
    s_cmp_ge_u32 s55, s53
    s_setprio 3
    s_cbranch_scc1 parallel_sum__mha_block__mixer_token_mlp__prompt_kernel_a_s2e
    s_setprio 2
    s_branch parallel_sum__mha_block__mixer_token_mlp__prompt_kernel_a_s2e
parallel_sum__mha_block__mixer_token_mlp__prompt_kernel_a_s2q:
    s_cmp_ge_u32 s55, s53
    s_setprio 2
    s_cbranch_scc1 parallel_sum__mha_block__mixer_token_mlp__prompt_kernel_a_s2e
    s_setprio 0
parallel_sum__mha_block__mixer_token_mlp__prompt_kernel_a_s2e:
    s_add_u32 s53, s53, 1
    v_exp_f32 v125, v125
    v_exp_f32 v126, v126
    v_exp_f32 v127, v127
    v_exp_f32 v128, v128
    v_smfmac_f32_32x32x32_bf16 v[84:99], v[136:139], v[116:123], v167
    v_exp_f32 v129, v129
    v_exp_f32 v130, v130
    v_exp_f32 v131, v131
    v_exp_f32 v100, v100
    v_exp_f32 v101, v101
    v_smfmac_f32_32x32x32_bf16 v[84:99], v[140:143], v[124:131], v167
    v_exp_f32 v102, v102
    v_exp_f32 v103, v103
    v_exp_f32 v104, v104
    v_mfma_f32_32x32x16_bf16 v[116:131], v[146:149], v[16:19], 0
    v_exp_f32 v105, v105
    v_exp_f32 v106, v106
    v_exp_f32 v107, v107
    v_exp_f32 v108, v108
    v_mfma_f32_32x32x8bf16_1k v[116:131], v[158:159], v[30:31], v[116:131]
    v_exp_f32 v109, v109
    v_exp_f32 v110, v110
    v_exp_f32 v111, v111
    v_exp_f32 v112, v112
    v_smfmac_f32_32x32x32_bf16 v[36:51], v[150:153], v[100:107], v167
    v_exp_f32 v113, v113
    v_exp_f32 v114, v114
    v_exp_f32 v115, v115
    s_nop 3
    v_exp_f32 v116, v116
    v_exp_f32 v117, v117
    v_smfmac_f32_32x32x32_bf16 v[36:51], v[154:157], v[108:115], v167
    v_exp_f32 v118, v118
    v_exp_f32 v119, v119
    v_exp_f32 v120, v120
    v_mfma_f32_32x32x16_bf16 v[100:115], v[146:149], v[20:23], 0
    v_exp_f32 v121, v121
    v_exp_f32 v122, v122
    v_exp_f32 v123, v123
    v_exp_f32 v124, v124
    v_mfma_f32_32x32x8bf16_1k v[100:115], v[158:159], v[32:33], v[100:115]
    s_cmp_eq_u32 s52, 1
    s_cbranch_scc1 parallel_sum__mha_block__mixer_token_mlp__prompt_kernel_a_s3b
    s_cmp_eq_u32 s26, 1
    s_cbranch_scc0 parallel_sum__mha_block__mixer_token_mlp__prompt_kernel_a_s3w
    s_waitcnt vmcnt(3)
parallel_sum__mha_block__mixer_token_mlp__prompt_kernel_a_s3w:
    s_waitcnt vmcnt(9)
    s_mov_b64 exec, 1
    ds_add_u32 v160, v162
    s_mov_b64 exec, -1
    s_branch parallel_sum__mha_block__mixer_token_mlp__prompt_kernel_a_s3r
parallel_sum__mha_block__mixer_token_mlp__prompt_kernel_a_s3b:
    s_sub_u32 s24, s53, 2
    s_max_u32 s24, s24, 2
    s_min_u32 s24, s24, 14
    s_cmp_ge_u32 s55, s24
    s_cbranch_scc1 parallel_sum__mha_block__mixer_token_mlp__prompt_kernel_a_s3r
    s_mov_b64 exec, 1
    v_mov_b32 v7, s57
    s_mov_b32 s61, 1048576
Lw14:
    ds_read_b32 v8, v7
    s_waitcnt lgkmcnt(0)
    v_readfirstlane_b32 s59, v8
    s_nop 0
    s_cmp_ge_u32 s59, s24
    s_cbranch_scc1 Lw14x
    s_sleep 1
    s_sub_u32 s61, s61, 1
    s_cmp_lg_u32 s61, 0
    s_cbranch_scc1 Lw14
Lw14x:
    s_mov_b64 exec, -1
parallel_sum__mha_block__mixer_token_mlp__prompt_kernel_a_s3r:
    ds_read2st64_b64 v[132:135], v165 offset0:20 offset1:21
    s_mov_b64 exec, s[32:33]
    ds_read_b64 v[144:145], v165 offset:11264
    s_mov_b64 exec, s[30:31]
    ds_read_b128 v[136:139], v166 offset:11520
    ds_read_b128 v[140:143], v166 offset:12160
    ds_read_b32 v163, v161
    s_mov_b64 exec, -1
    v_exp_f32 v125, v125
    v_exp_f32 v126, v126
    v_exp_f32 v127, v127
    v_exp_f32 v128, v128
    v_smfmac_f32_32x32x32_bf16 v[52:67], v[150:153], v[116:123], v167
    v_exp_f32 v129, v129
    v_exp_f32 v130, v130
    v_exp_f32 v131, v131
    v_exp_f32 v100, v100
    v_exp_f32 v101, v101
    v_smfmac_f32_32x32x32_bf16 v[52:67], v[154:157], v[124:131], v167
    v_exp_f32 v102, v102
    v_exp_f32 v103, v103
    v_exp_f32 v104, v104
    v_mfma_f32_32x32x16_bf16 v[116:131], v[146:149], v[24:27], 0
    v_exp_f32 v105, v105
    v_exp_f32 v106, v106
    v_exp_f32 v107, v107
    v_exp_f32 v108, v108
    v_mfma_f32_32x32x8bf16_1k v[116:131], v[158:159], v[34:35], v[116:131]
    v_exp_f32 v109, v109
    v_exp_f32 v110, v110
    v_exp_f32 v111, v111
    v_exp_f32 v112, v112
    v_smfmac_f32_32x32x32_bf16 v[68:83], v[150:153], v[100:107], v167
    v_exp_f32 v113, v113
    v_exp_f32 v114, v114
    v_exp_f32 v115, v115
    s_nop 3
    v_exp_f32 v116, v116
    v_exp_f32 v117, v117
    v_smfmac_f32_32x32x32_bf16 v[68:83], v[154:157], v[108:115], v167
    v_exp_f32 v118, v118
    v_exp_f32 v119, v119
    v_exp_f32 v120, v120
    s_waitcnt lgkmcnt(0)
    v_mfma_f32_32x32x16_bf16 v[100:115], v[132:135], v[12:15], 0
    v_exp_f32 v121, v121
    v_exp_f32 v122, v122
    v_exp_f32 v123, v123
    v_exp_f32 v124, v124
    v_mfma_f32_32x32x8bf16_1k v[100:115], v[144:145], v[28:29], v[100:115]
    v_readfirstlane_b32 s55, v163
    s_sub_u32 s24, s53, 2
    s_cmp_eq_u32 s52, 0
    s_cbranch_scc1 parallel_sum__mha_block__mixer_token_mlp__prompt_kernel_a_s3a
    s_mov_b64 exec, 1
    ds_add_u32 v160, v162
    s_mov_b64 exec, -1
    s_branch parallel_sum__mha_block__mixer_token_mlp__prompt_kernel_a_s3p
parallel_sum__mha_block__mixer_token_mlp__prompt_kernel_a_s3a:
    s_cmp_ge_u32 s39, 16
    s_cbranch_scc1 parallel_sum__mha_block__mixer_token_mlp__prompt_kernel_a_s3p
    s_cmp_ge_u32 s55, s24
    s_cbranch_scc1 parallel_sum__mha_block__mixer_token_mlp__prompt_kernel_a_s3d
    s_mov_b64 exec, 1
    v_mov_b32 v7, s57
    s_mov_b32 s61, 1048576
Lw15:
    ds_read_b32 v8, v7
    s_waitcnt lgkmcnt(0)
    v_readfirstlane_b32 s59, v8
    s_nop 0
    s_cmp_ge_u32 s59, s24
    s_cbranch_scc1 Lw15x
    s_sleep 1
    s_sub_u32 s61, s61, 1
    s_cmp_lg_u32 s61, 0
    s_cbranch_scc1 Lw15
Lw15x:
    s_mov_b64 exec, -1
parallel_sum__mha_block__mixer_token_mlp__prompt_kernel_a_s3d:
    s_mul_i32 s36, s37, 2560
    s_add_u32 s36, s36, s23
    s_add_u32 m0, s38, 5120
    s_add_u32 s37, s37, 1
    buffer_load_dwordx4 v4, s[8:11], s36 offen sc1 lds
    buffer_load_dwordx4 v4, s[8:11], s36 offen offset:1024 sc1 lds
    s_mov_b64 exec, s[32:33]
    buffer_load_dwordx4 v4, s[8:11], s36 offen offset:2048 sc1 lds
    s_mov_b64 exec, -1
    s_and_b32 s37, s37, 15
    s_add_u32 s39, s39, 1
parallel_sum__mha_block__mixer_token_mlp__prompt_kernel_a_s3p:
    s_cmp_eq_u32 s26, 1
    s_cbranch_scc1 parallel_sum__mha_block__mixer_token_mlp__prompt_kernel_a_s3q
    s_cmp_ge_u32 s55, s53
    s_setprio 3
    s_cbranch_scc1 parallel_sum__mha_block__mixer_token_mlp__prompt_kernel_a_s3e
    s_setprio 2
    s_branch parallel_sum__mha_block__mixer_token_mlp__prompt_kernel_a_s3e
parallel_sum__mha_block__mixer_token_mlp__prompt_kernel_a_s3q:
    s_cmp_ge_u32 s55, s53
    s_setprio 1
    s_cbranch_scc1 parallel_sum__mha_block__mixer_token_mlp__prompt_kernel_a_s3e
    s_setprio 0
parallel_sum__mha_block__mixer_token_mlp__prompt_kernel_a_s3e:
    s_add_u32 s53, s53, 1
    v_exp_f32 v125, v125
    v_exp_f32 v126, v126
    v_exp_f32 v127, v127
    v_exp_f32 v128, v128
    v_smfmac_f32_32x32x32_bf16 v[84:99], v[150:153], v[116:123], v167
    v_exp_f32 v129, v129
    v_exp_f32 v130, v130
    v_exp_f32 v131, v131
    v_exp_f32 v100, v100
    v_exp_f32 v101, v101
    v_smfmac_f32_32x32x32_bf16 v[84:99], v[154:157], v[124:131], v167
    v_exp_f32 v102, v102
    v_exp_f32 v103, v103
    v_exp_f32 v104, v104
    v_mfma_f32_32x32x16_bf16 v[116:131], v[132:135], v[16:19], 0
    v_exp_f32 v105, v105
    v_exp_f32 v106, v106
    v_exp_f32 v107, v107
    v_exp_f32 v108, v108
    v_mfma_f32_32x32x8bf16_1k v[116:131], v[144:145], v[30:31], v[116:131]
    v_exp_f32 v109, v109
    v_exp_f32 v110, v110
    v_exp_f32 v111, v111
    v_exp_f32 v112, v112
    v_smfmac_f32_32x32x32_bf16 v[36:51], v[136:139], v[100:107], v167
    v_exp_f32 v113, v113
    v_exp_f32 v114, v114
    v_exp_f32 v115, v115
    s_nop 3
    v_exp_f32 v116, v116
    v_exp_f32 v117, v117
    v_smfmac_f32_32x32x32_bf16 v[36:51], v[140:143], v[108:115], v167
    v_exp_f32 v118, v118
    v_exp_f32 v119, v119
    v_exp_f32 v120, v120
    v_mfma_f32_32x32x16_bf16 v[100:115], v[132:135], v[20:23], 0
    v_exp_f32 v121, v121
    v_exp_f32 v122, v122
    v_exp_f32 v123, v123
    v_exp_f32 v124, v124
    v_mfma_f32_32x32x8bf16_1k v[100:115], v[144:145], v[32:33], v[100:115]
    s_cmp_eq_u32 s52, 1
    s_cbranch_scc1 parallel_sum__mha_block__mixer_token_mlp__prompt_kernel_a_s4b
    s_cmp_eq_u32 s26, 1
    s_cbranch_scc0 parallel_sum__mha_block__mixer_token_mlp__prompt_kernel_a_s4w
    s_waitcnt vmcnt(0)
parallel_sum__mha_block__mixer_token_mlp__prompt_kernel_a_s4w:
    s_waitcnt vmcnt(9)
    s_mov_b64 exec, 1
    ds_add_u32 v160, v162
    s_mov_b64 exec, -1
    s_branch parallel_sum__mha_block__mixer_token_mlp__prompt_kernel_a_s4r
parallel_sum__mha_block__mixer_token_mlp__prompt_kernel_a_s4b:
    s_sub_u32 s24, s53, 2
    s_max_u32 s24, s24, 2
    s_min_u32 s24, s24, 14
    s_cmp_ge_u32 s55, s24
    s_cbranch_scc1 parallel_sum__mha_block__mixer_token_mlp__prompt_kernel_a_s4r
    s_mov_b64 exec, 1
    v_mov_b32 v7, s57
    s_mov_b32 s61, 1048576
Lw16:
    ds_read_b32 v8, v7
    s_waitcnt lgkmcnt(0)
    v_readfirstlane_b32 s59, v8
    s_nop 0
    s_cmp_ge_u32 s59, s24
    s_cbranch_scc1 Lw16x
    s_sleep 1
    s_sub_u32 s61, s61, 1
    s_cmp_lg_u32 s61, 0
    s_cbranch_scc1 Lw16
Lw16x:
    s_mov_b64 exec, -1
parallel_sum__mha_block__mixer_token_mlp__prompt_kernel_a_s4r:
    ds_read2st64_b64 v[146:149], v165 offset0:25 offset1:26
    s_mov_b64 exec, s[32:33]
    ds_read_b64 v[158:159], v165 offset:13824
    s_mov_b64 exec, s[30:31]
    ds_read_b128 v[150:153], v166 offset:14080
    ds_read_b128 v[154:157], v166 offset:14720
    ds_read_b32 v163, v161
    s_mov_b64 exec, -1
    v_exp_f32 v125, v125
    v_exp_f32 v126, v126
    v_exp_f32 v127, v127
    v_exp_f32 v128, v128
    v_smfmac_f32_32x32x32_bf16 v[52:67], v[136:139], v[116:123], v167
    v_exp_f32 v129, v129
    v_exp_f32 v130, v130
    v_exp_f32 v131, v131
    v_exp_f32 v100, v100
    v_exp_f32 v101, v101
    v_smfmac_f32_32x32x32_bf16 v[52:67], v[140:143], v[124:131], v167
    v_exp_f32 v102, v102
    v_exp_f32 v103, v103
    v_exp_f32 v104, v104
    v_mfma_f32_32x32x16_bf16 v[116:131], v[132:135], v[24:27], 0
    v_exp_f32 v105, v105
    v_exp_f32 v106, v106
    v_exp_f32 v107, v107
    v_exp_f32 v108, v108
    v_mfma_f32_32x32x8bf16_1k v[116:131], v[144:145], v[34:35], v[116:131]
    v_exp_f32 v109, v109
    v_exp_f32 v110, v110
    v_exp_f32 v111, v111
    v_exp_f32 v112, v112
    v_smfmac_f32_32x32x32_bf16 v[68:83], v[136:139], v[100:107], v167
    v_exp_f32 v113, v113
    v_exp_f32 v114, v114
    v_exp_f32 v115, v115
    s_nop 3
    v_exp_f32 v116, v116
    v_exp_f32 v117, v117
    v_smfmac_f32_32x32x32_bf16 v[68:83], v[140:143], v[108:115], v167
    v_exp_f32 v118, v118
    v_exp_f32 v119, v119
    v_exp_f32 v120, v120
    s_waitcnt lgkmcnt(0)
    v_mfma_f32_32x32x16_bf16 v[100:115], v[146:149], v[12:15], 0
    v_exp_f32 v121, v121
    v_exp_f32 v122, v122
    v_exp_f32 v123, v123
    v_exp_f32 v124, v124
    v_mfma_f32_32x32x8bf16_1k v[100:115], v[158:159], v[28:29], v[100:115]
    v_readfirstlane_b32 s55, v163
    s_sub_u32 s24, s53, 2
    s_cmp_eq_u32 s52, 0
    s_cbranch_scc1 parallel_sum__mha_block__mixer_token_mlp__prompt_kernel_a_s4a
    s_mov_b64 exec, 1
    ds_add_u32 v160, v162
    s_mov_b64 exec, -1
    s_branch parallel_sum__mha_block__mixer_token_mlp__prompt_kernel_a_s4p
parallel_sum__mha_block__mixer_token_mlp__prompt_kernel_a_s4a:
    s_cmp_ge_u32 s39, 16
    s_cbranch_scc1 parallel_sum__mha_block__mixer_token_mlp__prompt_kernel_a_s4p
    s_cmp_ge_u32 s55, s24
    s_cbranch_scc1 parallel_sum__mha_block__mixer_token_mlp__prompt_kernel_a_s4d
    s_mov_b64 exec, 1
    v_mov_b32 v7, s57
    s_mov_b32 s61, 1048576
Lw17:
    ds_read_b32 v8, v7
    s_waitcnt lgkmcnt(0)
    v_readfirstlane_b32 s59, v8
    s_nop 0
    s_cmp_ge_u32 s59, s24
    s_cbranch_scc1 Lw17x
    s_sleep 1
    s_sub_u32 s61, s61, 1
    s_cmp_lg_u32 s61, 0
    s_cbranch_scc1 Lw17
Lw17x:
    s_mov_b64 exec, -1
parallel_sum__mha_block__mixer_token_mlp__prompt_kernel_a_s4d:
    s_mul_i32 s36, s37, 2560
    s_add_u32 s36, s36, s23
    s_add_u32 m0, s38, 7680
    s_add_u32 s37, s37, 1
    buffer_load_dwordx4 v4, s[8:11], s36 offen sc1 lds
    buffer_load_dwordx4 v4, s[8:11], s36 offen offset:1024 sc1 lds
    s_mov_b64 exec, s[32:33]
    buffer_load_dwordx4 v4, s[8:11], s36 offen offset:2048 sc1 lds
    s_mov_b64 exec, -1
    s_and_b32 s37, s37, 15
    s_add_u32 s39, s39, 1
parallel_sum__mha_block__mixer_token_mlp__prompt_kernel_a_s4p:
    s_cmp_eq_u32 s26, 1
    s_cbranch_scc1 parallel_sum__mha_block__mixer_token_mlp__prompt_kernel_a_s4q
    s_cmp_ge_u32 s55, s53
    s_setprio 3
    s_cbranch_scc1 parallel_sum__mha_block__mixer_token_mlp__prompt_kernel_a_s4e
    s_setprio 2
    s_branch parallel_sum__mha_block__mixer_token_mlp__prompt_kernel_a_s4e
parallel_sum__mha_block__mixer_token_mlp__prompt_kernel_a_s4q:
    s_cmp_ge_u32 s55, s53
    s_setprio 1
    s_cbranch_scc1 parallel_sum__mha_block__mixer_token_mlp__prompt_kernel_a_s4e
    s_setprio 0
parallel_sum__mha_block__mixer_token_mlp__prompt_kernel_a_s4e:
    s_add_u32 s53, s53, 1
    v_exp_f32 v125, v125
    v_exp_f32 v126, v126
    v_exp_f32 v127, v127
    v_exp_f32 v128, v128
    v_smfmac_f32_32x32x32_bf16 v[84:99], v[136:139], v[116:123], v167
    v_exp_f32 v129, v129
    v_exp_f32 v130, v130
    v_exp_f32 v131, v131
    v_exp_f32 v100, v100
    v_exp_f32 v101, v101
    v_smfmac_f32_32x32x32_bf16 v[84:99], v[140:143], v[124:131], v167
    v_exp_f32 v102, v102
    v_exp_f32 v103, v103
    v_exp_f32 v104, v104
    v_mfma_f32_32x32x16_bf16 v[116:131], v[146:149], v[16:19], 0
    v_exp_f32 v105, v105
    v_exp_f32 v106, v106
    v_exp_f32 v107, v107
    v_exp_f32 v108, v108
    v_mfma_f32_32x32x8bf16_1k v[116:131], v[158:159], v[30:31], v[116:131]
    v_exp_f32 v109, v109
    v_exp_f32 v110, v110
    v_exp_f32 v111, v111
    v_exp_f32 v112, v112
    v_smfmac_f32_32x32x32_bf16 v[36:51], v[150:153], v[100:107], v167
    v_exp_f32 v113, v113
    v_exp_f32 v114, v114
    v_exp_f32 v115, v115
    s_nop 3
    v_exp_f32 v116, v116
    v_exp_f32 v117, v117
    v_smfmac_f32_32x32x32_bf16 v[36:51], v[154:157], v[108:115], v167
    v_exp_f32 v118, v118
    v_exp_f32 v119, v119
    v_exp_f32 v120, v120
    v_mfma_f32_32x32x16_bf16 v[100:115], v[146:149], v[20:23], 0
    v_exp_f32 v121, v121
    v_exp_f32 v122, v122
    v_exp_f32 v123, v123
    v_exp_f32 v124, v124
    v_mfma_f32_32x32x8bf16_1k v[100:115], v[158:159], v[32:33], v[100:115]
    s_cmp_eq_u32 s52, 1
    s_cbranch_scc1 parallel_sum__mha_block__mixer_token_mlp__prompt_kernel_a_s5b
    s_waitcnt vmcnt(9)
    s_mov_b64 exec, 1
    ds_add_u32 v160, v162
    s_mov_b64 exec, -1
    s_branch parallel_sum__mha_block__mixer_token_mlp__prompt_kernel_a_s5r
parallel_sum__mha_block__mixer_token_mlp__prompt_kernel_a_s5b:
    s_sub_u32 s24, s53, 2
    s_max_u32 s24, s24, 2
    s_min_u32 s24, s24, 14
    s_cmp_ge_u32 s55, s24
    s_cbranch_scc1 parallel_sum__mha_block__mixer_token_mlp__prompt_kernel_a_s5r
    s_mov_b64 exec, 1
    v_mov_b32 v7, s57
    s_mov_b32 s61, 1048576
Lw18:
    ds_read_b32 v8, v7
    s_waitcnt lgkmcnt(0)
    v_readfirstlane_b32 s59, v8
    s_nop 0
    s_cmp_ge_u32 s59, s24
    s_cbranch_scc1 Lw18x
    s_sleep 1
    s_sub_u32 s61, s61, 1
    s_cmp_lg_u32 s61, 0
    s_cbranch_scc1 Lw18
Lw18x:
    s_mov_b64 exec, -1
parallel_sum__mha_block__mixer_token_mlp__prompt_kernel_a_s5r:
    ds_read2st64_b64 v[132:135], v165 offset0:30 offset1:31
    s_mov_b64 exec, s[32:33]
    ds_read_b64 v[144:145], v165 offset:16384
    s_mov_b64 exec, s[30:31]
    ds_read_b128 v[136:139], v166 offset:16640
    ds_read_b128 v[140:143], v166 offset:17280
    ds_read_b32 v163, v161
    s_mov_b64 exec, -1
    v_exp_f32 v125, v125
    v_exp_f32 v126, v126
    v_exp_f32 v127, v127
    v_exp_f32 v128, v128
    v_smfmac_f32_32x32x32_bf16 v[52:67], v[150:153], v[116:123], v167
    v_exp_f32 v129, v129
    v_exp_f32 v130, v130
    v_exp_f32 v131, v131
    v_exp_f32 v100, v100
    v_exp_f32 v101, v101
    v_smfmac_f32_32x32x32_bf16 v[52:67], v[154:157], v[124:131], v167
    v_exp_f32 v102, v102
    v_exp_f32 v103, v103
    v_exp_f32 v104, v104
    v_mfma_f32_32x32x16_bf16 v[116:131], v[146:149], v[24:27], 0
    v_exp_f32 v105, v105
    v_exp_f32 v106, v106
    v_exp_f32 v107, v107
    v_exp_f32 v108, v108
    v_mfma_f32_32x32x8bf16_1k v[116:131], v[158:159], v[34:35], v[116:131]
    v_exp_f32 v109, v109
    v_exp_f32 v110, v110
    v_exp_f32 v111, v111
    v_exp_f32 v112, v112
    v_smfmac_f32_32x32x32_bf16 v[68:83], v[150:153], v[100:107], v167
    v_exp_f32 v113, v113
    v_exp_f32 v114, v114
    v_exp_f32 v115, v115
    s_nop 3
    v_exp_f32 v116, v116
    v_exp_f32 v117, v117
    v_smfmac_f32_32x32x32_bf16 v[68:83], v[154:157], v[108:115], v167
    v_exp_f32 v118, v118
    v_exp_f32 v119, v119
    v_exp_f32 v120, v120
    s_waitcnt lgkmcnt(0)
    v_mfma_f32_32x32x16_bf16 v[100:115], v[132:135], v[12:15], 0
    v_exp_f32 v121, v121
    v_exp_f32 v122, v122
    v_exp_f32 v123, v123
    v_exp_f32 v124, v124
    v_mfma_f32_32x32x8bf16_1k v[100:115], v[144:145], v[28:29], v[100:115]
    v_readfirstlane_b32 s55, v163
    s_sub_u32 s24, s53, 2
    s_cmp_eq_u32 s52, 0
    s_cbranch_scc1 parallel_sum__mha_block__mixer_token_mlp__prompt_kernel_a_s5a
    s_mov_b64 exec, 1
    ds_add_u32 v160, v162
    s_mov_b64 exec, -1
    s_branch parallel_sum__mha_block__mixer_token_mlp__prompt_kernel_a_s5p
parallel_sum__mha_block__mixer_token_mlp__prompt_kernel_a_s5a:
    s_cmp_ge_u32 s39, 16
    s_cbranch_scc1 parallel_sum__mha_block__mixer_token_mlp__prompt_kernel_a_s5p
    s_cmp_ge_u32 s55, s24
    s_cbranch_scc1 parallel_sum__mha_block__mixer_token_mlp__prompt_kernel_a_s5d
    s_mov_b64 exec, 1
    v_mov_b32 v7, s57
    s_mov_b32 s61, 1048576
Lw19:
    ds_read_b32 v8, v7
    s_waitcnt lgkmcnt(0)
    v_readfirstlane_b32 s59, v8
    s_nop 0
    s_cmp_ge_u32 s59, s24
    s_cbranch_scc1 Lw19x
    s_sleep 1
    s_sub_u32 s61, s61, 1
    s_cmp_lg_u32 s61, 0
    s_cbranch_scc1 Lw19
Lw19x:
    s_mov_b64 exec, -1
parallel_sum__mha_block__mixer_token_mlp__prompt_kernel_a_s5d:
    s_mul_i32 s36, s37, 2560
    s_add_u32 s36, s36, s23
    s_add_u32 m0, s38, 10240
    s_add_u32 s37, s37, 1
    buffer_load_dwordx4 v4, s[8:11], s36 offen sc1 lds
    buffer_load_dwordx4 v4, s[8:11], s36 offen offset:1024 sc1 lds
    s_mov_b64 exec, s[32:33]
    buffer_load_dwordx4 v4, s[8:11], s36 offen offset:2048 sc1 lds
    s_mov_b64 exec, -1
    s_and_b32 s37, s37, 15
    s_add_u32 s39, s39, 1
parallel_sum__mha_block__mixer_token_mlp__prompt_kernel_a_s5p:
    s_cmp_eq_u32 s26, 1
    s_cbranch_scc1 parallel_sum__mha_block__mixer_token_mlp__prompt_kernel_a_s5q
    s_cmp_ge_u32 s55, s53
    s_setprio 3
    s_cbranch_scc1 parallel_sum__mha_block__mixer_token_mlp__prompt_kernel_a_s5e
    s_setprio 2
    s_branch parallel_sum__mha_block__mixer_token_mlp__prompt_kernel_a_s5e
parallel_sum__mha_block__mixer_token_mlp__prompt_kernel_a_s5q:
    s_cmp_ge_u32 s55, s53
    s_setprio 1
    s_cbranch_scc1 parallel_sum__mha_block__mixer_token_mlp__prompt_kernel_a_s5e
    s_setprio 0
parallel_sum__mha_block__mixer_token_mlp__prompt_kernel_a_s5e:
    s_add_u32 s53, s53, 1
    v_exp_f32 v125, v125
    v_exp_f32 v126, v126
    v_exp_f32 v127, v127
    v_exp_f32 v128, v128
    v_smfmac_f32_32x32x32_bf16 v[84:99], v[150:153], v[116:123], v167
    v_exp_f32 v129, v129
    v_exp_f32 v130, v130
    v_exp_f32 v131, v131
    v_exp_f32 v100, v100
    v_exp_f32 v101, v101
    v_smfmac_f32_32x32x32_bf16 v[84:99], v[154:157], v[124:131], v167
    v_exp_f32 v102, v102
    v_exp_f32 v103, v103
    v_exp_f32 v104, v104
    v_mfma_f32_32x32x16_bf16 v[116:131], v[132:135], v[16:19], 0
    v_exp_f32 v105, v105
    v_exp_f32 v106, v106
    v_exp_f32 v107, v107
    v_exp_f32 v108, v108
    v_mfma_f32_32x32x8bf16_1k v[116:131], v[144:145], v[30:31], v[116:131]
    v_exp_f32 v109, v109
    v_exp_f32 v110, v110
    v_exp_f32 v111, v111
    v_exp_f32 v112, v112
    v_smfmac_f32_32x32x32_bf16 v[36:51], v[136:139], v[100:107], v167
    v_exp_f32 v113, v113
    v_exp_f32 v114, v114
    v_exp_f32 v115, v115
    s_nop 3
    v_exp_f32 v116, v116
    v_exp_f32 v117, v117
    v_smfmac_f32_32x32x32_bf16 v[36:51], v[140:143], v[108:115], v167
    v_exp_f32 v118, v118
    v_exp_f32 v119, v119
    v_exp_f32 v120, v120
    v_mfma_f32_32x32x16_bf16 v[100:115], v[132:135], v[20:23], 0
    v_exp_f32 v121, v121
    v_exp_f32 v122, v122
    v_exp_f32 v123, v123
    v_exp_f32 v124, v124
    v_mfma_f32_32x32x8bf16_1k v[100:115], v[144:145], v[32:33], v[100:115]
    s_cmp_eq_u32 s52, 1
    s_cbranch_scc1 parallel_sum__mha_block__mixer_token_mlp__prompt_kernel_a_s6b
    s_waitcnt vmcnt(9)
    s_mov_b64 exec, 1
    ds_add_u32 v160, v162
    s_mov_b64 exec, -1
    s_branch parallel_sum__mha_block__mixer_token_mlp__prompt_kernel_a_s6r
parallel_sum__mha_block__mixer_token_mlp__prompt_kernel_a_s6b:
    s_sub_u32 s24, s53, 2
    s_max_u32 s24, s24, 2
    s_min_u32 s24, s24, 14
    s_cmp_ge_u32 s55, s24
    s_cbranch_scc1 parallel_sum__mha_block__mixer_token_mlp__prompt_kernel_a_s6r
    s_mov_b64 exec, 1
    v_mov_b32 v7, s57
    s_mov_b32 s61, 1048576
Lw20:
    ds_read_b32 v8, v7
    s_waitcnt lgkmcnt(0)
    v_readfirstlane_b32 s59, v8
    s_nop 0
    s_cmp_ge_u32 s59, s24
    s_cbranch_scc1 Lw20x
    s_sleep 1
    s_sub_u32 s61, s61, 1
    s_cmp_lg_u32 s61, 0
    s_cbranch_scc1 Lw20
Lw20x:
    s_mov_b64 exec, -1
parallel_sum__mha_block__mixer_token_mlp__prompt_kernel_a_s6r:
    ds_read2st64_b64 v[146:149], v165 offset0:35 offset1:36
    s_mov_b64 exec, s[32:33]
    ds_read_b64 v[158:159], v165 offset:18944
    s_mov_b64 exec, s[30:31]
    ds_read_b128 v[150:153], v166 offset:19200
    ds_read_b128 v[154:157], v166 offset:19840
    ds_read_b32 v163, v161
    s_mov_b64 exec, -1
    v_exp_f32 v125, v125
    v_exp_f32 v126, v126
    v_exp_f32 v127, v127
    v_exp_f32 v128, v128
    v_smfmac_f32_32x32x32_bf16 v[52:67], v[136:139], v[116:123], v167
    v_exp_f32 v129, v129
    v_exp_f32 v130, v130
    v_exp_f32 v131, v131
    v_exp_f32 v100, v100
    v_exp_f32 v101, v101
    v_smfmac_f32_32x32x32_bf16 v[52:67], v[140:143], v[124:131], v167
    v_exp_f32 v102, v102
    v_exp_f32 v103, v103
    v_exp_f32 v104, v104
    v_mfma_f32_32x32x16_bf16 v[116:131], v[132:135], v[24:27], 0
    v_exp_f32 v105, v105
    v_exp_f32 v106, v106
    v_exp_f32 v107, v107
    v_exp_f32 v108, v108
    v_mfma_f32_32x32x8bf16_1k v[116:131], v[144:145], v[34:35], v[116:131]
    v_exp_f32 v109, v109
    v_exp_f32 v110, v110
    v_exp_f32 v111, v111
    v_exp_f32 v112, v112
    v_smfmac_f32_32x32x32_bf16 v[68:83], v[136:139], v[100:107], v167
    v_exp_f32 v113, v113
    v_exp_f32 v114, v114
    v_exp_f32 v115, v115
    s_nop 3
    v_exp_f32 v116, v116
    v_exp_f32 v117, v117
    v_smfmac_f32_32x32x32_bf16 v[68:83], v[140:143], v[108:115], v167
    v_exp_f32 v118, v118
    v_exp_f32 v119, v119
    v_exp_f32 v120, v120
    s_waitcnt lgkmcnt(0)
    v_mfma_f32_32x32x16_bf16 v[100:115], v[146:149], v[12:15], 0
    v_exp_f32 v121, v121
    v_exp_f32 v122, v122
    v_exp_f32 v123, v123
    v_exp_f32 v124, v124
    v_mfma_f32_32x32x8bf16_1k v[100:115], v[158:159], v[28:29], v[100:115]
    v_readfirstlane_b32 s55, v163
    s_sub_u32 s24, s53, 2
    s_cmp_eq_u32 s52, 0
    s_cbranch_scc1 parallel_sum__mha_block__mixer_token_mlp__prompt_kernel_a_s6a
    s_mov_b64 exec, 1
    ds_add_u32 v160, v162
    s_mov_b64 exec, -1
    s_branch parallel_sum__mha_block__mixer_token_mlp__prompt_kernel_a_s6p
parallel_sum__mha_block__mixer_token_mlp__prompt_kernel_a_s6a:
    s_cmp_ge_u32 s39, 16
    s_cbranch_scc1 parallel_sum__mha_block__mixer_token_mlp__prompt_kernel_a_s6p
    s_cmp_ge_u32 s55, s24
    s_cbranch_scc1 parallel_sum__mha_block__mixer_token_mlp__prompt_kernel_a_s6d
    s_mov_b64 exec, 1
    v_mov_b32 v7, s57
    s_mov_b32 s61, 1048576
Lw21:
    ds_read_b32 v8, v7
    s_waitcnt lgkmcnt(0)
    v_readfirstlane_b32 s59, v8
    s_nop 0
    s_cmp_ge_u32 s59, s24
    s_cbranch_scc1 Lw21x
    s_sleep 1
    s_sub_u32 s61, s61, 1
    s_cmp_lg_u32 s61, 0
    s_cbranch_scc1 Lw21
Lw21x:
    s_mov_b64 exec, -1
parallel_sum__mha_block__mixer_token_mlp__prompt_kernel_a_s6d:
    s_mul_i32 s36, s37, 2560
    s_add_u32 s36, s36, s23
    s_add_u32 m0, s38, 12800
    s_add_u32 s37, s37, 1
    buffer_load_dwordx4 v4, s[8:11], s36 offen sc1 lds
    buffer_load_dwordx4 v4, s[8:11], s36 offen offset:1024 sc1 lds
    s_mov_b64 exec, s[32:33]
    buffer_load_dwordx4 v4, s[8:11], s36 offen offset:2048 sc1 lds
    s_mov_b64 exec, -1
    s_and_b32 s37, s37, 15
    s_add_u32 s39, s39, 1
parallel_sum__mha_block__mixer_token_mlp__prompt_kernel_a_s6p:
    s_cmp_eq_u32 s26, 1
    s_cbranch_scc1 parallel_sum__mha_block__mixer_token_mlp__prompt_kernel_a_s6q
    s_cmp_ge_u32 s55, s53
    s_setprio 3
    s_cbranch_scc1 parallel_sum__mha_block__mixer_token_mlp__prompt_kernel_a_s6e
    s_setprio 2
    s_branch parallel_sum__mha_block__mixer_token_mlp__prompt_kernel_a_s6e
parallel_sum__mha_block__mixer_token_mlp__prompt_kernel_a_s6q:
    s_cmp_ge_u32 s55, s53
    s_setprio 1
    s_cbranch_scc1 parallel_sum__mha_block__mixer_token_mlp__prompt_kernel_a_s6e
    s_setprio 0
parallel_sum__mha_block__mixer_token_mlp__prompt_kernel_a_s6e:
    s_add_u32 s53, s53, 1
    v_exp_f32 v125, v125
    v_exp_f32 v126, v126
    v_exp_f32 v127, v127
    v_exp_f32 v128, v128
    v_smfmac_f32_32x32x32_bf16 v[84:99], v[136:139], v[116:123], v167
    v_exp_f32 v129, v129
    v_exp_f32 v130, v130
    v_exp_f32 v131, v131
    v_exp_f32 v100, v100
    v_exp_f32 v101, v101
    v_smfmac_f32_32x32x32_bf16 v[84:99], v[140:143], v[124:131], v167
    v_exp_f32 v102, v102
    v_exp_f32 v103, v103
    v_exp_f32 v104, v104
    v_mfma_f32_32x32x16_bf16 v[116:131], v[146:149], v[16:19], 0
    v_exp_f32 v105, v105
    v_exp_f32 v106, v106
    v_exp_f32 v107, v107
    v_exp_f32 v108, v108
    v_mfma_f32_32x32x8bf16_1k v[116:131], v[158:159], v[30:31], v[116:131]
    v_exp_f32 v109, v109
    v_exp_f32 v110, v110
    v_exp_f32 v111, v111
    v_exp_f32 v112, v112
    v_smfmac_f32_32x32x32_bf16 v[36:51], v[150:153], v[100:107], v167
    v_exp_f32 v113, v113
    v_exp_f32 v114, v114
    v_exp_f32 v115, v115
    s_nop 3
    v_exp_f32 v116, v116
    v_exp_f32 v117, v117
    v_smfmac_f32_32x32x32_bf16 v[36:51], v[154:157], v[108:115], v167
    v_exp_f32 v118, v118
    v_exp_f32 v119, v119
    v_exp_f32 v120, v120
    v_mfma_f32_32x32x16_bf16 v[100:115], v[146:149], v[20:23], 0
    v_exp_f32 v121, v121
    v_exp_f32 v122, v122
    v_exp_f32 v123, v123
    v_exp_f32 v124, v124
    v_mfma_f32_32x32x8bf16_1k v[100:115], v[158:159], v[32:33], v[100:115]
    s_cmp_eq_u32 s52, 1
    s_cbranch_scc1 parallel_sum__mha_block__mixer_token_mlp__prompt_kernel_a_s7b
    s_waitcnt vmcnt(9)
    s_mov_b64 exec, 1
    ds_add_u32 v160, v162
    s_mov_b64 exec, -1
    s_branch parallel_sum__mha_block__mixer_token_mlp__prompt_kernel_a_s7r
parallel_sum__mha_block__mixer_token_mlp__prompt_kernel_a_s7b:
    s_sub_u32 s24, s53, 2
    s_max_u32 s24, s24, 2
    s_min_u32 s24, s24, 14
    s_cmp_ge_u32 s55, s24
    s_cbranch_scc1 parallel_sum__mha_block__mixer_token_mlp__prompt_kernel_a_s7r
    s_mov_b64 exec, 1
    v_mov_b32 v7, s57
    s_mov_b32 s61, 1048576
Lw22:
    ds_read_b32 v8, v7
    s_waitcnt lgkmcnt(0)
    v_readfirstlane_b32 s59, v8
    s_nop 0
    s_cmp_ge_u32 s59, s24
    s_cbranch_scc1 Lw22x
    s_sleep 1
    s_sub_u32 s61, s61, 1
    s_cmp_lg_u32 s61, 0
    s_cbranch_scc1 Lw22
Lw22x:
    s_mov_b64 exec, -1
parallel_sum__mha_block__mixer_token_mlp__prompt_kernel_a_s7r:
    ds_read2st64_b64 v[132:135], v165 offset0:0 offset1:1
    s_mov_b64 exec, s[32:33]
    ds_read_b64 v[144:145], v165 offset:1024
    s_mov_b64 exec, s[30:31]
    ds_read_b128 v[136:139], v166 offset:1280
    ds_read_b128 v[140:143], v166 offset:1920
    ds_read_b32 v163, v161
    s_mov_b64 exec, -1
    v_exp_f32 v125, v125
    v_exp_f32 v126, v126
    v_exp_f32 v127, v127
    v_exp_f32 v128, v128
    v_smfmac_f32_32x32x32_bf16 v[52:67], v[150:153], v[116:123], v167
    v_exp_f32 v129, v129
    v_exp_f32 v130, v130
    v_exp_f32 v131, v131
    v_exp_f32 v100, v100
    v_exp_f32 v101, v101
    v_smfmac_f32_32x32x32_bf16 v[52:67], v[154:157], v[124:131], v167
    v_exp_f32 v102, v102
    v_exp_f32 v103, v103
    v_exp_f32 v104, v104
    v_mfma_f32_32x32x16_bf16 v[116:131], v[146:149], v[24:27], 0
    v_exp_f32 v105, v105
    v_exp_f32 v106, v106
    v_exp_f32 v107, v107
    v_exp_f32 v108, v108
    v_mfma_f32_32x32x8bf16_1k v[116:131], v[158:159], v[34:35], v[116:131]
    v_exp_f32 v109, v109
    v_exp_f32 v110, v110
    v_exp_f32 v111, v111
    v_exp_f32 v112, v112
    v_smfmac_f32_32x32x32_bf16 v[68:83], v[150:153], v[100:107], v167
    v_exp_f32 v113, v113
    v_exp_f32 v114, v114
    v_exp_f32 v115, v115
    s_nop 3
    v_exp_f32 v116, v116
    v_exp_f32 v117, v117
    v_smfmac_f32_32x32x32_bf16 v[68:83], v[154:157], v[108:115], v167
    v_exp_f32 v118, v118
    v_exp_f32 v119, v119
    v_exp_f32 v120, v120
    s_waitcnt lgkmcnt(0)
    v_mfma_f32_32x32x16_bf16 v[100:115], v[132:135], v[12:15], 0
    v_exp_f32 v121, v121
    v_exp_f32 v122, v122
    v_exp_f32 v123, v123
    v_exp_f32 v124, v124
    v_mfma_f32_32x32x8bf16_1k v[100:115], v[144:145], v[28:29], v[100:115]
    v_readfirstlane_b32 s55, v163
    s_sub_u32 s24, s53, 2
    s_cmp_eq_u32 s52, 0
    s_cbranch_scc1 parallel_sum__mha_block__mixer_token_mlp__prompt_kernel_a_s7a
    s_mov_b64 exec, 1
    ds_add_u32 v160, v162
    s_mov_b64 exec, -1
    s_branch parallel_sum__mha_block__mixer_token_mlp__prompt_kernel_a_s7p
parallel_sum__mha_block__mixer_token_mlp__prompt_kernel_a_s7a:
    s_cmp_ge_u32 s39, 16
    s_cbranch_scc1 parallel_sum__mha_block__mixer_token_mlp__prompt_kernel_a_s7p
    s_cmp_ge_u32 s55, s24
    s_cbranch_scc1 parallel_sum__mha_block__mixer_token_mlp__prompt_kernel_a_s7d
    s_mov_b64 exec, 1
    v_mov_b32 v7, s57
    s_mov_b32 s61, 1048576
Lw23:
    ds_read_b32 v8, v7
    s_waitcnt lgkmcnt(0)
    v_readfirstlane_b32 s59, v8
    s_nop 0
    s_cmp_ge_u32 s59, s24
    s_cbranch_scc1 Lw23x
    s_sleep 1
    s_sub_u32 s61, s61, 1
    s_cmp_lg_u32 s61, 0
    s_cbranch_scc1 Lw23
Lw23x:
    s_mov_b64 exec, -1
parallel_sum__mha_block__mixer_token_mlp__prompt_kernel_a_s7d:
    s_mul_i32 s36, s37, 2560
    s_add_u32 s36, s36, s23
    s_add_u32 m0, s38, 15360
    s_add_u32 s37, s37, 1
    buffer_load_dwordx4 v4, s[8:11], s36 offen sc1 lds
    buffer_load_dwordx4 v4, s[8:11], s36 offen offset:1024 sc1 lds
    s_mov_b64 exec, s[32:33]
    buffer_load_dwordx4 v4, s[8:11], s36 offen offset:2048 sc1 lds
    s_mov_b64 exec, -1
    s_and_b32 s37, s37, 15
    s_add_u32 s39, s39, 1
parallel_sum__mha_block__mixer_token_mlp__prompt_kernel_a_s7p:
    s_cmp_eq_u32 s26, 1
    s_cbranch_scc1 parallel_sum__mha_block__mixer_token_mlp__prompt_kernel_a_s7q
    s_cmp_ge_u32 s55, s53
    s_setprio 2
    s_cbranch_scc1 parallel_sum__mha_block__mixer_token_mlp__prompt_kernel_a_s7e
    s_setprio 0
    s_branch parallel_sum__mha_block__mixer_token_mlp__prompt_kernel_a_s7e
parallel_sum__mha_block__mixer_token_mlp__prompt_kernel_a_s7q:
    s_cmp_ge_u32 s55, s53
    s_setprio 1
    s_cbranch_scc1 parallel_sum__mha_block__mixer_token_mlp__prompt_kernel_a_s7e
    s_setprio 0
parallel_sum__mha_block__mixer_token_mlp__prompt_kernel_a_s7e:
    s_add_u32 s53, s53, 1
    v_exp_f32 v125, v125
    v_exp_f32 v126, v126
    v_exp_f32 v127, v127
    v_exp_f32 v128, v128
    v_smfmac_f32_32x32x32_bf16 v[84:99], v[150:153], v[116:123], v167
    s_sub_u32 s26, s26, 1
    s_cmp_lg_u32 s26, 0
    v_exp_f32 v129, v129
    v_exp_f32 v130, v130
    v_exp_f32 v131, v131
    s_cbranch_scc1 parallel_sum__mha_block__mixer_token_mlp__prompt_kernel_a_loop
    s_nop 0
    v_smfmac_f32_32x32x32_bf16 v[84:99], v[154:157], v[124:131], v167
    s_setprio 3
    s_mov_b64 exec, 1
    v_mov_b32 v7, s57
    s_mov_b32 s61, 1048576
Lw24:
    ds_read_b32 v8, v7
    s_waitcnt lgkmcnt(0)
    v_readfirstlane_b32 s59, v8
    s_nop 0
    s_cmp_ge_u32 s59, s41
    s_cbranch_scc1 Lw24x
    s_sleep 1
    s_sub_u32 s61, s61, 1
    s_cmp_lg_u32 s61, 0
    s_cbranch_scc1 Lw24
Lw24x:
    s_mov_b64 exec, -1
    ds_write_b128 v164, v[52:55] offset:0
    ds_write_b128 v164, v[56:59] offset:1024
    ds_write_b128 v164, v[60:63] offset:2048
    ds_write_b128 v164, v[68:71] offset:3072
    ds_write_b128 v164, v[72:75] offset:4096
    ds_write_b128 v164, v[76:79] offset:5120
    ds_write_b128 v164, v[84:87] offset:6144
    ds_write_b128 v164, v[88:91] offset:7168
    ds_write_b128 v164, v[92:95] offset:8192
    s_xor_b32 s25, s20, 1
    s_mul_i32 s24, s25, 20480
    s_cmp_eq_u32 s25, 3
    s_cselect_b32 s24, 143360, s24
    s_add_u32 s24, s24, s48
    v_add_u32 v161, s24, v4
    s_xor_b32 s25, s20, 2
    s_mul_i32 s24, s25, 20480
    s_cmp_eq_u32 s25, 3
    s_cselect_b32 s24, 143360, s24
    s_add_u32 s24, s24, s48
    v_add_u32 v162, s24, v4
    s_xor_b32 s25, s20, 3
    s_mul_i32 s24, s25, 20480
    s_cmp_eq_u32 s25, 3
    s_cselect_b32 s24, 143360, s24
    s_add_u32 s24, s24, s48
    v_add_u32 v163, s24, v4
    s_lshl_b32 s26, s22, 2
    s_add_u32 s26, s26, s20
    s_lshl_b32 s26, s26, 8
    s_lshl_b32 s37, s21, 14
    s_add_u32 s37, s37, s26
    s_add_u32 s37, s37, 14811136
    s_lshl_b32 s27, s21, 16
    s_lshl_b32 s26, s26, 1
    s_add_u32 s27, s27, s26
    s_add_u32 s27, s27, 12713984
    s_mov_b64 exec, 1
    v_mov_b32 v7, s50
    v_mov_b32 v8, 1
    ds_add_u32 v7, v8
    s_mov_b64 exec, -1
    s_add_u32 s60, s60, 4
    s_mov_b64 exec, 1
    v_mov_b32 v7, s50
    s_mov_b32 s61, 1048576
Lw25:
    ds_read_b32 v8, v7
    s_waitcnt lgkmcnt(0)
    v_readfirstlane_b32 s59, v8
    s_nop 0
    s_cmp_ge_u32 s59, s60
    s_cbranch_scc1 Lw25x
    s_sleep 1
    s_sub_u32 s61, s61, 1
    s_cmp_lg_u32 s61, 0
    s_cbranch_scc1 Lw25
Lw25x:
    s_mov_b64 exec, -1
    ds_read_b128 v[60:63], v161 offset:2048
    ds_read_b128 v[52:55], v161 offset:0
    ds_read_b128 v[56:59], v161 offset:1024
    ds_read_b128 v[76:79], v162 offset:5120
    ds_read_b128 v[68:71], v162 offset:3072
    ds_read_b128 v[72:75], v162 offset:4096
    ds_read_b128 v[92:95], v163 offset:8192
    ds_read_b128 v[84:87], v163 offset:6144
    ds_read_b128 v[88:91], v163 offset:7168
    s_mov_b64 exec, 1
    v_mov_b32 v7, 141776
    v_mov_b32 v8, 1
    ds_add_u32 v7, v8
    s_mov_b64 exec, -1
    s_waitcnt lgkmcnt(7)
    v_add_f32 v36, v36, v52
    v_add_f32 v37, v37, v53
    v_add_f32 v38, v38, v54
    v_add_f32 v39, v39, v55
    v_add_f32 v40, v40, v56
    v_add_f32 v41, v41, v57
    v_add_f32 v42, v42, v58
    v_add_f32 v43, v43, v59
    v_add_f32 v44, v44, v60
    v_add_f32 v45, v45, v61
    v_add_f32 v46, v46, v62
    v_add_f32 v47, v47, v63
    s_waitcnt lgkmcnt(4)
    v_add_f32 v36, v36, v68
    v_add_f32 v37, v37, v69
    v_add_f32 v38, v38, v70
    v_add_f32 v39, v39, v71
    v_add_f32 v40, v40, v72
    v_add_f32 v41, v41, v73
    v_add_f32 v42, v42, v74
    v_add_f32 v43, v43, v75
    v_add_f32 v44, v44, v76
    v_add_f32 v45, v45, v77
    v_add_f32 v46, v46, v78
    v_add_f32 v47, v47, v79
    s_waitcnt lgkmcnt(1)
    v_add_f32 v36, v36, v84
    v_add_f32 v37, v37, v85
    v_add_f32 v38, v38, v86
    v_add_f32 v39, v39, v87
    v_add_f32 v40, v40, v88
    v_add_f32 v41, v41, v89
    v_add_f32 v42, v42, v90
    v_add_f32 v43, v43, v91
    v_add_f32 v44, v44, v92
    v_add_f32 v45, v45, v93
    v_add_f32 v46, v46, v94
    v_add_f32 v47, v47, v95
    v_mov_b32 v9, v44
    v_mov_b32 v10, v44
    s_nop 1
    v_permlane32_swap_b32 v9, v10
    v_add_f32 v9, |v36|, |v37|
    v_add_f32 v9, v9, |v38|
    v_add_f32 v9, v9, |v39|
    v_add_f32 v9, v9, |v40|
    v_add_f32 v9, v9, |v41|
    v_add_f32 v9, v9, |v42|
    v_add_f32 v9, v9, |v43|
    v_add_f32 v9, v9, |v44|
    v_add_f32 v9, v9, |v45|
    v_add_f32 v9, v9, |v46|
    v_add_f32 v9, v9, |v47|
    v_mov_b32 v11, 0x7f000000
    v_cmp_nlt_f32 vcc, v9, v11
    s_nop 0
    s_mov_b64 s[42:43], vcc
    v_mov_b32 v11, 0x71800000
    v_cmp_nle_f32 vcc, v10, v11
    s_nop 0
    s_or_b64 s[42:43], s[42:43], vcc
    v_cmp_nge_f32 vcc, v10, 0.5
    s_nop 0
    s_or_b64 s[42:43], s[42:43], vcc
    s_cbranch_scc1 parallel_sum__mha_block__mixer_token_mlp__prompt_kernel_a_fallback
parallel_sum__mha_block__mixer_token_mlp__prompt_kernel_a_fin:
    v_rcp_f32 v10, v10
    v_lshlrev_b32 v7, 4, v2
    v_lshl_add_u32 v8, v3, 15, v7
    v_mul_f32 v36, v36, v10
    v_mul_f32 v37, v37, v10
    v_mul_f32 v38, v38, v10
    v_mul_f32 v39, v39, v10
    v_mul_f32 v40, v40, v10
    v_mul_f32 v41, v41, v10
    v_mul_f32 v42, v42, v10
    v_mul_f32 v43, v43, v10
    v_mul_f32 v44, v44, v10
    v_mul_f32 v45, v45, v10
    v_mul_f32 v46, v46, v10
    v_mul_f32 v47, v47, v10
    v_cvt_pk_bf16_f32 v36, v36, v37
    v_cvt_pk_bf16_f32 v37, v38, v39
    v_cvt_pk_bf16_f32 v38, v40, v41
    v_cvt_pk_bf16_f32 v39, v42, v43
    v_cvt_pk_bf16_f32 v40, v44, v45
    v_cvt_pk_bf16_f32 v41, v46, v47
    buffer_store_dwordx4 v[36:39], v8, s[8:11], s27 offen sc1
    s_mov_b64 exec, s[32:33]
    buffer_store_dwordx2 v[40:41], v5, s[8:11], s37 offen sc1
    s_lshl_b32 s24, s22, 5
    s_add_u32 s24, s24, s21
    s_lshl_b32 s24, s24, 7
    s_add_u32 s24, s24, 21823488
    s_mov_b64 exec, 1
    v_mov_b32 v7, s51
    v_mov_b32 v8, 1
    s_waitcnt vmcnt(0)
    ds_add_rtn_u32 v7, v7, v8
    s_waitcnt lgkmcnt(0)
    v_readfirstlane_b32 s59, v7
    s_nop 0
    s_cmp_lg_u32 s59, 3
    s_cbranch_scc1 Lp26
    v_mov_b32 v7, 0
    buffer_store_dword v8, v7, s[8:11], s24 offen sc1
Lp26:
    s_mov_b64 exec, -1
    s_endpgm
parallel_sum__mha_block__mixer_token_mlp__prompt_kernel_a_fallback:
    s_mul_i32 s24, s20, 1280
    s_add_u32 s24, s24, s28
    v_mov_b32 v28, 0
    v_mov_b32 v29, 0
    buffer_load_dwordx2 v[12:13], v5, s[8:11], s24 offen sc1
    buffer_load_dwordx2 v[14:15], v5, s[8:11], s24 offen offset:512 sc1
    s_mov_b64 exec, s[32:33]
    buffer_load_dwordx2 v[28:29], v5, s[8:11], s24 offen offset:1024 sc1
    s_mov_b64 exec, -1
    v_mov_b32 v160, 0xff800000
    s_mov_b32 s36, s40
    s_mov_b32 s26, 64
parallel_sum__mha_block__mixer_token_mlp__prompt_kernel_a_f1:
    buffer_load_dwordx2 v[132:133], v5, s[8:11], s36 offen sc1
    buffer_load_dwordx2 v[134:135], v5, s[8:11], s36 offen offset:512 sc1
    s_mov_b64 exec, s[32:33]
    buffer_load_dwordx2 v[144:145], v5, s[8:11], s36 offen offset:1024 sc1
    s_mov_b64 exec, -1
    s_waitcnt vmcnt(0)
    v_mfma_f32_32x32x16_bf16 v[100:115], v[132:135], v[12:15], 0
    v_mfma_f32_32x32x8bf16_1k v[100:115], v[144:145], v[28:29], v[100:115]
    s_nop 11
    v_max3_f32 v160, v160, v100, v101
    v_max3_f32 v160, v160, v102, v103
    v_max3_f32 v160, v160, v104, v105
    v_max3_f32 v160, v160, v106, v107
    v_max3_f32 v160, v160, v108, v109
    v_max3_f32 v160, v160, v110, v111
    v_max3_f32 v160, v160, v112, v113
    v_max3_f32 v160, v160, v114, v115
    s_add_u32 s36, s36, 2560
    s_sub_u32 s26, s26, 1
    s_cmp_lg_u32 s26, 0
    s_cbranch_scc1 parallel_sum__mha_block__mixer_token_mlp__prompt_kernel_a_f1
    v_mov_b32 v7, v160
    s_nop 1
    v_permlane32_swap_b32 v160, v7
    v_max_f32 v160, v160, v7
    s_mov_b64 exec, s[34:35]
    v_sub_f32 v7, 0, v160
    v_cvt_pk_bf16_f32 v8, v7, v7
    v_and_b32 v9, 0xffff0000, v8
    v_sub_f32 v7, v7, v9
    v_cvt_pk_bf16_f32 v28, v9, v7
    v_and_b32 v9, 0xffff0000, v28
    v_sub_f32 v7, v7, v9
    v_cvt_pk_bf16_f32 v29, v7, 0
    s_mov_b64 exec, -1
    v_mov_b32 v36, 0
    v_mov_b32 v37, 0
    v_mov_b32 v38, 0
    v_mov_b32 v39, 0
    v_mov_b32 v40, 0
    v_mov_b32 v41, 0
    v_mov_b32 v42, 0
    v_mov_b32 v43, 0
    v_mov_b32 v44, 0
    v_mov_b32 v45, 0
    v_mov_b32 v46, 0
    v_mov_b32 v47, 0
    v_mov_b32 v48, 0
    v_mov_b32 v49, 0
    v_mov_b32 v50, 0
    v_mov_b32 v51, 0
    s_mov_b32 s36, s40
    s_mov_b32 s26, 64
    v_mov_b32 v161, v5
parallel_sum__mha_block__mixer_token_mlp__prompt_kernel_a_f2:
    buffer_load_dwordx2 v[132:133], v161, s[8:11], s36 offen sc1
    buffer_load_dwordx2 v[134:135], v161, s[8:11], s36 offen offset:512 sc1
    s_mov_b64 exec, s[32:33]
    buffer_load_dwordx2 v[144:145], v161, s[8:11], s36 offen offset:1024 sc1
    s_mov_b64 exec, -1
    s_mov_b64 exec, s[30:31]
    buffer_load_dwordx4 v[136:139], v6, s[8:11], s36 offen offset:1280 sc1
    buffer_load_dwordx4 v[140:143], v6, s[8:11], s36 offen offset:1920 sc1
    s_mov_b64 exec, -1
    s_waitcnt vmcnt(0)
    v_mfma_f32_32x32x16_bf16 v[100:115], v[132:135], v[12:15], 0
    v_mfma_f32_32x32x8bf16_1k v[100:115], v[144:145], v[28:29], v[100:115]
    s_nop 11
    v_exp_f32 v100, v100
    v_exp_f32 v101, v101
    v_exp_f32 v102, v102
    v_exp_f32 v103, v103
    v_exp_f32 v104, v104
    v_exp_f32 v105, v105
    v_exp_f32 v106, v106
    v_exp_f32 v107, v107
    v_exp_f32 v108, v108
    v_exp_f32 v109, v109
    v_exp_f32 v110, v110
    v_exp_f32 v111, v111
    v_exp_f32 v112, v112
    v_exp_f32 v113, v113
    v_exp_f32 v114, v114
    v_exp_f32 v115, v115
    v_smfmac_f32_32x32x32_bf16 v[36:51], v[136:139], v[100:107], v167
    s_nop 0
    v_smfmac_f32_32x32x32_bf16 v[36:51], v[140:143], v[108:115], v167
    s_add_u32 s36, s36, 2560
    s_sub_u32 s26, s26, 1
    s_cmp_lg_u32 s26, 0
    s_cbranch_scc1 parallel_sum__mha_block__mixer_token_mlp__prompt_kernel_a_f2
    s_nop 15
    v_mov_b32 v9, v44
    v_mov_b32 v10, v44
    s_nop 1
    v_permlane32_swap_b32 v9, v10
    s_branch parallel_sum__mha_block__mixer_token_mlp__prompt_kernel_a_fin
parallel_sum__mha_block__mixer_token_mlp__prompt_kernel_gemm:
    s_setprio 0
    s_load_dwordx2 s[6:7], s[0:1], 32
    s_load_dwordx2 s[38:39], s[0:1], 40
    s_load_dwordx2 s[42:43], s[0:1], 48
    s_load_dwordx2 s[52:53], s[0:1], 0
    s_load_dwordx4 s[48:51], s[0:1], 56
    s_mov_b32 s8, s36
    s_and_b32 s9, s37, 0xffff
    s_mov_b32 s10, 24117248
    s_mov_b32 s11, 0x00020000
    s_mov_b32 s35, s2
    s_mov_b32 s41, 0
    s_add_u32 s2, s2, 512
    v_bfe_u32 v7, v0, 4, 2
    v_mul_u32_u24 v1, 10240, v7
    v_and_b32 v7, 15, v0
    v_lshl_add_u32 v1, v7, 4, v1
    s_mul_i32 s28, s20, 16384
    s_add_u32 s28, s28, 65536
    s_cmp_ge_u32 s35, 216
    s_cbranch_scc1 parallel_sum__mha_block__mixer_token_mlp__prompt_kernel_m_skip1
    s_and_b32 s24, s35, 7
    s_lshr_b32 s23, s35, 3
    s_lshr_b32 s21, s24, 1
    s_mul_i32 s21, s21, 27
    s_add_u32 s23, s23, s21
    s_lshr_b32 s22, s23, 2
    s_and_b32 s23, s23, 3
    s_and_b32 s21, s24, 1
    s_lshl_b32 s21, s21, 2
    s_add_u32 s21, s21, s23
    s_lshl_b32 s31, s23, 2
    s_mul_i32 s23, s22, 5
    s_lshr_b32 s23, s23, 1
    s_add_u32 s31, s31, s23
    s_and_b32 s31, s31, 0
    s_mov_b32 s32, s31
    s_mov_b32 s33, 16
    s_mul_i32 s29, s20, 655360
    s_mul_i32 s23, s21, 1280
    s_add_u32 s29, s29, s23
    s_add_u32 s29, s29, 7864320
    v_bfe_u32 v7, v0, 5, 1
    v_bfe_u32 v8, v0, 3, 2
    v_lshl_add_u32 v7, v7, 3, v8
    v_mul_u32_u24 v2, 3456, v7
    v_bfe_u32 v7, v0, 4, 2
    v_lshlrev_b32 v7, 1, v7
    v_and_b32 v8, 7, v0
    v_xor_b32 v7, v7, v8
    v_lshl_add_u32 v2, v7, 4, v2
    s_mul_i32 s30, s20, 1769472
    s_lshl_b32 s23, s22, 7
    s_add_u32 s30, s30, s23
    v_bfe_u32 v7, v0, 2, 4
    v_lshlrev_b32 v3, 7, v7
    v_bfe_u32 v7, v0, 3, 2
    v_xor_b32 v7, s20, v7
    v_lshl_add_u32 v3, v7, 5, v3
    v_and_b32 v7, 3, v0
    v_lshl_add_u32 v3, v7, 3, v3
    v_add_u32 v3, s28, v3
    v_xor_b32 v4, 32, v3
    v_xor_b32 v5, 64, v3
    v_xor_b32 v6, 96, v3
    s_waitcnt lgkmcnt(0)
    s_mov_b32 s12, s6
    s_and_b32 s13, s7, 0xffff
    s_mov_b32 s14, 7077888
    s_mov_b32 s15, 0x00020000
    s_mov_b32 s16, s38
    s_and_b32 s17, s39, 0xffff
    s_mov_b32 s18, 3456
    s_mov_b32 s19, 0x00020000
    s_setprio 0
    s_lshl_b32 s23, s20, 5
    s_lshl_b32 s24, s22, 7
    s_add_u32 s23, s23, s24
    v_bfe_u32 v7, v0, 4, 2
    v_lshlrev_b32 v7, 3, v7
    buffer_load_dwordx2 v[10:11], v7, s[16:19], s23 offen
    s_waitcnt vmcnt(0)
    v_lshlrev_b32 v12, 16, v10
    v_and_b32 v13, 0xffff0000, v10
    v_lshlrev_b32 v14, 16, v11
    v_and_b32 v15, 0xffff0000, v11
    v_lshlrev_b32 v16, 16, v10
    v_and_b32 v17, 0xffff0000, v10
    v_lshlrev_b32 v18, 16, v11
    v_and_b32 v19, 0xffff0000, v11
    v_lshlrev_b32 v20, 16, v10
    v_and_b32 v21, 0xffff0000, v10
    v_lshlrev_b32 v22, 16, v11
    v_and_b32 v23, 0xffff0000, v11
    v_lshlrev_b32 v24, 16, v10
    v_and_b32 v25, 0xffff0000, v10
    v_lshlrev_b32 v26, 16, v11
    v_and_b32 v27, 0xffff0000, v11
    v_lshlrev_b32 v28, 16, v10
    v_and_b32 v29, 0xffff0000, v10
    v_lshlrev_b32 v30, 16, v11
    v_and_b32 v31, 0xffff0000, v11
    s_lshl_b32 s23, s20, 13
    s_add_u32 s23, s23, 21757952
    s_setprio 3
    s_mov_b64 exec, 1
    v_mov_b32 v164, 141772
    s_mov_b32 s61, 1048576
Lw27:
    ds_read_b32 v165, v164
    s_waitcnt lgkmcnt(0)
    v_readfirstlane_b32 s59, v165
    s_nop 0
    s_cmp_ge_u32 s59, 1
    s_cbranch_scc1 Lw27x
    s_sleep 1
    s_sub_u32 s61, s61, 1
    s_cmp_lg_u32 s61, 0
    s_cbranch_scc1 Lw27
Lw27x:
    s_mov_b64 exec, -1
    v_and_b32 v164, 63, v0
    v_lshlrev_b32 v164, 7, v164
    s_mov_b32 exec_lo, 0xffffffff
    s_mov_b32 exec_hi, 0xffffffff
    s_mov_b32 s61, 262144
Lg28:
    buffer_load_dword v165, v164, s[8:11], s23 offen sc1
    s_waitcnt vmcnt(0)
    v_cmp_gt_u32 vcc, 1, v165
    s_nop 4
    s_cbranch_vccz Lg28x
    s_sleep 2
    s_sub_u32 s61, s61, 1
    s_cmp_lg_u32 s61, 0
    s_cbranch_scc1 Lg28
Lg28x:
    s_mov_b64 exec, -1
    s_setprio 0
    s_mov_b64 exec, 1
    v_mov_b32 v164, 141764
    v_mov_b32 v165, 1
    ds_add_u32 v164, v165
    s_mov_b64 exec, -1
    s_add_u32 s60, s60, 4
    s_mov_b64 exec, 1
    v_mov_b32 v164, 141764
    s_mov_b32 s61, 1048576
Lw29:
    ds_read_b32 v165, v164
    s_waitcnt lgkmcnt(0)
    v_readfirstlane_b32 s59, v165
    s_nop 0
    s_cmp_ge_u32 s59, s60
    s_cbranch_scc1 Lw29x
    s_sleep 1
    s_sub_u32 s61, s61, 1
    s_cmp_lg_u32 s61, 0
    s_cbranch_scc1 Lw29
Lw29x:
    s_mov_b64 exec, -1
    s_mov_b64 exec, 1
    v_mov_b32 v164, 141800
    s_mov_b32 s61, 1048576
Lw30:
    ds_read_b32 v165, v164
    s_waitcnt lgkmcnt(0)
    v_readfirstlane_b32 s59, v165
    s_nop 0
    s_cmp_ge_u32 s59, 8
    s_cbranch_scc1 Lw30x
    s_sleep 1
    s_sub_u32 s61, s61, 1
    s_cmp_lg_u32 s61, 0
    s_cbranch_scc1 Lw30
Lw30x:
    s_mov_b64 exec, -1
    s_mul_i32 s27, s31, 110592
    s_add_u32 s27, s27, s30
    s_add_u32 s31, s31, 1
    s_cmp_eq_u32 s31, s33
    s_cselect_b32 s31, 0, s31
    s_add_u32 m0, s28, 0
    s_nop 0
    buffer_load_dwordx4 v2, s[12:15], s27 offen  lds
    s_add_u32 m0, s28, 1024
    s_add_u32 s34, s27, 55296
    buffer_load_dwordx4 v2, s[12:15], s34 offen  lds
    s_add_u32 m0, s28, 2048
    s_add_u32 s34, s27, 13824
    buffer_load_dwordx4 v2, s[12:15], s34 offen  lds
    s_add_u32 m0, s28, 3072
    s_add_u32 s34, s27, 69120
    buffer_load_dwordx4 v2, s[12:15], s34 offen  lds
    s_mul_i32 s26, s32, 40960
    s_add_u32 s26, s26, s29
    s_add_u32 s32, s32, 1
    s_cmp_eq_u32 s32, s33
    s_cselect_b32 s32, 0, s32
    buffer_load_dwordx4 v[124:127], v1, s[8:11], s26 offen offset:0 sc1
    buffer_load_dwordx4 v[128:131], v1, s[8:11], s26 offen offset:256 sc1
    buffer_load_dwordx4 v[132:135], v1, s[8:11], s26 offen offset:512 sc1
    buffer_load_dwordx4 v[136:139], v1, s[8:11], s26 offen offset:768 sc1
    buffer_load_dwordx4 v[140:143], v1, s[8:11], s26 offen offset:1024 sc1
    s_mul_i32 s27, s31, 110592
    s_add_u32 s27, s27, s30
    s_add_u32 s31, s31, 1
    s_cmp_eq_u32 s31, s33
    s_cselect_b32 s31, 0, s31
    s_add_u32 m0, s28, 4096
    s_nop 0
    buffer_load_dwordx4 v2, s[12:15], s27 offen  lds
    s_add_u32 m0, s28, 5120
    s_add_u32 s34, s27, 55296
    buffer_load_dwordx4 v2, s[12:15], s34 offen  lds
    s_add_u32 m0, s28, 6144
    s_add_u32 s34, s27, 13824
    buffer_load_dwordx4 v2, s[12:15], s34 offen  lds
    s_add_u32 m0, s28, 7168
    s_add_u32 s34, s27, 69120
    buffer_load_dwordx4 v2, s[12:15], s34 offen  lds
    s_mul_i32 s26, s32, 40960
    s_add_u32 s26, s26, s29
    s_add_u32 s32, s32, 1
    s_cmp_eq_u32 s32, s33
    s_cselect_b32 s32, 0, s32
    buffer_load_dwordx4 v[144:147], v1, s[8:11], s26 offen offset:0 sc1
    buffer_load_dwordx4 v[148:151], v1, s[8:11], s26 offen offset:256 sc1
    buffer_load_dwordx4 v[152:155], v1, s[8:11], s26 offen offset:512 sc1
    buffer_load_dwordx4 v[156:159], v1, s[8:11], s26 offen offset:768 sc1
    buffer_load_dwordx4 v[160:163], v1, s[8:11], s26 offen offset:1024 sc1
    s_mul_i32 s27, s31, 110592
    s_add_u32 s27, s27, s30
    s_add_u32 s31, s31, 1
    s_cmp_eq_u32 s31, s33
    s_cselect_b32 s31, 0, s31
    s_add_u32 m0, s28, 8192
    s_nop 0
    buffer_load_dwordx4 v2, s[12:15], s27 offen  lds
    s_add_u32 m0, s28, 9216
    s_add_u32 s34, s27, 55296
    buffer_load_dwordx4 v2, s[12:15], s34 offen  lds
    s_add_u32 m0, s28, 10240
    s_add_u32 s34, s27, 13824
    buffer_load_dwordx4 v2, s[12:15], s34 offen  lds
    s_add_u32 m0, s28, 11264
    s_add_u32 s34, s27, 69120
    buffer_load_dwordx4 v2, s[12:15], s34 offen  lds
    s_mul_i32 s27, s31, 110592
    s_add_u32 s27, s27, s30
    s_add_u32 s31, s31, 1
    s_cmp_eq_u32 s31, s33
    s_cselect_b32 s31, 0, s31
    s_add_u32 m0, s28, 12288
    s_nop 0
    buffer_load_dwordx4 v2, s[12:15], s27 offen  lds
    s_add_u32 m0, s28, 13312
    s_add_u32 s34, s27, 55296
    buffer_load_dwordx4 v2, s[12:15], s34 offen  lds
    s_add_u32 m0, s28, 14336
    s_add_u32 s34, s27, 13824
    buffer_load_dwordx4 v2, s[12:15], s34 offen  lds
    s_add_u32 m0, s28, 15360
    s_add_u32 s34, s27, 69120
    buffer_load_dwordx4 v2, s[12:15], s34 offen  lds
    s_setprio 1
    s_waitcnt vmcnt(22)
    ds_read_b64_tr_b16 v[92:93], v3 offset:0
    ds_read_b64_tr_b16 v[94:95], v3 offset:2048
    ds_read_b64_tr_b16 v[96:97], v4 offset:0
    ds_read_b64_tr_b16 v[98:99], v4 offset:2048
    ds_read_b64_tr_b16 v[100:101], v5 offset:0
    ds_read_b64_tr_b16 v[102:103], v5 offset:2048
    ds_read_b64_tr_b16 v[104:105], v6 offset:0
    ds_read_b64_tr_b16 v[106:107], v6 offset:2048
    s_waitcnt lgkmcnt(0)
    s_mul_i32 s27, s31, 110592
    s_add_u32 s27, s27, s30
    s_add_u32 s31, s31, 1
    s_cmp_eq_u32 s31, s33
    s_cselect_b32 s31, 0, s31
    s_add_u32 m0, s28, 0
    s_nop 0
    buffer_load_dwordx4 v2, s[12:15], s27 offen  lds
    s_add_u32 m0, s28, 1024
    s_add_u32 s34, s27, 55296
    buffer_load_dwordx4 v2, s[12:15], s34 offen  lds
    s_add_u32 m0, s28, 2048
    s_add_u32 s34, s27, 13824
    buffer_load_dwordx4 v2, s[12:15], s34 offen  lds
    s_add_u32 m0, s28, 3072
    s_add_u32 s34, s27, 69120
    buffer_load_dwordx4 v2, s[12:15], s34 offen  lds
    s_waitcnt vmcnt(17) lgkmcnt(0)
    s_mul_i32 s26, s32, 40960
    s_add_u32 s26, s26, s29
    s_add_u32 s32, s32, 1
    s_cmp_eq_u32 s32, s33
    s_cselect_b32 s32, 0, s32
    v_mfma_f32_16x16x32_bf16 v[12:15], v[92:95], v[124:127], v[12:15]
    ds_read_b64_tr_b16 v[108:109], v3 offset:4096
    ds_read_b64_tr_b16 v[110:111], v3 offset:6144
    v_mfma_f32_16x16x32_bf16 v[32:35], v[96:99], v[124:127], 0
    ds_read_b64_tr_b16 v[112:113], v4 offset:4096
    ds_read_b64_tr_b16 v[114:115], v4 offset:6144
    v_mfma_f32_16x16x32_bf16 v[52:55], v[100:103], v[124:127], 0
    ds_read_b64_tr_b16 v[116:117], v5 offset:4096
    ds_read_b64_tr_b16 v[118:119], v5 offset:6144
    v_mfma_f32_16x16x32_bf16 v[72:75], v[104:107], v[124:127], 0
    ds_read_b64_tr_b16 v[120:121], v6 offset:4096
    ds_read_b64_tr_b16 v[122:123], v6 offset:6144
    buffer_load_dwordx4 v[124:127], v1, s[8:11], s26 offen offset:0 sc1
    s_waitcnt vmcnt(18)
    v_mfma_f32_16x16x32_bf16 v[16:19], v[92:95], v[128:131], v[16:19]
    v_mfma_f32_16x16x32_bf16 v[36:39], v[96:99], v[128:131], 0
    v_mfma_f32_16x16x32_bf16 v[56:59], v[100:103], v[128:131], 0
    v_mfma_f32_16x16x32_bf16 v[76:79], v[104:107], v[128:131], 0
    buffer_load_dwordx4 v[128:131], v1, s[8:11], s26 offen offset:256 sc1
    s_waitcnt vmcnt(19)
    s_waitcnt lgkmcnt(0)
    s_mul_i32 s27, s31, 110592
    s_add_u32 s27, s27, s30
    s_add_u32 s31, s31, 1
    s_cmp_eq_u32 s31, s33
    s_cselect_b32 s31, 0, s31
    v_mfma_f32_16x16x32_bf16 v[20:23], v[92:95], v[132:135], v[20:23]
    v_mfma_f32_16x16x32_bf16 v[40:43], v[96:99], v[132:135], 0
    s_add_u32 m0, s28, 4096
    s_nop 0
    buffer_load_dwordx4 v2, s[12:15], s27 offen  lds
    v_mfma_f32_16x16x32_bf16 v[60:63], v[100:103], v[132:135], 0
    v_mfma_f32_16x16x32_bf16 v[80:83], v[104:107], v[132:135], 0
    buffer_load_dwordx4 v[132:135], v1, s[8:11], s26 offen offset:512 sc1
    s_waitcnt vmcnt(21)
    v_mfma_f32_16x16x32_bf16 v[24:27], v[92:95], v[136:139], v[24:27]
    s_add_u32 m0, s28, 5120
    s_add_u32 s34, s27, 55296
    buffer_load_dwordx4 v2, s[12:15], s34 offen  lds
    v_mfma_f32_16x16x32_bf16 v[44:47], v[96:99], v[136:139], 0
    v_mfma_f32_16x16x32_bf16 v[64:67], v[100:103], v[136:139], 0
    s_add_u32 m0, s28, 6144
    s_add_u32 s34, s27, 13824
    buffer_load_dwordx4 v2, s[12:15], s34 offen  lds
    v_mfma_f32_16x16x32_bf16 v[84:87], v[104:107], v[136:139], 0
    buffer_load_dwordx4 v[136:139], v1, s[8:11], s26 offen offset:768 sc1
    s_waitcnt vmcnt(24)
    v_mfma_f32_16x16x32_bf16 v[28:31], v[92:95], v[140:143], v[28:31]
    v_mfma_f32_16x16x32_bf16 v[48:51], v[96:99], v[140:143], 0
    s_add_u32 m0, s28, 7168
    s_add_u32 s34, s27, 69120
    buffer_load_dwordx4 v2, s[12:15], s34 offen  lds
    v_mfma_f32_16x16x32_bf16 v[68:71], v[100:103], v[140:143], 0
    v_mfma_f32_16x16x32_bf16 v[88:91], v[104:107], v[140:143], 0
    buffer_load_dwordx4 v[140:143], v1, s[8:11], s26 offen offset:1024 sc1
    s_waitcnt vmcnt(17) lgkmcnt(0)
    s_mul_i32 s26, s32, 40960
    s_add_u32 s26, s26, s29
    s_add_u32 s32, s32, 1
    s_cmp_eq_u32 s32, s33
    s_cselect_b32 s32, 0, s32
    v_mfma_f32_16x16x32_bf16 v[12:15], v[108:111], v[144:147], v[12:15]
    ds_read_b64_tr_b16 v[92:93], v3 offset:8192
    ds_read_b64_tr_b16 v[94:95], v3 offset:10240
    v_mfma_f32_16x16x32_bf16 v[32:35], v[112:115], v[144:147], v[32:35]
    ds_read_b64_tr_b16 v[96:97], v4 offset:8192
    ds_read_b64_tr_b16 v[98:99], v4 offset:10240
    v_mfma_f32_16x16x32_bf16 v[52:55], v[116:119], v[144:147], v[52:55]
    ds_read_b64_tr_b16 v[100:101], v5 offset:8192
    ds_read_b64_tr_b16 v[102:103], v5 offset:10240
    v_mfma_f32_16x16x32_bf16 v[72:75], v[120:123], v[144:147], v[72:75]
    ds_read_b64_tr_b16 v[104:105], v6 offset:8192
    ds_read_b64_tr_b16 v[106:107], v6 offset:10240
    buffer_load_dwordx4 v[144:147], v1, s[8:11], s26 offen offset:0 sc1
    s_waitcnt vmcnt(18)
    v_mfma_f32_16x16x32_bf16 v[16:19], v[108:111], v[148:151], v[16:19]
    v_mfma_f32_16x16x32_bf16 v[36:39], v[112:115], v[148:151], v[36:39]
    v_mfma_f32_16x16x32_bf16 v[56:59], v[116:119], v[148:151], v[56:59]
    v_mfma_f32_16x16x32_bf16 v[76:79], v[120:123], v[148:151], v[76:79]
    buffer_load_dwordx4 v[148:151], v1, s[8:11], s26 offen offset:256 sc1
    s_waitcnt vmcnt(19)
    s_waitcnt lgkmcnt(0)
    s_mul_i32 s27, s31, 110592
    s_add_u32 s27, s27, s30
    s_add_u32 s31, s31, 1
    s_cmp_eq_u32 s31, s33
    s_cselect_b32 s31, 0, s31
    v_mfma_f32_16x16x32_bf16 v[20:23], v[108:111], v[152:155], v[20:23]
    v_mfma_f32_16x16x32_bf16 v[40:43], v[112:115], v[152:155], v[40:43]
    s_add_u32 m0, s28, 8192
    s_nop 0
    buffer_load_dwordx4 v2, s[12:15], s27 offen  lds
    v_mfma_f32_16x16x32_bf16 v[60:63], v[116:119], v[152:155], v[60:63]
    v_mfma_f32_16x16x32_bf16 v[80:83], v[120:123], v[152:155], v[80:83]
    buffer_load_dwordx4 v[152:155], v1, s[8:11], s26 offen offset:512 sc1
    s_waitcnt vmcnt(21)
    v_mfma_f32_16x16x32_bf16 v[24:27], v[108:111], v[156:159], v[24:27]
    s_add_u32 m0, s28, 9216
    s_add_u32 s34, s27, 55296
    buffer_load_dwordx4 v2, s[12:15], s34 offen  lds
    v_mfma_f32_16x16x32_bf16 v[44:47], v[112:115], v[156:159], v[44:47]
    v_mfma_f32_16x16x32_bf16 v[64:67], v[116:119], v[156:159], v[64:67]
    s_add_u32 m0, s28, 10240
    s_add_u32 s34, s27, 13824
    buffer_load_dwordx4 v2, s[12:15], s34 offen  lds
    v_mfma_f32_16x16x32_bf16 v[84:87], v[120:123], v[156:159], v[84:87]
    buffer_load_dwordx4 v[156:159], v1, s[8:11], s26 offen offset:768 sc1
    s_waitcnt vmcnt(24)
    v_mfma_f32_16x16x32_bf16 v[28:31], v[108:111], v[160:163], v[28:31]
    v_mfma_f32_16x16x32_bf16 v[48:51], v[112:115], v[160:163], v[48:51]
    s_add_u32 m0, s28, 11264
    s_add_u32 s34, s27, 69120
    buffer_load_dwordx4 v2, s[12:15], s34 offen  lds
    v_mfma_f32_16x16x32_bf16 v[68:71], v[116:119], v[160:163], v[68:71]
    v_mfma_f32_16x16x32_bf16 v[88:91], v[120:123], v[160:163], v[88:91]
    buffer_load_dwordx4 v[160:163], v1, s[8:11], s26 offen offset:1024 sc1
    s_waitcnt vmcnt(17) lgkmcnt(0)
    s_mul_i32 s26, s32, 40960
    s_add_u32 s26, s26, s29
    s_add_u32 s32, s32, 1
    s_cmp_eq_u32 s32, s33
    s_cselect_b32 s32, 0, s32
    v_mfma_f32_16x16x32_bf16 v[12:15], v[92:95], v[124:127], v[12:15]
    ds_read_b64_tr_b16 v[108:109], v3 offset:12288
    ds_read_b64_tr_b16 v[110:111], v3 offset:14336
    v_mfma_f32_16x16x32_bf16 v[32:35], v[96:99], v[124:127], v[32:35]
    ds_read_b64_tr_b16 v[112:113], v4 offset:12288
    ds_read_b64_tr_b16 v[114:115], v4 offset:14336
    v_mfma_f32_16x16x32_bf16 v[52:55], v[100:103], v[124:127], v[52:55]
    ds_read_b64_tr_b16 v[116:117], v5 offset:12288
    ds_read_b64_tr_b16 v[118:119], v5 offset:14336
    v_mfma_f32_16x16x32_bf16 v[72:75], v[104:107], v[124:127], v[72:75]
    ds_read_b64_tr_b16 v[120:121], v6 offset:12288
    ds_read_b64_tr_b16 v[122:123], v6 offset:14336
    buffer_load_dwordx4 v[124:127], v1, s[8:11], s26 offen offset:0 sc1
    s_waitcnt vmcnt(17)
    v_mfma_f32_16x16x32_bf16 v[16:19], v[92:95], v[128:131], v[16:19]
    v_mfma_f32_16x16x32_bf16 v[36:39], v[96:99], v[128:131], v[36:39]
    v_mfma_f32_16x16x32_bf16 v[56:59], v[100:103], v[128:131], v[56:59]
    v_mfma_f32_16x16x32_bf16 v[76:79], v[104:107], v[128:131], v[76:79]
    buffer_load_dwordx4 v[128:131], v1, s[8:11], s26 offen offset:256 sc1
    s_waitcnt vmcnt(16)
    s_waitcnt lgkmcnt(0)
    s_mul_i32 s27, s31, 110592
    s_add_u32 s27, s27, s30
    s_add_u32 s31, s31, 1
    s_cmp_eq_u32 s31, s33
    s_cselect_b32 s31, 0, s31
    v_mfma_f32_16x16x32_bf16 v[20:23], v[92:95], v[132:135], v[20:23]
    v_mfma_f32_16x16x32_bf16 v[40:43], v[96:99], v[132:135], v[40:43]
    s_add_u32 m0, s28, 12288
    s_nop 0
    buffer_load_dwordx4 v2, s[12:15], s27 offen  lds
    v_mfma_f32_16x16x32_bf16 v[60:63], v[100:103], v[132:135], v[60:63]
    v_mfma_f32_16x16x32_bf16 v[80:83], v[104:107], v[132:135], v[80:83]
    buffer_load_dwordx4 v[132:135], v1, s[8:11], s26 offen offset:512 sc1
    s_waitcnt vmcnt(15)
    v_mfma_f32_16x16x32_bf16 v[24:27], v[92:95], v[136:139], v[24:27]
    s_add_u32 m0, s28, 13312
    s_add_u32 s34, s27, 55296
    buffer_load_dwordx4 v2, s[12:15], s34 offen  lds
    v_mfma_f32_16x16x32_bf16 v[44:47], v[96:99], v[136:139], v[44:47]
    v_mfma_f32_16x16x32_bf16 v[64:67], v[100:103], v[136:139], v[64:67]
    s_add_u32 m0, s28, 14336
    s_add_u32 s34, s27, 13824
    buffer_load_dwordx4 v2, s[12:15], s34 offen  lds
    v_mfma_f32_16x16x32_bf16 v[84:87], v[104:107], v[136:139], v[84:87]
    buffer_load_dwordx4 v[136:139], v1, s[8:11], s26 offen offset:768 sc1
    s_waitcnt vmcnt(16)
    v_mfma_f32_16x16x32_bf16 v[28:31], v[92:95], v[140:143], v[28:31]
    v_mfma_f32_16x16x32_bf16 v[48:51], v[96:99], v[140:143], v[48:51]
    s_add_u32 m0, s28, 15360
    s_add_u32 s34, s27, 69120
    buffer_load_dwordx4 v2, s[12:15], s34 offen  lds
    v_mfma_f32_16x16x32_bf16 v[68:71], v[100:103], v[140:143], v[68:71]
    v_mfma_f32_16x16x32_bf16 v[88:91], v[104:107], v[140:143], v[88:91]
    buffer_load_dwordx4 v[140:143], v1, s[8:11], s26 offen offset:1024 sc1
    s_waitcnt vmcnt(17) lgkmcnt(0)
    s_mul_i32 s26, s32, 40960
    s_add_u32 s26, s26, s29
    s_add_u32 s32, s32, 1
    s_cmp_eq_u32 s32, s33
    s_cselect_b32 s32, 0, s32
    v_mfma_f32_16x16x32_bf16 v[12:15], v[108:111], v[144:147], v[12:15]
    ds_read_b64_tr_b16 v[92:93], v3 offset:0
    ds_read_b64_tr_b16 v[94:95], v3 offset:2048
    v_mfma_f32_16x16x32_bf16 v[32:35], v[112:115], v[144:147], v[32:35]
    ds_read_b64_tr_b16 v[96:97], v4 offset:0
    ds_read_b64_tr_b16 v[98:99], v4 offset:2048
    v_mfma_f32_16x16x32_bf16 v[52:55], v[116:119], v[144:147], v[52:55]
    ds_read_b64_tr_b16 v[100:101], v5 offset:0
    ds_read_b64_tr_b16 v[102:103], v5 offset:2048
    v_mfma_f32_16x16x32_bf16 v[72:75], v[120:123], v[144:147], v[72:75]
    ds_read_b64_tr_b16 v[104:105], v6 offset:0
    ds_read_b64_tr_b16 v[106:107], v6 offset:2048
    buffer_load_dwordx4 v[144:147], v1, s[8:11], s26 offen offset:0 sc1
    s_waitcnt vmcnt(17)
    v_mfma_f32_16x16x32_bf16 v[16:19], v[108:111], v[148:151], v[16:19]
    v_mfma_f32_16x16x32_bf16 v[36:39], v[112:115], v[148:151], v[36:39]
    v_mfma_f32_16x16x32_bf16 v[56:59], v[116:119], v[148:151], v[56:59]
    v_mfma_f32_16x16x32_bf16 v[76:79], v[120:123], v[148:151], v[76:79]
    buffer_load_dwordx4 v[148:151], v1, s[8:11], s26 offen offset:256 sc1
    s_waitcnt vmcnt(16)
    s_waitcnt lgkmcnt(0)
    s_mul_i32 s27, s31, 110592
    s_add_u32 s27, s27, s30
    s_add_u32 s31, s31, 1
    s_cmp_eq_u32 s31, s33
    s_cselect_b32 s31, 0, s31
    v_mfma_f32_16x16x32_bf16 v[20:23], v[108:111], v[152:155], v[20:23]
    v_mfma_f32_16x16x32_bf16 v[40:43], v[112:115], v[152:155], v[40:43]
    s_add_u32 m0, s28, 0
    s_nop 0
    buffer_load_dwordx4 v2, s[12:15], s27 offen  lds
    v_mfma_f32_16x16x32_bf16 v[60:63], v[116:119], v[152:155], v[60:63]
    v_mfma_f32_16x16x32_bf16 v[80:83], v[120:123], v[152:155], v[80:83]
    buffer_load_dwordx4 v[152:155], v1, s[8:11], s26 offen offset:512 sc1
    s_waitcnt vmcnt(15)
    v_mfma_f32_16x16x32_bf16 v[24:27], v[108:111], v[156:159], v[24:27]
    s_add_u32 m0, s28, 1024
    s_add_u32 s34, s27, 55296
    buffer_load_dwordx4 v2, s[12:15], s34 offen  lds
    v_mfma_f32_16x16x32_bf16 v[44:47], v[112:115], v[156:159], v[44:47]
    v_mfma_f32_16x16x32_bf16 v[64:67], v[116:119], v[156:159], v[64:67]
    s_add_u32 m0, s28, 2048
    s_add_u32 s34, s27, 13824
    buffer_load_dwordx4 v2, s[12:15], s34 offen  lds
    v_mfma_f32_16x16x32_bf16 v[84:87], v[120:123], v[156:159], v[84:87]
    buffer_load_dwordx4 v[156:159], v1, s[8:11], s26 offen offset:768 sc1
    s_waitcnt vmcnt(16)
    v_mfma_f32_16x16x32_bf16 v[28:31], v[108:111], v[160:163], v[28:31]
    v_mfma_f32_16x16x32_bf16 v[48:51], v[112:115], v[160:163], v[48:51]
    s_add_u32 m0, s28, 3072
    s_add_u32 s34, s27, 69120
    buffer_load_dwordx4 v2, s[12:15], s34 offen  lds
    v_mfma_f32_16x16x32_bf16 v[68:71], v[116:119], v[160:163], v[68:71]
    v_mfma_f32_16x16x32_bf16 v[88:91], v[120:123], v[160:163], v[88:91]
    buffer_load_dwordx4 v[160:163], v1, s[8:11], s26 offen offset:1024 sc1
    s_waitcnt vmcnt(17) lgkmcnt(0)
    s_mul_i32 s26, s32, 40960
    s_add_u32 s26, s26, s29
    s_add_u32 s32, s32, 1
    s_cmp_eq_u32 s32, s33
    s_cselect_b32 s32, 0, s32
    v_mfma_f32_16x16x32_bf16 v[12:15], v[92:95], v[124:127], v[12:15]
    ds_read_b64_tr_b16 v[108:109], v3 offset:4096
    ds_read_b64_tr_b16 v[110:111], v3 offset:6144
    v_mfma_f32_16x16x32_bf16 v[32:35], v[96:99], v[124:127], v[32:35]
    ds_read_b64_tr_b16 v[112:113], v4 offset:4096
    ds_read_b64_tr_b16 v[114:115], v4 offset:6144
    v_mfma_f32_16x16x32_bf16 v[52:55], v[100:103], v[124:127], v[52:55]
    ds_read_b64_tr_b16 v[116:117], v5 offset:4096
    ds_read_b64_tr_b16 v[118:119], v5 offset:6144
    v_mfma_f32_16x16x32_bf16 v[72:75], v[104:107], v[124:127], v[72:75]
    ds_read_b64_tr_b16 v[120:121], v6 offset:4096
    ds_read_b64_tr_b16 v[122:123], v6 offset:6144
    buffer_load_dwordx4 v[124:127], v1, s[8:11], s26 offen offset:0 sc1
    s_waitcnt vmcnt(17)
    v_mfma_f32_16x16x32_bf16 v[16:19], v[92:95], v[128:131], v[16:19]
    v_mfma_f32_16x16x32_bf16 v[36:39], v[96:99], v[128:131], v[36:39]
    v_mfma_f32_16x16x32_bf16 v[56:59], v[100:103], v[128:131], v[56:59]
    v_mfma_f32_16x16x32_bf16 v[76:79], v[104:107], v[128:131], v[76:79]
    buffer_load_dwordx4 v[128:131], v1, s[8:11], s26 offen offset:256 sc1
    s_waitcnt vmcnt(16)
    s_waitcnt lgkmcnt(0)
    s_mul_i32 s27, s31, 110592
    s_add_u32 s27, s27, s30
    s_add_u32 s31, s31, 1
    s_cmp_eq_u32 s31, s33
    s_cselect_b32 s31, 0, s31
    v_mfma_f32_16x16x32_bf16 v[20:23], v[92:95], v[132:135], v[20:23]
    v_mfma_f32_16x16x32_bf16 v[40:43], v[96:99], v[132:135], v[40:43]
    s_add_u32 m0, s28, 4096
    s_nop 0
    buffer_load_dwordx4 v2, s[12:15], s27 offen  lds
    v_mfma_f32_16x16x32_bf16 v[60:63], v[100:103], v[132:135], v[60:63]
    v_mfma_f32_16x16x32_bf16 v[80:83], v[104:107], v[132:135], v[80:83]
    buffer_load_dwordx4 v[132:135], v1, s[8:11], s26 offen offset:512 sc1
    s_waitcnt vmcnt(15)
    v_mfma_f32_16x16x32_bf16 v[24:27], v[92:95], v[136:139], v[24:27]
    s_add_u32 m0, s28, 5120
    s_add_u32 s34, s27, 55296
    buffer_load_dwordx4 v2, s[12:15], s34 offen  lds
    v_mfma_f32_16x16x32_bf16 v[44:47], v[96:99], v[136:139], v[44:47]
    v_mfma_f32_16x16x32_bf16 v[64:67], v[100:103], v[136:139], v[64:67]
    s_add_u32 m0, s28, 6144
    s_add_u32 s34, s27, 13824
    buffer_load_dwordx4 v2, s[12:15], s34 offen  lds
    v_mfma_f32_16x16x32_bf16 v[84:87], v[104:107], v[136:139], v[84:87]
    buffer_load_dwordx4 v[136:139], v1, s[8:11], s26 offen offset:768 sc1
    s_waitcnt vmcnt(16)
    v_mfma_f32_16x16x32_bf16 v[28:31], v[92:95], v[140:143], v[28:31]
    v_mfma_f32_16x16x32_bf16 v[48:51], v[96:99], v[140:143], v[48:51]
    s_add_u32 m0, s28, 7168
    s_add_u32 s34, s27, 69120
    buffer_load_dwordx4 v2, s[12:15], s34 offen  lds
    v_mfma_f32_16x16x32_bf16 v[68:71], v[100:103], v[140:143], v[68:71]
    v_mfma_f32_16x16x32_bf16 v[88:91], v[104:107], v[140:143], v[88:91]
    buffer_load_dwordx4 v[140:143], v1, s[8:11], s26 offen offset:1024 sc1
    s_waitcnt vmcnt(17) lgkmcnt(0)
    s_mul_i32 s26, s32, 40960
    s_add_u32 s26, s26, s29
    s_add_u32 s32, s32, 1
    s_cmp_eq_u32 s32, s33
    s_cselect_b32 s32, 0, s32
    v_mfma_f32_16x16x32_bf16 v[12:15], v[108:111], v[144:147], v[12:15]
    ds_read_b64_tr_b16 v[92:93], v3 offset:8192
    ds_read_b64_tr_b16 v[94:95], v3 offset:10240
    v_mfma_f32_16x16x32_bf16 v[32:35], v[112:115], v[144:147], v[32:35]
    ds_read_b64_tr_b16 v[96:97], v4 offset:8192
    ds_read_b64_tr_b16 v[98:99], v4 offset:10240
    v_mfma_f32_16x16x32_bf16 v[52:55], v[116:119], v[144:147], v[52:55]
    ds_read_b64_tr_b16 v[100:101], v5 offset:8192
    ds_read_b64_tr_b16 v[102:103], v5 offset:10240
    v_mfma_f32_16x16x32_bf16 v[72:75], v[120:123], v[144:147], v[72:75]
    ds_read_b64_tr_b16 v[104:105], v6 offset:8192
    ds_read_b64_tr_b16 v[106:107], v6 offset:10240
    buffer_load_dwordx4 v[144:147], v1, s[8:11], s26 offen offset:0 sc1
    s_waitcnt vmcnt(17)
    v_mfma_f32_16x16x32_bf16 v[16:19], v[108:111], v[148:151], v[16:19]
    v_mfma_f32_16x16x32_bf16 v[36:39], v[112:115], v[148:151], v[36:39]
    v_mfma_f32_16x16x32_bf16 v[56:59], v[116:119], v[148:151], v[56:59]
    v_mfma_f32_16x16x32_bf16 v[76:79], v[120:123], v[148:151], v[76:79]
    buffer_load_dwordx4 v[148:151], v1, s[8:11], s26 offen offset:256 sc1
    s_waitcnt vmcnt(16)
    s_waitcnt lgkmcnt(0)
    s_mul_i32 s27, s31, 110592
    s_add_u32 s27, s27, s30
    s_add_u32 s31, s31, 1
    s_cmp_eq_u32 s31, s33
    s_cselect_b32 s31, 0, s31
    v_mfma_f32_16x16x32_bf16 v[20:23], v[108:111], v[152:155], v[20:23]
    v_mfma_f32_16x16x32_bf16 v[40:43], v[112:115], v[152:155], v[40:43]
    s_add_u32 m0, s28, 8192
    s_nop 0
    buffer_load_dwordx4 v2, s[12:15], s27 offen  lds
    v_mfma_f32_16x16x32_bf16 v[60:63], v[116:119], v[152:155], v[60:63]
    v_mfma_f32_16x16x32_bf16 v[80:83], v[120:123], v[152:155], v[80:83]
    buffer_load_dwordx4 v[152:155], v1, s[8:11], s26 offen offset:512 sc1
    s_waitcnt vmcnt(15)
    v_mfma_f32_16x16x32_bf16 v[24:27], v[108:111], v[156:159], v[24:27]
    s_add_u32 m0, s28, 9216
    s_add_u32 s34, s27, 55296
    buffer_load_dwordx4 v2, s[12:15], s34 offen  lds
    v_mfma_f32_16x16x32_bf16 v[44:47], v[112:115], v[156:159], v[44:47]
    v_mfma_f32_16x16x32_bf16 v[64:67], v[116:119], v[156:159], v[64:67]
    s_add_u32 m0, s28, 10240
    s_add_u32 s34, s27, 13824
    buffer_load_dwordx4 v2, s[12:15], s34 offen  lds
    v_mfma_f32_16x16x32_bf16 v[84:87], v[120:123], v[156:159], v[84:87]
    buffer_load_dwordx4 v[156:159], v1, s[8:11], s26 offen offset:768 sc1
    s_waitcnt vmcnt(16)
    v_mfma_f32_16x16x32_bf16 v[28:31], v[108:111], v[160:163], v[28:31]
    v_mfma_f32_16x16x32_bf16 v[48:51], v[112:115], v[160:163], v[48:51]
    s_add_u32 m0, s28, 11264
    s_add_u32 s34, s27, 69120
    buffer_load_dwordx4 v2, s[12:15], s34 offen  lds
    v_mfma_f32_16x16x32_bf16 v[68:71], v[116:119], v[160:163], v[68:71]
    v_mfma_f32_16x16x32_bf16 v[88:91], v[120:123], v[160:163], v[88:91]
    buffer_load_dwordx4 v[160:163], v1, s[8:11], s26 offen offset:1024 sc1
    s_waitcnt vmcnt(17) lgkmcnt(0)
    s_mul_i32 s26, s32, 40960
    s_add_u32 s26, s26, s29
    s_add_u32 s32, s32, 1
    s_cmp_eq_u32 s32, s33
    s_cselect_b32 s32, 0, s32
    v_mfma_f32_16x16x32_bf16 v[12:15], v[92:95], v[124:127], v[12:15]
    ds_read_b64_tr_b16 v[108:109], v3 offset:12288
    ds_read_b64_tr_b16 v[110:111], v3 offset:14336
    v_mfma_f32_16x16x32_bf16 v[32:35], v[96:99], v[124:127], v[32:35]
    ds_read_b64_tr_b16 v[112:113], v4 offset:12288
    ds_read_b64_tr_b16 v[114:115], v4 offset:14336
    v_mfma_f32_16x16x32_bf16 v[52:55], v[100:103], v[124:127], v[52:55]
    ds_read_b64_tr_b16 v[116:117], v5 offset:12288
    ds_read_b64_tr_b16 v[118:119], v5 offset:14336
    v_mfma_f32_16x16x32_bf16 v[72:75], v[104:107], v[124:127], v[72:75]
    ds_read_b64_tr_b16 v[120:121], v6 offset:12288
    ds_read_b64_tr_b16 v[122:123], v6 offset:14336
    buffer_load_dwordx4 v[124:127], v1, s[8:11], s26 offen offset:0 sc1
    s_waitcnt vmcnt(17)
    v_mfma_f32_16x16x32_bf16 v[16:19], v[92:95], v[128:131], v[16:19]
    v_mfma_f32_16x16x32_bf16 v[36:39], v[96:99], v[128:131], v[36:39]
    v_mfma_f32_16x16x32_bf16 v[56:59], v[100:103], v[128:131], v[56:59]
    v_mfma_f32_16x16x32_bf16 v[76:79], v[104:107], v[128:131], v[76:79]
    buffer_load_dwordx4 v[128:131], v1, s[8:11], s26 offen offset:256 sc1
    s_waitcnt vmcnt(16)
    s_waitcnt lgkmcnt(0)
    s_mul_i32 s27, s31, 110592
    s_add_u32 s27, s27, s30
    s_add_u32 s31, s31, 1
    s_cmp_eq_u32 s31, s33
    s_cselect_b32 s31, 0, s31
    v_mfma_f32_16x16x32_bf16 v[20:23], v[92:95], v[132:135], v[20:23]
    v_mfma_f32_16x16x32_bf16 v[40:43], v[96:99], v[132:135], v[40:43]
    s_add_u32 m0, s28, 12288
    s_nop 0
    buffer_load_dwordx4 v2, s[12:15], s27 offen  lds
    v_mfma_f32_16x16x32_bf16 v[60:63], v[100:103], v[132:135], v[60:63]
    v_mfma_f32_16x16x32_bf16 v[80:83], v[104:107], v[132:135], v[80:83]
    buffer_load_dwordx4 v[132:135], v1, s[8:11], s26 offen offset:512 sc1
    s_waitcnt vmcnt(15)
    v_mfma_f32_16x16x32_bf16 v[24:27], v[92:95], v[136:139], v[24:27]
    s_add_u32 m0, s28, 13312
    s_add_u32 s34, s27, 55296
    buffer_load_dwordx4 v2, s[12:15], s34 offen  lds
    v_mfma_f32_16x16x32_bf16 v[44:47], v[96:99], v[136:139], v[44:47]
    v_mfma_f32_16x16x32_bf16 v[64:67], v[100:103], v[136:139], v[64:67]
    s_add_u32 m0, s28, 14336
    s_add_u32 s34, s27, 13824
    buffer_load_dwordx4 v2, s[12:15], s34 offen  lds
    v_mfma_f32_16x16x32_bf16 v[84:87], v[104:107], v[136:139], v[84:87]
    buffer_load_dwordx4 v[136:139], v1, s[8:11], s26 offen offset:768 sc1
    s_waitcnt vmcnt(16)
    v_mfma_f32_16x16x32_bf16 v[28:31], v[92:95], v[140:143], v[28:31]
    v_mfma_f32_16x16x32_bf16 v[48:51], v[96:99], v[140:143], v[48:51]
    s_add_u32 m0, s28, 15360
    s_add_u32 s34, s27, 69120
    buffer_load_dwordx4 v2, s[12:15], s34 offen  lds
    v_mfma_f32_16x16x32_bf16 v[68:71], v[100:103], v[140:143], v[68:71]
    v_mfma_f32_16x16x32_bf16 v[88:91], v[104:107], v[140:143], v[88:91]
    buffer_load_dwordx4 v[140:143], v1, s[8:11], s26 offen offset:1024 sc1
    s_waitcnt vmcnt(17) lgkmcnt(0)
    s_mul_i32 s26, s32, 40960
    s_add_u32 s26, s26, s29
    s_add_u32 s32, s32, 1
    s_cmp_eq_u32 s32, s33
    s_cselect_b32 s32, 0, s32
    v_mfma_f32_16x16x32_bf16 v[12:15], v[108:111], v[144:147], v[12:15]
    ds_read_b64_tr_b16 v[92:93], v3 offset:0
    ds_read_b64_tr_b16 v[94:95], v3 offset:2048
    v_mfma_f32_16x16x32_bf16 v[32:35], v[112:115], v[144:147], v[32:35]
    ds_read_b64_tr_b16 v[96:97], v4 offset:0
    ds_read_b64_tr_b16 v[98:99], v4 offset:2048
    v_mfma_f32_16x16x32_bf16 v[52:55], v[116:119], v[144:147], v[52:55]
    ds_read_b64_tr_b16 v[100:101], v5 offset:0
    ds_read_b64_tr_b16 v[102:103], v5 offset:2048
    v_mfma_f32_16x16x32_bf16 v[72:75], v[120:123], v[144:147], v[72:75]
    ds_read_b64_tr_b16 v[104:105], v6 offset:0
    ds_read_b64_tr_b16 v[106:107], v6 offset:2048
    buffer_load_dwordx4 v[144:147], v1, s[8:11], s26 offen offset:0 sc1
    s_waitcnt vmcnt(17)
    v_mfma_f32_16x16x32_bf16 v[16:19], v[108:111], v[148:151], v[16:19]
    v_mfma_f32_16x16x32_bf16 v[36:39], v[112:115], v[148:151], v[36:39]
    v_mfma_f32_16x16x32_bf16 v[56:59], v[116:119], v[148:151], v[56:59]
    v_mfma_f32_16x16x32_bf16 v[76:79], v[120:123], v[148:151], v[76:79]
    buffer_load_dwordx4 v[148:151], v1, s[8:11], s26 offen offset:256 sc1
    s_waitcnt vmcnt(16)
    s_waitcnt lgkmcnt(0)
    s_mul_i32 s27, s31, 110592
    s_add_u32 s27, s27, s30
    s_add_u32 s31, s31, 1
    s_cmp_eq_u32 s31, s33
    s_cselect_b32 s31, 0, s31
    v_mfma_f32_16x16x32_bf16 v[20:23], v[108:111], v[152:155], v[20:23]
    v_mfma_f32_16x16x32_bf16 v[40:43], v[112:115], v[152:155], v[40:43]
    s_add_u32 m0, s28, 0
    s_nop 0
    buffer_load_dwordx4 v2, s[12:15], s27 offen  lds
    v_mfma_f32_16x16x32_bf16 v[60:63], v[116:119], v[152:155], v[60:63]
    v_mfma_f32_16x16x32_bf16 v[80:83], v[120:123], v[152:155], v[80:83]
    buffer_load_dwordx4 v[152:155], v1, s[8:11], s26 offen offset:512 sc1
    s_waitcnt vmcnt(15)
    v_mfma_f32_16x16x32_bf16 v[24:27], v[108:111], v[156:159], v[24:27]
    s_add_u32 m0, s28, 1024
    s_add_u32 s34, s27, 55296
    buffer_load_dwordx4 v2, s[12:15], s34 offen  lds
    v_mfma_f32_16x16x32_bf16 v[44:47], v[112:115], v[156:159], v[44:47]
    v_mfma_f32_16x16x32_bf16 v[64:67], v[116:119], v[156:159], v[64:67]
    s_add_u32 m0, s28, 2048
    s_add_u32 s34, s27, 13824
    buffer_load_dwordx4 v2, s[12:15], s34 offen  lds
    v_mfma_f32_16x16x32_bf16 v[84:87], v[120:123], v[156:159], v[84:87]
    buffer_load_dwordx4 v[156:159], v1, s[8:11], s26 offen offset:768 sc1
    s_waitcnt vmcnt(16)
    v_mfma_f32_16x16x32_bf16 v[28:31], v[108:111], v[160:163], v[28:31]
    v_mfma_f32_16x16x32_bf16 v[48:51], v[112:115], v[160:163], v[48:51]
    s_add_u32 m0, s28, 3072
    s_add_u32 s34, s27, 69120
    buffer_load_dwordx4 v2, s[12:15], s34 offen  lds
    v_mfma_f32_16x16x32_bf16 v[68:71], v[116:119], v[160:163], v[68:71]
    v_mfma_f32_16x16x32_bf16 v[88:91], v[120:123], v[160:163], v[88:91]
    buffer_load_dwordx4 v[160:163], v1, s[8:11], s26 offen offset:1024 sc1
    s_waitcnt vmcnt(17) lgkmcnt(0)
    s_mul_i32 s26, s32, 40960
    s_add_u32 s26, s26, s29
    s_add_u32 s32, s32, 1
    s_cmp_eq_u32 s32, s33
    s_cselect_b32 s32, 0, s32
    v_mfma_f32_16x16x32_bf16 v[12:15], v[92:95], v[124:127], v[12:15]
    ds_read_b64_tr_b16 v[108:109], v3 offset:4096
    ds_read_b64_tr_b16 v[110:111], v3 offset:6144
    v_mfma_f32_16x16x32_bf16 v[32:35], v[96:99], v[124:127], v[32:35]
    ds_read_b64_tr_b16 v[112:113], v4 offset:4096
    ds_read_b64_tr_b16 v[114:115], v4 offset:6144
    v_mfma_f32_16x16x32_bf16 v[52:55], v[100:103], v[124:127], v[52:55]
    ds_read_b64_tr_b16 v[116:117], v5 offset:4096
    ds_read_b64_tr_b16 v[118:119], v5 offset:6144
    v_mfma_f32_16x16x32_bf16 v[72:75], v[104:107], v[124:127], v[72:75]
    ds_read_b64_tr_b16 v[120:121], v6 offset:4096
    ds_read_b64_tr_b16 v[122:123], v6 offset:6144
    buffer_load_dwordx4 v[124:127], v1, s[8:11], s26 offen offset:0 sc1
    s_waitcnt vmcnt(17)
    v_mfma_f32_16x16x32_bf16 v[16:19], v[92:95], v[128:131], v[16:19]
    v_mfma_f32_16x16x32_bf16 v[36:39], v[96:99], v[128:131], v[36:39]
    v_mfma_f32_16x16x32_bf16 v[56:59], v[100:103], v[128:131], v[56:59]
    v_mfma_f32_16x16x32_bf16 v[76:79], v[104:107], v[128:131], v[76:79]
    buffer_load_dwordx4 v[128:131], v1, s[8:11], s26 offen offset:256 sc1
    s_waitcnt vmcnt(16)
    s_waitcnt lgkmcnt(0)
    s_mul_i32 s27, s31, 110592
    s_add_u32 s27, s27, s30
    s_add_u32 s31, s31, 1
    s_cmp_eq_u32 s31, s33
    s_cselect_b32 s31, 0, s31
    v_mfma_f32_16x16x32_bf16 v[20:23], v[92:95], v[132:135], v[20:23]
    v_mfma_f32_16x16x32_bf16 v[40:43], v[96:99], v[132:135], v[40:43]
    s_add_u32 m0, s28, 4096
    s_nop 0
    buffer_load_dwordx4 v2, s[12:15], s27 offen  lds
    v_mfma_f32_16x16x32_bf16 v[60:63], v[100:103], v[132:135], v[60:63]
    v_mfma_f32_16x16x32_bf16 v[80:83], v[104:107], v[132:135], v[80:83]
    buffer_load_dwordx4 v[132:135], v1, s[8:11], s26 offen offset:512 sc1
    s_waitcnt vmcnt(15)
    v_mfma_f32_16x16x32_bf16 v[24:27], v[92:95], v[136:139], v[24:27]
    s_add_u32 m0, s28, 5120
    s_add_u32 s34, s27, 55296
    buffer_load_dwordx4 v2, s[12:15], s34 offen  lds
    v_mfma_f32_16x16x32_bf16 v[44:47], v[96:99], v[136:139], v[44:47]
    v_mfma_f32_16x16x32_bf16 v[64:67], v[100:103], v[136:139], v[64:67]
    s_add_u32 m0, s28, 6144
    s_add_u32 s34, s27, 13824
    buffer_load_dwordx4 v2, s[12:15], s34 offen  lds
    v_mfma_f32_16x16x32_bf16 v[84:87], v[104:107], v[136:139], v[84:87]
    buffer_load_dwordx4 v[136:139], v1, s[8:11], s26 offen offset:768 sc1
    s_waitcnt vmcnt(16)
    v_mfma_f32_16x16x32_bf16 v[28:31], v[92:95], v[140:143], v[28:31]
    v_mfma_f32_16x16x32_bf16 v[48:51], v[96:99], v[140:143], v[48:51]
    s_add_u32 m0, s28, 7168
    s_add_u32 s34, s27, 69120
    buffer_load_dwordx4 v2, s[12:15], s34 offen  lds
    v_mfma_f32_16x16x32_bf16 v[68:71], v[100:103], v[140:143], v[68:71]
    v_mfma_f32_16x16x32_bf16 v[88:91], v[104:107], v[140:143], v[88:91]
    buffer_load_dwordx4 v[140:143], v1, s[8:11], s26 offen offset:1024 sc1
    s_waitcnt vmcnt(17) lgkmcnt(0)
    s_mul_i32 s26, s32, 40960
    s_add_u32 s26, s26, s29
    s_add_u32 s32, s32, 1
    s_cmp_eq_u32 s32, s33
    s_cselect_b32 s32, 0, s32
    v_mfma_f32_16x16x32_bf16 v[12:15], v[108:111], v[144:147], v[12:15]
    ds_read_b64_tr_b16 v[92:93], v3 offset:8192
    ds_read_b64_tr_b16 v[94:95], v3 offset:10240
    v_mfma_f32_16x16x32_bf16 v[32:35], v[112:115], v[144:147], v[32:35]
    ds_read_b64_tr_b16 v[96:97], v4 offset:8192
    ds_read_b64_tr_b16 v[98:99], v4 offset:10240
    v_mfma_f32_16x16x32_bf16 v[52:55], v[116:119], v[144:147], v[52:55]
    ds_read_b64_tr_b16 v[100:101], v5 offset:8192
    ds_read_b64_tr_b16 v[102:103], v5 offset:10240
    v_mfma_f32_16x16x32_bf16 v[72:75], v[120:123], v[144:147], v[72:75]
    ds_read_b64_tr_b16 v[104:105], v6 offset:8192
    ds_read_b64_tr_b16 v[106:107], v6 offset:10240
    buffer_load_dwordx4 v[144:147], v1, s[8:11], s26 offen offset:0 sc1
    s_waitcnt vmcnt(17)
    v_mfma_f32_16x16x32_bf16 v[16:19], v[108:111], v[148:151], v[16:19]
    v_mfma_f32_16x16x32_bf16 v[36:39], v[112:115], v[148:151], v[36:39]
    v_mfma_f32_16x16x32_bf16 v[56:59], v[116:119], v[148:151], v[56:59]
    v_mfma_f32_16x16x32_bf16 v[76:79], v[120:123], v[148:151], v[76:79]
    buffer_load_dwordx4 v[148:151], v1, s[8:11], s26 offen offset:256 sc1
    s_waitcnt vmcnt(16)
    s_waitcnt lgkmcnt(0)
    s_mul_i32 s27, s31, 110592
    s_add_u32 s27, s27, s30
    s_add_u32 s31, s31, 1
    s_cmp_eq_u32 s31, s33
    s_cselect_b32 s31, 0, s31
    v_mfma_f32_16x16x32_bf16 v[20:23], v[108:111], v[152:155], v[20:23]
    v_mfma_f32_16x16x32_bf16 v[40:43], v[112:115], v[152:155], v[40:43]
    s_add_u32 m0, s28, 8192
    s_nop 0
    buffer_load_dwordx4 v2, s[12:15], s27 offen  lds
    v_mfma_f32_16x16x32_bf16 v[60:63], v[116:119], v[152:155], v[60:63]
    v_mfma_f32_16x16x32_bf16 v[80:83], v[120:123], v[152:155], v[80:83]
    buffer_load_dwordx4 v[152:155], v1, s[8:11], s26 offen offset:512 sc1
    s_waitcnt vmcnt(15)
    v_mfma_f32_16x16x32_bf16 v[24:27], v[108:111], v[156:159], v[24:27]
    s_add_u32 m0, s28, 9216
    s_add_u32 s34, s27, 55296
    buffer_load_dwordx4 v2, s[12:15], s34 offen  lds
    v_mfma_f32_16x16x32_bf16 v[44:47], v[112:115], v[156:159], v[44:47]
    v_mfma_f32_16x16x32_bf16 v[64:67], v[116:119], v[156:159], v[64:67]
    s_add_u32 m0, s28, 10240
    s_add_u32 s34, s27, 13824
    buffer_load_dwordx4 v2, s[12:15], s34 offen  lds
    v_mfma_f32_16x16x32_bf16 v[84:87], v[120:123], v[156:159], v[84:87]
    buffer_load_dwordx4 v[156:159], v1, s[8:11], s26 offen offset:768 sc1
    s_waitcnt vmcnt(16)
    v_mfma_f32_16x16x32_bf16 v[28:31], v[108:111], v[160:163], v[28:31]
    v_mfma_f32_16x16x32_bf16 v[48:51], v[112:115], v[160:163], v[48:51]
    s_add_u32 m0, s28, 11264
    s_add_u32 s34, s27, 69120
    buffer_load_dwordx4 v2, s[12:15], s34 offen  lds
    v_mfma_f32_16x16x32_bf16 v[68:71], v[116:119], v[160:163], v[68:71]
    v_mfma_f32_16x16x32_bf16 v[88:91], v[120:123], v[160:163], v[88:91]
    buffer_load_dwordx4 v[160:163], v1, s[8:11], s26 offen offset:1024 sc1
    s_waitcnt vmcnt(17) lgkmcnt(0)
    s_mul_i32 s26, s32, 40960
    s_add_u32 s26, s26, s29
    s_add_u32 s32, s32, 1
    s_cmp_eq_u32 s32, s33
    s_cselect_b32 s32, 0, s32
    v_mfma_f32_16x16x32_bf16 v[12:15], v[92:95], v[124:127], v[12:15]
    ds_read_b64_tr_b16 v[108:109], v3 offset:12288
    ds_read_b64_tr_b16 v[110:111], v3 offset:14336
    v_mfma_f32_16x16x32_bf16 v[32:35], v[96:99], v[124:127], v[32:35]
    ds_read_b64_tr_b16 v[112:113], v4 offset:12288
    ds_read_b64_tr_b16 v[114:115], v4 offset:14336
    v_mfma_f32_16x16x32_bf16 v[52:55], v[100:103], v[124:127], v[52:55]
    ds_read_b64_tr_b16 v[116:117], v5 offset:12288
    ds_read_b64_tr_b16 v[118:119], v5 offset:14336
    v_mfma_f32_16x16x32_bf16 v[72:75], v[104:107], v[124:127], v[72:75]
    ds_read_b64_tr_b16 v[120:121], v6 offset:12288
    ds_read_b64_tr_b16 v[122:123], v6 offset:14336
    buffer_load_dwordx4 v[124:127], v1, s[8:11], s26 offen offset:0 sc1
    s_waitcnt vmcnt(17)
    v_mfma_f32_16x16x32_bf16 v[16:19], v[92:95], v[128:131], v[16:19]
    v_mfma_f32_16x16x32_bf16 v[36:39], v[96:99], v[128:131], v[36:39]
    v_mfma_f32_16x16x32_bf16 v[56:59], v[100:103], v[128:131], v[56:59]
    v_mfma_f32_16x16x32_bf16 v[76:79], v[104:107], v[128:131], v[76:79]
    buffer_load_dwordx4 v[128:131], v1, s[8:11], s26 offen offset:256 sc1
    s_waitcnt vmcnt(16)
    s_waitcnt lgkmcnt(0)
    s_mul_i32 s27, s31, 110592
    s_add_u32 s27, s27, s30
    s_add_u32 s31, s31, 1
    s_cmp_eq_u32 s31, s33
    s_cselect_b32 s31, 0, s31
    v_mfma_f32_16x16x32_bf16 v[20:23], v[92:95], v[132:135], v[20:23]
    v_mfma_f32_16x16x32_bf16 v[40:43], v[96:99], v[132:135], v[40:43]
    s_add_u32 m0, s28, 12288
    s_nop 0
    buffer_load_dwordx4 v2, s[12:15], s27 offen  lds
    v_mfma_f32_16x16x32_bf16 v[60:63], v[100:103], v[132:135], v[60:63]
    v_mfma_f32_16x16x32_bf16 v[80:83], v[104:107], v[132:135], v[80:83]
    buffer_load_dwordx4 v[132:135], v1, s[8:11], s26 offen offset:512 sc1
    s_waitcnt vmcnt(15)
    v_mfma_f32_16x16x32_bf16 v[24:27], v[92:95], v[136:139], v[24:27]
    s_add_u32 m0, s28, 13312
    s_add_u32 s34, s27, 55296
    buffer_load_dwordx4 v2, s[12:15], s34 offen  lds
    v_mfma_f32_16x16x32_bf16 v[44:47], v[96:99], v[136:139], v[44:47]
    v_mfma_f32_16x16x32_bf16 v[64:67], v[100:103], v[136:139], v[64:67]
    s_add_u32 m0, s28, 14336
    s_add_u32 s34, s27, 13824
    buffer_load_dwordx4 v2, s[12:15], s34 offen  lds
    v_mfma_f32_16x16x32_bf16 v[84:87], v[104:107], v[136:139], v[84:87]
    buffer_load_dwordx4 v[136:139], v1, s[8:11], s26 offen offset:768 sc1
    s_waitcnt vmcnt(16)
    v_mfma_f32_16x16x32_bf16 v[28:31], v[92:95], v[140:143], v[28:31]
    v_mfma_f32_16x16x32_bf16 v[48:51], v[96:99], v[140:143], v[48:51]
    s_add_u32 m0, s28, 15360
    s_add_u32 s34, s27, 69120
    buffer_load_dwordx4 v2, s[12:15], s34 offen  lds
    v_mfma_f32_16x16x32_bf16 v[68:71], v[100:103], v[140:143], v[68:71]
    v_mfma_f32_16x16x32_bf16 v[88:91], v[104:107], v[140:143], v[88:91]
    buffer_load_dwordx4 v[140:143], v1, s[8:11], s26 offen offset:1024 sc1
    s_waitcnt vmcnt(17) lgkmcnt(0)
    s_mul_i32 s26, s32, 40960
    s_add_u32 s26, s26, s29
    s_add_u32 s32, s32, 1
    s_cmp_eq_u32 s32, s33
    s_cselect_b32 s32, 0, s32
    v_mfma_f32_16x16x32_bf16 v[12:15], v[108:111], v[144:147], v[12:15]
    ds_read_b64_tr_b16 v[92:93], v3 offset:0
    ds_read_b64_tr_b16 v[94:95], v3 offset:2048
    v_mfma_f32_16x16x32_bf16 v[32:35], v[112:115], v[144:147], v[32:35]
    ds_read_b64_tr_b16 v[96:97], v4 offset:0
    ds_read_b64_tr_b16 v[98:99], v4 offset:2048
    v_mfma_f32_16x16x32_bf16 v[52:55], v[116:119], v[144:147], v[52:55]
    ds_read_b64_tr_b16 v[100:101], v5 offset:0
    ds_read_b64_tr_b16 v[102:103], v5 offset:2048
    v_mfma_f32_16x16x32_bf16 v[72:75], v[120:123], v[144:147], v[72:75]
    ds_read_b64_tr_b16 v[104:105], v6 offset:0
    ds_read_b64_tr_b16 v[106:107], v6 offset:2048
    buffer_load_dwordx4 v[144:147], v1, s[8:11], s26 offen offset:0 sc1
    s_waitcnt vmcnt(17)
    v_mfma_f32_16x16x32_bf16 v[16:19], v[108:111], v[148:151], v[16:19]
    v_mfma_f32_16x16x32_bf16 v[36:39], v[112:115], v[148:151], v[36:39]
    v_mfma_f32_16x16x32_bf16 v[56:59], v[116:119], v[148:151], v[56:59]
    v_mfma_f32_16x16x32_bf16 v[76:79], v[120:123], v[148:151], v[76:79]
    buffer_load_dwordx4 v[148:151], v1, s[8:11], s26 offen offset:256 sc1
    s_waitcnt vmcnt(16)
    v_mfma_f32_16x16x32_bf16 v[20:23], v[108:111], v[152:155], v[20:23]
    v_mfma_f32_16x16x32_bf16 v[40:43], v[112:115], v[152:155], v[40:43]
    v_mfma_f32_16x16x32_bf16 v[60:63], v[116:119], v[152:155], v[60:63]
    v_mfma_f32_16x16x32_bf16 v[80:83], v[120:123], v[152:155], v[80:83]
    buffer_load_dwordx4 v[152:155], v1, s[8:11], s26 offen offset:512 sc1
    s_waitcnt vmcnt(14)
    v_mfma_f32_16x16x32_bf16 v[24:27], v[108:111], v[156:159], v[24:27]
    v_mfma_f32_16x16x32_bf16 v[44:47], v[112:115], v[156:159], v[44:47]
    v_mfma_f32_16x16x32_bf16 v[64:67], v[116:119], v[156:159], v[64:67]
    v_mfma_f32_16x16x32_bf16 v[84:87], v[120:123], v[156:159], v[84:87]
    buffer_load_dwordx4 v[156:159], v1, s[8:11], s26 offen offset:768 sc1
    s_waitcnt vmcnt(13)
    v_mfma_f32_16x16x32_bf16 v[28:31], v[108:111], v[160:163], v[28:31]
    v_mfma_f32_16x16x32_bf16 v[48:51], v[112:115], v[160:163], v[48:51]
    v_mfma_f32_16x16x32_bf16 v[68:71], v[116:119], v[160:163], v[68:71]
    v_mfma_f32_16x16x32_bf16 v[88:91], v[120:123], v[160:163], v[88:91]
    buffer_load_dwordx4 v[160:163], v1, s[8:11], s26 offen offset:1024 sc1
    s_waitcnt vmcnt(13) lgkmcnt(0)
    s_mul_i32 s26, s32, 40960
    s_add_u32 s26, s26, s29
    s_add_u32 s32, s32, 1
    s_cmp_eq_u32 s32, s33
    s_cselect_b32 s32, 0, s32
    v_mfma_f32_16x16x32_bf16 v[12:15], v[92:95], v[124:127], v[12:15]
    ds_read_b64_tr_b16 v[108:109], v3 offset:4096
    ds_read_b64_tr_b16 v[110:111], v3 offset:6144
    v_mfma_f32_16x16x32_bf16 v[32:35], v[96:99], v[124:127], v[32:35]
    ds_read_b64_tr_b16 v[112:113], v4 offset:4096
    ds_read_b64_tr_b16 v[114:115], v4 offset:6144
    v_mfma_f32_16x16x32_bf16 v[52:55], v[100:103], v[124:127], v[52:55]
    ds_read_b64_tr_b16 v[116:117], v5 offset:4096
    ds_read_b64_tr_b16 v[118:119], v5 offset:6144
    v_mfma_f32_16x16x32_bf16 v[72:75], v[104:107], v[124:127], v[72:75]
    ds_read_b64_tr_b16 v[120:121], v6 offset:4096
    ds_read_b64_tr_b16 v[122:123], v6 offset:6144
    buffer_load_dwordx4 v[124:127], v1, s[8:11], s26 offen offset:0 sc1
    s_waitcnt vmcnt(13)
    v_mfma_f32_16x16x32_bf16 v[16:19], v[92:95], v[128:131], v[16:19]
    v_mfma_f32_16x16x32_bf16 v[36:39], v[96:99], v[128:131], v[36:39]
    v_mfma_f32_16x16x32_bf16 v[56:59], v[100:103], v[128:131], v[56:59]
    v_mfma_f32_16x16x32_bf16 v[76:79], v[104:107], v[128:131], v[76:79]
    buffer_load_dwordx4 v[128:131], v1, s[8:11], s26 offen offset:256 sc1
    s_waitcnt vmcnt(12)
    v_mfma_f32_16x16x32_bf16 v[20:23], v[92:95], v[132:135], v[20:23]
    v_mfma_f32_16x16x32_bf16 v[40:43], v[96:99], v[132:135], v[40:43]
    v_mfma_f32_16x16x32_bf16 v[60:63], v[100:103], v[132:135], v[60:63]
    v_mfma_f32_16x16x32_bf16 v[80:83], v[104:107], v[132:135], v[80:83]
    buffer_load_dwordx4 v[132:135], v1, s[8:11], s26 offen offset:512 sc1
    s_waitcnt vmcnt(10)
    v_mfma_f32_16x16x32_bf16 v[24:27], v[92:95], v[136:139], v[24:27]
    v_mfma_f32_16x16x32_bf16 v[44:47], v[96:99], v[136:139], v[44:47]
    v_mfma_f32_16x16x32_bf16 v[64:67], v[100:103], v[136:139], v[64:67]
    v_mfma_f32_16x16x32_bf16 v[84:87], v[104:107], v[136:139], v[84:87]
    buffer_load_dwordx4 v[136:139], v1, s[8:11], s26 offen offset:768 sc1
    s_waitcnt vmcnt(9)
    v_mfma_f32_16x16x32_bf16 v[28:31], v[92:95], v[140:143], v[28:31]
    v_mfma_f32_16x16x32_bf16 v[48:51], v[96:99], v[140:143], v[48:51]
    v_mfma_f32_16x16x32_bf16 v[68:71], v[100:103], v[140:143], v[68:71]
    v_mfma_f32_16x16x32_bf16 v[88:91], v[104:107], v[140:143], v[88:91]
    buffer_load_dwordx4 v[140:143], v1, s[8:11], s26 offen offset:1024 sc1
    s_waitcnt vmcnt(9) lgkmcnt(0)
    s_mul_i32 s26, s32, 40960
    s_add_u32 s26, s26, s29
    s_add_u32 s32, s32, 1
    s_cmp_eq_u32 s32, s33
    s_cselect_b32 s32, 0, s32
    v_mfma_f32_16x16x32_bf16 v[12:15], v[108:111], v[144:147], v[12:15]
    ds_read_b64_tr_b16 v[92:93], v3 offset:8192
    ds_read_b64_tr_b16 v[94:95], v3 offset:10240
    v_mfma_f32_16x16x32_bf16 v[32:35], v[112:115], v[144:147], v[32:35]
    ds_read_b64_tr_b16 v[96:97], v4 offset:8192
    ds_read_b64_tr_b16 v[98:99], v4 offset:10240
    v_mfma_f32_16x16x32_bf16 v[52:55], v[116:119], v[144:147], v[52:55]
    ds_read_b64_tr_b16 v[100:101], v5 offset:8192
    ds_read_b64_tr_b16 v[102:103], v5 offset:10240
    v_mfma_f32_16x16x32_bf16 v[72:75], v[120:123], v[144:147], v[72:75]
    ds_read_b64_tr_b16 v[104:105], v6 offset:8192
    ds_read_b64_tr_b16 v[106:107], v6 offset:10240
    buffer_load_dwordx4 v[144:147], v1, s[8:11], s26 offen offset:0 sc1
    s_waitcnt vmcnt(9)
    v_mfma_f32_16x16x32_bf16 v[16:19], v[108:111], v[148:151], v[16:19]
    v_mfma_f32_16x16x32_bf16 v[36:39], v[112:115], v[148:151], v[36:39]
    v_mfma_f32_16x16x32_bf16 v[56:59], v[116:119], v[148:151], v[56:59]
    v_mfma_f32_16x16x32_bf16 v[76:79], v[120:123], v[148:151], v[76:79]
    buffer_load_dwordx4 v[148:151], v1, s[8:11], s26 offen offset:256 sc1
    s_waitcnt vmcnt(9)
    v_mfma_f32_16x16x32_bf16 v[20:23], v[108:111], v[152:155], v[20:23]
    v_mfma_f32_16x16x32_bf16 v[40:43], v[112:115], v[152:155], v[40:43]
    v_mfma_f32_16x16x32_bf16 v[60:63], v[116:119], v[152:155], v[60:63]
    v_mfma_f32_16x16x32_bf16 v[80:83], v[120:123], v[152:155], v[80:83]
    buffer_load_dwordx4 v[152:155], v1, s[8:11], s26 offen offset:512 sc1
    s_waitcnt vmcnt(9)
    v_mfma_f32_16x16x32_bf16 v[24:27], v[108:111], v[156:159], v[24:27]
    v_mfma_f32_16x16x32_bf16 v[44:47], v[112:115], v[156:159], v[44:47]
    v_mfma_f32_16x16x32_bf16 v[64:67], v[116:119], v[156:159], v[64:67]
    v_mfma_f32_16x16x32_bf16 v[84:87], v[120:123], v[156:159], v[84:87]
    buffer_load_dwordx4 v[156:159], v1, s[8:11], s26 offen offset:768 sc1
    s_waitcnt vmcnt(9)
    v_mfma_f32_16x16x32_bf16 v[28:31], v[108:111], v[160:163], v[28:31]
    v_mfma_f32_16x16x32_bf16 v[48:51], v[112:115], v[160:163], v[48:51]
    v_mfma_f32_16x16x32_bf16 v[68:71], v[116:119], v[160:163], v[68:71]
    v_mfma_f32_16x16x32_bf16 v[88:91], v[120:123], v[160:163], v[88:91]
    buffer_load_dwordx4 v[160:163], v1, s[8:11], s26 offen offset:1024 sc1
    s_mov_b32 s44, s42
    s_and_b32 s45, s43, 0xffff
    s_mov_b32 s46, 7077888
    s_mov_b32 s47, 0x00020000
    s_bfe_u32 s23, s35, 0x20001
    s_lshl_b32 s23, s23, 10
    s_lshr_b32 s24, s35, 3
    s_lshl_b32 s24, s24, 2
    s_add_u32 s24, s24, s20
    s_mul_i32 s24, s24, 57344
    s_add_u32 s23, s23, s24
    v_bfe_u32 v7, v0, 3, 3
    v_lshlrev_b32 v7, 12, v7
    v_and_b32 v8, 7, v0
    v_lshl_add_u32 v7, v8, 7, v7
    s_and_b32 s24, s35, 1
    s_mul_i32 s24, s24, 28672
    s_add_u32 s23, s23, s24
    s_mov_b32 exec_hi, 0xffffff
    buffer_load_dword v166, v7, s[44:47], s23 offen
    s_mov_b64 exec, -1
    s_waitcnt vmcnt(10) lgkmcnt(0)
    v_mfma_f32_16x16x32_bf16 v[12:15], v[92:95], v[124:127], v[12:15]
    ds_read_b64_tr_b16 v[108:109], v3 offset:12288
    ds_read_b64_tr_b16 v[110:111], v3 offset:14336
    v_mfma_f32_16x16x32_bf16 v[32:35], v[96:99], v[124:127], v[32:35]
    ds_read_b64_tr_b16 v[112:113], v4 offset:12288
    ds_read_b64_tr_b16 v[114:115], v4 offset:14336
    v_mfma_f32_16x16x32_bf16 v[52:55], v[100:103], v[124:127], v[52:55]
    ds_read_b64_tr_b16 v[116:117], v5 offset:12288
    ds_read_b64_tr_b16 v[118:119], v5 offset:14336
    v_mfma_f32_16x16x32_bf16 v[72:75], v[104:107], v[124:127], v[72:75]
    ds_read_b64_tr_b16 v[120:121], v6 offset:12288
    ds_read_b64_tr_b16 v[122:123], v6 offset:14336
    s_waitcnt vmcnt(9)
    v_mfma_f32_16x16x32_bf16 v[16:19], v[92:95], v[128:131], v[16:19]
    v_mfma_f32_16x16x32_bf16 v[36:39], v[96:99], v[128:131], v[36:39]
    v_mfma_f32_16x16x32_bf16 v[56:59], v[100:103], v[128:131], v[56:59]
    v_mfma_f32_16x16x32_bf16 v[76:79], v[104:107], v[128:131], v[76:79]
    s_waitcnt vmcnt(8)
    v_mfma_f32_16x16x32_bf16 v[20:23], v[92:95], v[132:135], v[20:23]
    v_mfma_f32_16x16x32_bf16 v[40:43], v[96:99], v[132:135], v[40:43]
    v_mfma_f32_16x16x32_bf16 v[60:63], v[100:103], v[132:135], v[60:63]
    v_mfma_f32_16x16x32_bf16 v[80:83], v[104:107], v[132:135], v[80:83]
    s_waitcnt vmcnt(7)
    v_mfma_f32_16x16x32_bf16 v[24:27], v[92:95], v[136:139], v[24:27]
    v_mfma_f32_16x16x32_bf16 v[44:47], v[96:99], v[136:139], v[44:47]
    v_mfma_f32_16x16x32_bf16 v[64:67], v[100:103], v[136:139], v[64:67]
    v_mfma_f32_16x16x32_bf16 v[84:87], v[104:107], v[136:139], v[84:87]
    s_waitcnt vmcnt(6)
    v_mfma_f32_16x16x32_bf16 v[28:31], v[92:95], v[140:143], v[28:31]
    v_mfma_f32_16x16x32_bf16 v[48:51], v[96:99], v[140:143], v[48:51]
    v_mfma_f32_16x16x32_bf16 v[68:71], v[100:103], v[140:143], v[68:71]
    v_mfma_f32_16x16x32_bf16 v[88:91], v[104:107], v[140:143], v[88:91]
    s_waitcnt vmcnt(5) lgkmcnt(0)
    v_mfma_f32_16x16x32_bf16 v[12:15], v[108:111], v[144:147], v[12:15]
    v_mfma_f32_16x16x32_bf16 v[32:35], v[112:115], v[144:147], v[32:35]
    v_mfma_f32_16x16x32_bf16 v[52:55], v[116:119], v[144:147], v[52:55]
    v_mfma_f32_16x16x32_bf16 v[72:75], v[120:123], v[144:147], v[72:75]
    s_waitcnt vmcnt(4)
    v_mfma_f32_16x16x32_bf16 v[16:19], v[108:111], v[148:151], v[16:19]
    v_mfma_f32_16x16x32_bf16 v[36:39], v[112:115], v[148:151], v[36:39]
    v_mfma_f32_16x16x32_bf16 v[56:59], v[116:119], v[148:151], v[56:59]
    v_mfma_f32_16x16x32_bf16 v[76:79], v[120:123], v[148:151], v[76:79]
    s_waitcnt vmcnt(3)
    v_mfma_f32_16x16x32_bf16 v[20:23], v[108:111], v[152:155], v[20:23]
    v_mfma_f32_16x16x32_bf16 v[40:43], v[112:115], v[152:155], v[40:43]
    v_mfma_f32_16x16x32_bf16 v[60:63], v[116:119], v[152:155], v[60:63]
    v_mfma_f32_16x16x32_bf16 v[80:83], v[120:123], v[152:155], v[80:83]
    s_waitcnt vmcnt(2)
    v_mfma_f32_16x16x32_bf16 v[24:27], v[108:111], v[156:159], v[24:27]
    v_mfma_f32_16x16x32_bf16 v[44:47], v[112:115], v[156:159], v[44:47]
    v_mfma_f32_16x16x32_bf16 v[64:67], v[116:119], v[156:159], v[64:67]
    v_mfma_f32_16x16x32_bf16 v[84:87], v[120:123], v[156:159], v[84:87]
    s_waitcnt vmcnt(1)
    v_mfma_f32_16x16x32_bf16 v[28:31], v[108:111], v[160:163], v[28:31]
    v_mfma_f32_16x16x32_bf16 v[48:51], v[112:115], v[160:163], v[48:51]
    v_mfma_f32_16x16x32_bf16 v[68:71], v[116:119], v[160:163], v[68:71]
    v_mfma_f32_16x16x32_bf16 v[88:91], v[120:123], v[160:163], v[88:91]
    s_setprio 3
    v_and_b32 v7, 63, v0
    v_lshlrev_b32 v7, 4, v7
    v_add_u32 v3, s28, v7
    s_xor_b32 s23, s20, 1
    s_mul_i32 s23, s23, 16384
    s_add_u32 s23, s23, 65536
    v_add_u32 v4, s23, v7
    s_xor_b32 s23, s20, 3
    s_mul_i32 s23, s23, 16384
    s_add_u32 s23, s23, 65536
    v_add_u32 v5, s23, v7
    ds_write_b128 v3, v[32:35] offset:0
    ds_write_b128 v3, v[36:39] offset:1024
    ds_write_b128 v3, v[40:43] offset:2048
    ds_write_b128 v3, v[44:47] offset:3072
    ds_write_b128 v3, v[48:51] offset:4096
    ds_write_b128 v3, v[72:75] offset:5120
    ds_write_b128 v3, v[76:79] offset:6144
    ds_write_b128 v3, v[80:83] offset:7168
    ds_write_b128 v3, v[84:87] offset:8192
    ds_write_b128 v3, v[88:91] offset:9216
    s_lshl_b32 s59, s20, 2
    s_add_u32 s59, s59, 140448
    s_mov_b64 exec, 1
    v_mov_b32 v164, s59
    v_mov_b32 v165, 1
    ds_add_u32 v164, v165
    s_mov_b64 exec, -1
    s_add_u32 s41, s41, 1
    s_xor_b32 s59, s20, 1
    s_lshl_b32 s59, s59, 2
    s_add_u32 s59, s59, 140448
    s_mov_b64 exec, 1
    v_mov_b32 v164, s59
    s_mov_b32 s61, 1048576
Lw31:
    ds_read_b32 v165, v164
    s_waitcnt lgkmcnt(0)
    v_readfirstlane_b32 s59, v165
    s_nop 0
    s_cmp_ge_u32 s59, s41
    s_cbranch_scc1 Lw31x
    s_sleep 1
    s_sub_u32 s61, s61, 1
    s_cmp_lg_u32 s61, 0
    s_cbranch_scc1 Lw31
Lw31x:
    s_mov_b64 exec, -1
    ds_read_b128 v[72:75], v4 offset:5120
    ds_read_b128 v[76:79], v4 offset:6144
    ds_read_b128 v[80:83], v4 offset:7168
    ds_read_b128 v[84:87], v4 offset:8192
    ds_read_b128 v[88:91], v4 offset:9216
    ds_read_b128 v[32:35], v4 offset:0
    ds_read_b128 v[36:39], v4 offset:1024
    ds_read_b128 v[40:43], v4 offset:2048
    ds_read_b128 v[44:47], v4 offset:3072
    ds_read_b128 v[48:51], v4 offset:4096
    s_waitcnt lgkmcnt(5)
    v_add_f32 v52, v52, v72
    v_add_f32 v53, v53, v73
    v_add_f32 v54, v54, v74
    v_add_f32 v55, v55, v75
    v_add_f32 v56, v56, v76
    v_add_f32 v57, v57, v77
    v_add_f32 v58, v58, v78
    v_add_f32 v59, v59, v79
    v_add_f32 v60, v60, v80
    v_add_f32 v61, v61, v81
    v_add_f32 v62, v62, v82
    v_add_f32 v63, v63, v83
    v_add_f32 v64, v64, v84
    v_add_f32 v65, v65, v85
    v_add_f32 v66, v66, v86
    v_add_f32 v67, v67, v87
    v_add_f32 v68, v68, v88
    v_add_f32 v69, v69, v89
    v_add_f32 v70, v70, v90
    v_add_f32 v71, v71, v91
    s_waitcnt lgkmcnt(0)
    ds_write_b128 v4, v[52:55] offset:0
    ds_write_b128 v4, v[56:59] offset:1024
    ds_write_b128 v4, v[60:63] offset:2048
    ds_write_b128 v4, v[64:67] offset:3072
    ds_write_b128 v4, v[68:71] offset:4096
    s_lshl_b32 s59, s20, 2
    s_add_u32 s59, s59, 140448
    s_mov_b64 exec, 1
    v_mov_b32 v164, s59
    v_mov_b32 v165, 1
    ds_add_u32 v164, v165
    s_mov_b64 exec, -1
    s_add_u32 s41, s41, 1
    v_add_f32 v12, v12, v32
    v_add_f32 v13, v13, v33
    v_add_f32 v14, v14, v34
    v_add_f32 v15, v15, v35
    v_add_f32 v16, v16, v36
    v_add_f32 v17, v17, v37
    v_add_f32 v18, v18, v38
    v_add_f32 v19, v19, v39
    v_add_f32 v20, v20, v40
    v_add_f32 v21, v21, v41
    v_add_f32 v22, v22, v42
    v_add_f32 v23, v23, v43
    v_add_f32 v24, v24, v44
    v_add_f32 v25, v25, v45
    v_add_f32 v26, v26, v46
    v_add_f32 v27, v27, v47
    v_add_f32 v28, v28, v48
    v_add_f32 v29, v29, v49
    v_add_f32 v30, v30, v50
    v_add_f32 v31, v31, v51
    s_xor_b32 s59, s20, 2
    s_lshl_b32 s59, s59, 2
    s_add_u32 s59, s59, 140448
    s_mov_b64 exec, 1
    v_mov_b32 v164, s59
    s_mov_b32 s61, 1048576
Lw32:
    ds_read_b32 v165, v164
    s_waitcnt lgkmcnt(0)
    v_readfirstlane_b32 s59, v165
    s_nop 0
    s_cmp_ge_u32 s59, s41
    s_cbranch_scc1 Lw32x
    s_sleep 1
    s_sub_u32 s61, s61, 1
    s_cmp_lg_u32 s61, 0
    s_cbranch_scc1 Lw32
Lw32x:
    s_mov_b64 exec, -1
    ds_read_b128 v[32:35], v5 offset:0
    ds_read_b128 v[36:39], v5 offset:1024
    ds_read_b128 v[40:43], v5 offset:2048
    ds_read_b128 v[44:47], v5 offset:3072
    ds_read_b128 v[48:51], v5 offset:4096
    s_waitcnt lgkmcnt(0)
    v_add_f32 v12, v12, v32
    v_add_f32 v13, v13, v33
    v_add_f32 v14, v14, v34
    v_add_f32 v15, v15, v35
    v_add_f32 v16, v16, v36
    v_add_f32 v17, v17, v37
    v_add_f32 v18, v18, v38
    v_add_f32 v19, v19, v39
    v_add_f32 v20, v20, v40
    v_add_f32 v21, v21, v41
    v_add_f32 v22, v22, v42
    v_add_f32 v23, v23, v43
    v_add_f32 v24, v24, v44
    v_add_f32 v25, v25, v45
    v_add_f32 v26, v26, v46
    v_add_f32 v27, v27, v47
    v_add_f32 v28, v28, v48
    v_add_f32 v29, v29, v49
    v_add_f32 v30, v30, v50
    v_add_f32 v31, v31, v51
    s_mov_b64 exec, 1
    v_mov_b32 v164, 141764
    v_mov_b32 v165, 1
    ds_add_u32 v164, v165
    s_mov_b64 exec, -1
    s_add_u32 s60, s60, 4
    s_mov_b32 s44, s52
    s_and_b32 s45, s53, 0xffff
    s_mov_b32 s46, 2621440
    s_mov_b32 s47, 0x00020000
    v_and_b32 v165, 15, v0
    v_bfe_u32 v164, v0, 4, 2
    v_lshlrev_b32 v167, 1, v165
    v_mul_u32_u24 v165, 1280, v165
    v_lshl_add_u32 v165, v164, 3, v165
    s_bfe_u32 s23, s35, 0x20001
    s_lshl_b32 s23, s23, 3
    s_bfe_u32 s24, s35, 0x30003
    s_add_u32 s23, s23, s24
    s_lshl_b32 s23, s23, 2
    s_add_u32 s23, s23, s20
    s_mul_i32 s58, s23, 20480
    s_lshl_b32 s57, s23, 5
    s_and_b32 s23, s35, 1
    s_lshl_b32 s23, s23, 2
    s_lshr_b32 s24, s35, 6
    s_add_u32 s23, s23, s24
    s_mul_i32 s23, s23, 160
    s_add_u32 s58, s58, s23
    buffer_load_dwordx2 v[76:77], v165, s[44:47], s58 offen offset:0
    buffer_load_dwordx2 v[78:79], v165, s[44:47], s58 offen offset:32
    buffer_load_dwordx2 v[80:81], v165, s[44:47], s58 offen offset:64
    buffer_load_dwordx2 v[82:83], v165, s[44:47], s58 offen offset:96
    buffer_load_dwordx2 v[84:85], v165, s[44:47], s58 offen offset:128
    s_mov_b32 s44, s48
    s_and_b32 s45, s49, 0xffff
    s_mov_b32 s46, 4096
    s_mov_b32 s47, 0x00020000
    buffer_load_ushort v86, v167, s[44:47], s57 offen
    s_mov_b32 s25, 0xbdd2d3e8
    v_mov_b32 v8, 0xc0135761
    v_bfe_u32 v7, v0, 5, 1
    v_mul_u32_u24 v3, 10240, v7
    v_and_b32 v7, 15, v0
    v_lshl_add_u32 v3, v7, 4, v3
    v_bfe_u32 v7, v0, 4, 1
    v_lshl_add_u32 v3, v7, 3, v3
    s_lshl_b32 s23, s22, 2
    s_add_u32 s23, s23, s20
    s_mul_i32 s23, s23, 20480
    s_mul_i32 s24, s21, 1280
    s_add_u32 s23, s23, s24
    s_add_u32 s23, s23, 10485760
    v_mul_f32 v32, v12, v12
    v_mul_f32 v33, v13, v13
    v_mul_f32 v34, v14, v14
    v_mul_f32 v35, v15, v15
    v_mul_f32 v36, v16, v16
    v_mul_f32 v37, v17, v17
    v_mul_f32 v38, v18, v18
    v_mul_f32 v39, v19, v19
    v_fma_f32 v32, v32, s25, v8
    v_fma_f32 v33, v33, s25, v8
    v_fma_f32 v34, v34, s25, v8
    v_fma_f32 v35, v35, s25, v8
    v_fma_f32 v36, v36, s25, v8
    v_fma_f32 v37, v37, s25, v8
    v_fma_f32 v38, v38, s25, v8
    v_fma_f32 v39, v39, s25, v8
    v_mul_f32 v32, v32, v12
    v_mul_f32 v33, v33, v13
    v_mul_f32 v34, v34, v14
    v_mul_f32 v35, v35, v15
    v_mul_f32 v36, v36, v16
    v_mul_f32 v37, v37, v17
    v_mul_f32 v38, v38, v18
    v_mul_f32 v39, v39, v19
    v_exp_f32 v32, v32
    v_exp_f32 v33, v33
    v_exp_f32 v34, v34
    v_exp_f32 v35, v35
    v_exp_f32 v36, v36
    v_exp_f32 v37, v37
    v_exp_f32 v38, v38
    v_exp_f32 v39, v39
    v_add_f32 v32, 1.0, v32
    v_add_f32 v33, 1.0, v33
    v_add_f32 v34, 1.0, v34
    v_add_f32 v35, 1.0, v35
    v_add_f32 v36, 1.0, v36
    v_add_f32 v37, 1.0, v37
    v_add_f32 v38, 1.0, v38
    v_add_f32 v39, 1.0, v39
    v_rcp_f32 v32, v32
    v_rcp_f32 v33, v33
    v_rcp_f32 v34, v34
    v_rcp_f32 v35, v35
    v_rcp_f32 v36, v36
    v_rcp_f32 v37, v37
    v_rcp_f32 v38, v38
    v_rcp_f32 v39, v39
    v_mul_f32 v12, v12, v32
    v_mul_f32 v13, v13, v33
    v_mul_f32 v14, v14, v34
    v_mul_f32 v15, v15, v35
    v_mul_f32 v16, v16, v36
    v_mul_f32 v17, v17, v37
    v_mul_f32 v18, v18, v38
    v_mul_f32 v19, v19, v39
    v_cvt_pk_bf16_f32 v12, v12, v13
    v_cvt_pk_bf16_f32 v13, v14, v15
    buffer_store_dwordx2 v[12:13], v3, s[8:11], s23 offen offset:0 sc1
    v_cvt_pk_bf16_f32 v16, v16, v17
    v_cvt_pk_bf16_f32 v17, v18, v19
    buffer_store_dwordx2 v[16:17], v3, s[8:11], s23 offen offset:256 sc1
    v_mul_f32 v40, v20, v20
    v_mul_f32 v41, v21, v21
    v_mul_f32 v42, v22, v22
    v_mul_f32 v43, v23, v23
    v_mul_f32 v44, v24, v24
    v_mul_f32 v45, v25, v25
    v_mul_f32 v46, v26, v26
    v_mul_f32 v47, v27, v27
    v_mul_f32 v48, v28, v28
    v_mul_f32 v49, v29, v29
    v_mul_f32 v50, v30, v30
    v_mul_f32 v51, v31, v31
    v_fma_f32 v40, v40, s25, v8
    v_fma_f32 v41, v41, s25, v8
    v_fma_f32 v42, v42, s25, v8
    v_fma_f32 v43, v43, s25, v8
    v_fma_f32 v44, v44, s25, v8
    v_fma_f32 v45, v45, s25, v8
    v_fma_f32 v46, v46, s25, v8
    v_fma_f32 v47, v47, s25, v8
    v_fma_f32 v48, v48, s25, v8
    v_fma_f32 v49, v49, s25, v8
    v_fma_f32 v50, v50, s25, v8
    v_fma_f32 v51, v51, s25, v8
    v_mul_f32 v40, v40, v20
    v_mul_f32 v41, v41, v21
    v_mul_f32 v42, v42, v22
    v_mul_f32 v43, v43, v23
    v_mul_f32 v44, v44, v24
    v_mul_f32 v45, v45, v25
    v_mul_f32 v46, v46, v26
    v_mul_f32 v47, v47, v27
    v_mul_f32 v48, v48, v28
    v_mul_f32 v49, v49, v29
    v_mul_f32 v50, v50, v30
    v_mul_f32 v51, v51, v31
    v_exp_f32 v40, v40
    v_exp_f32 v41, v41
    v_exp_f32 v42, v42
    v_exp_f32 v43, v43
    v_exp_f32 v44, v44
    v_exp_f32 v45, v45
    v_exp_f32 v46, v46
    v_exp_f32 v47, v47
    v_exp_f32 v48, v48
    v_exp_f32 v49, v49
    v_exp_f32 v50, v50
    v_exp_f32 v51, v51
    v_add_f32 v40, 1.0, v40
    v_add_f32 v41, 1.0, v41
    v_add_f32 v42, 1.0, v42
    v_add_f32 v43, 1.0, v43
    v_add_f32 v44, 1.0, v44
    v_add_f32 v45, 1.0, v45
    v_add_f32 v46, 1.0, v46
    v_add_f32 v47, 1.0, v47
    v_add_f32 v48, 1.0, v48
    v_add_f32 v49, 1.0, v49
    v_add_f32 v50, 1.0, v50
    v_add_f32 v51, 1.0, v51
    v_rcp_f32 v40, v40
    v_rcp_f32 v41, v41
    v_rcp_f32 v42, v42
    v_rcp_f32 v43, v43
    v_rcp_f32 v44, v44
    v_rcp_f32 v45, v45
    v_rcp_f32 v46, v46
    v_rcp_f32 v47, v47
    v_rcp_f32 v48, v48
    v_rcp_f32 v49, v49
    v_rcp_f32 v50, v50
    v_rcp_f32 v51, v51
    v_mul_f32 v20, v20, v40
    v_mul_f32 v21, v21, v41
    v_mul_f32 v22, v22, v42
    v_mul_f32 v23, v23, v43
    v_mul_f32 v24, v24, v44
    v_mul_f32 v25, v25, v45
    v_mul_f32 v26, v26, v46
    v_mul_f32 v27, v27, v47
    v_mul_f32 v28, v28, v48
    v_mul_f32 v29, v29, v49
    v_mul_f32 v30, v30, v50
    v_mul_f32 v31, v31, v51
    v_cvt_pk_bf16_f32 v20, v20, v21
    v_cvt_pk_bf16_f32 v21, v22, v23
    buffer_store_dwordx2 v[20:21], v3, s[8:11], s23 offen offset:512 sc1
    v_cvt_pk_bf16_f32 v24, v24, v25
    v_cvt_pk_bf16_f32 v25, v26, v27
    buffer_store_dwordx2 v[24:25], v3, s[8:11], s23 offen offset:768 sc1
    v_cvt_pk_bf16_f32 v28, v28, v29
    v_cvt_pk_bf16_f32 v29, v30, v31
    buffer_store_dwordx2 v[28:29], v3, s[8:11], s23 offen offset:1024 sc1
    s_lshl_b32 s23, s21, 5
    s_add_u32 s23, s23, s22
    s_lshl_b32 s23, s23, 7
    s_add_u32 s23, s23, 21790720
    s_mov_b64 exec, 1
    v_mov_b32 v7, 141784
    v_mov_b32 v8, 1
    s_waitcnt vmcnt(0)
    ds_add_rtn_u32 v7, v7, v8
    s_waitcnt lgkmcnt(0)
    v_readfirstlane_b32 s59, v7
    s_nop 0
    s_cmp_lg_u32 s59, 3
    s_cbranch_scc1 Lp33
    v_mov_b32 v7, 0
    buffer_store_dword v8, v7, s[8:11], s23 offen sc1
Lp33:
    s_mov_b64 exec, -1
    s_mov_b64 exec, 1
    v_mov_b32 v164, 141764
    s_mov_b32 s61, 1048576
Lw34:
    ds_read_b32 v165, v164
    s_waitcnt lgkmcnt(0)
    v_readfirstlane_b32 s59, v165
    s_nop 0
    s_cmp_ge_u32 s59, s60
    s_cbranch_scc1 Lw34x
    s_sleep 1
    s_sub_u32 s61, s61, 1
    s_cmp_lg_u32 s61, 0
    s_cbranch_scc1 Lw34
Lw34x:
    s_mov_b64 exec, -1
    s_branch parallel_sum__mha_block__mixer_token_mlp__prompt_kernel_m_p2
parallel_sum__mha_block__mixer_token_mlp__prompt_kernel_m_skip1:
    s_setprio 0
    s_waitcnt lgkmcnt(0)
    s_lshl_b32 s23, s20, 13
    s_add_u32 s23, s23, 21757952
    s_setprio 3
    s_mov_b64 exec, 1
    v_mov_b32 v164, 141772
    s_mov_b32 s61, 1048576
Lw35:
    ds_read_b32 v165, v164
    s_waitcnt lgkmcnt(0)
    v_readfirstlane_b32 s59, v165
    s_nop 0
    s_cmp_ge_u32 s59, 1
    s_cbranch_scc1 Lw35x
    s_sleep 1
    s_sub_u32 s61, s61, 1
    s_cmp_lg_u32 s61, 0
    s_cbranch_scc1 Lw35
Lw35x:
    s_mov_b64 exec, -1
    v_and_b32 v164, 63, v0
    v_lshlrev_b32 v164, 7, v164
    s_mov_b32 exec_lo, 0xffffffff
    s_mov_b32 exec_hi, 0xffffffff
    s_mov_b32 s61, 262144
Lg36:
    buffer_load_dword v165, v164, s[8:11], s23 offen sc1
    s_waitcnt vmcnt(0)
    v_cmp_gt_u32 vcc, 1, v165
    s_nop 4
    s_cbranch_vccz Lg36x
    s_sleep 2
    s_sub_u32 s61, s61, 1
    s_cmp_lg_u32 s61, 0
    s_cbranch_scc1 Lg36
Lg36x:
    s_mov_b64 exec, -1
    s_setprio 0
    s_mov_b64 exec, 1
    v_mov_b32 v164, 141764
    v_mov_b32 v165, 1
    ds_add_u32 v164, v165
    s_mov_b64 exec, -1
    s_add_u32 s60, s60, 4
    s_mov_b64 exec, 1
    v_mov_b32 v164, 141764
    s_mov_b32 s61, 1048576
Lw37:
    ds_read_b32 v165, v164
    s_waitcnt lgkmcnt(0)
    v_readfirstlane_b32 s59, v165
    s_nop 0
    s_cmp_ge_u32 s59, s60
    s_cbranch_scc1 Lw37x
    s_sleep 1
    s_sub_u32 s61, s61, 1
    s_cmp_lg_u32 s61, 0
    s_cbranch_scc1 Lw37
Lw37x:
    s_mov_b64 exec, -1
    s_setprio 0
    s_mov_b64 exec, 1
    v_mov_b32 v164, 141800
    s_mov_b32 s61, 1048576
Lw38:
    ds_read_b32 v165, v164
    s_waitcnt lgkmcnt(0)
    v_readfirstlane_b32 s59, v165
    s_nop 0
    s_cmp_ge_u32 s59, 4
    s_cbranch_scc1 Lw38x
    s_sleep 1
    s_sub_u32 s61, s61, 1
    s_cmp_lg_u32 s61, 0
    s_cbranch_scc1 Lw38
Lw38x:
    s_mov_b64 exec, -1
    s_mov_b32 s44, s6
    s_and_b32 s45, s7, 0xffff
    s_mov_b32 s46, 7077888
    s_mov_b32 s47, 0x00020000
    s_bfe_u32 s31, s35, 0x20001
    s_mul_i32 s31, s31, 27
    s_lshr_b32 s31, s31, 2
    s_lshl_b32 s31, s31, 7
    s_lshr_b32 s32, s35, 3
    s_sub_u32 s32, s32, 27
    s_lshl_b32 s32, s32, 2
    s_add_u32 s32, s32, s20
    s_lshl_b32 s32, s32, 1
    s_and_b32 s23, s35, 1
    s_add_u32 s32, s32, s23
    s_add_u32 s32, s32, 64
    v_bfe_u32 v7, v0, 3, 3
    v_mul_u32_u24 v7, 3456, v7
    v_and_b32 v8, 7, v0
    v_lshl_add_u32 v7, v8, 7, v7
parallel_sum__mha_block__mixer_token_mlp__prompt_kernel_m_pf1:
    s_lshr_b32 s23, s32, 4
    s_lshl_b32 s23, s23, 2
    s_and_b32 s24, s32, 3
    s_add_u32 s23, s23, s24
    s_lshl_b32 s23, s23, 3
    s_bfe_u32 s24, s32, 0x20002
    s_mul_i32 s24, s24, 512
    s_add_u32 s23, s23, s24
    s_mul_i32 s23, s23, 3456
    s_add_u32 s23, s23, s31
    buffer_load_dword v124, v7, s[44:47], s23 offen
    s_waitcnt vmcnt(2)
    s_add_u32 s32, s32, 40
    s_cmp_lt_u32 s32, 256
    s_cbranch_scc1 parallel_sum__mha_block__mixer_token_mlp__prompt_kernel_m_pf1
    s_mov_b32 s44, s42
    s_and_b32 s45, s43, 0xffff
    s_mov_b32 s46, 7077888
    s_mov_b32 s47, 0x00020000
    s_bfe_u32 s23, s35, 0x20001
    s_lshl_b32 s23, s23, 10
    s_lshr_b32 s24, s35, 3
    s_lshl_b32 s24, s24, 2
    s_add_u32 s24, s24, s20
    s_mul_i32 s24, s24, 57344
    s_add_u32 s23, s23, s24
    v_bfe_u32 v7, v0, 3, 3
    v_lshlrev_b32 v7, 12, v7
    v_and_b32 v8, 7, v0
    v_lshl_add_u32 v7, v8, 7, v7
    s_and_b32 s24, s35, 1
    s_mul_i32 s24, s24, 28672
    s_add_u32 s23, s23, s24
    s_mov_b32 exec_hi, 0xffffff
    buffer_load_dword v166, v7, s[44:47], s23 offen
    s_mov_b64 exec, -1
    s_mov_b32 s44, s52
    s_and_b32 s45, s53, 0xffff
    s_mov_b32 s46, 2621440
    s_mov_b32 s47, 0x00020000
    v_and_b32 v165, 15, v0
    v_bfe_u32 v164, v0, 4, 2
    v_lshlrev_b32 v167, 1, v165
    v_mul_u32_u24 v165, 1280, v165
    v_lshl_add_u32 v165, v164, 3, v165
    s_bfe_u32 s23, s35, 0x20001
    s_lshl_b32 s23, s23, 3
    s_bfe_u32 s24, s35, 0x30003
    s_add_u32 s23, s23, s24
    s_lshl_b32 s23, s23, 2
    s_add_u32 s23, s23, s20
    s_mul_i32 s58, s23, 20480
    s_lshl_b32 s57, s23, 5
    s_and_b32 s23, s35, 1
    s_lshl_b32 s23, s23, 2
    s_lshr_b32 s24, s35, 6
    s_add_u32 s23, s23, s24
    s_mul_i32 s23, s23, 160
    s_add_u32 s58, s58, s23
    buffer_load_dwordx2 v[76:77], v165, s[44:47], s58 offen offset:0
    buffer_load_dwordx2 v[78:79], v165, s[44:47], s58 offen offset:32
    buffer_load_dwordx2 v[80:81], v165, s[44:47], s58 offen offset:64
    buffer_load_dwordx2 v[82:83], v165, s[44:47], s58 offen offset:96
    buffer_load_dwordx2 v[84:85], v165, s[44:47], s58 offen offset:128
    s_mov_b32 s44, s48
    s_and_b32 s45, s49, 0xffff
    s_mov_b32 s46, 4096
    s_mov_b32 s47, 0x00020000
    buffer_load_ushort v86, v167, s[44:47], s57 offen
parallel_sum__mha_block__mixer_token_mlp__prompt_kernel_m_p2:
    s_mov_b32 s12, s42
    s_and_b32 s13, s43, 0xffff
    s_mov_b32 s14, 7077888
    s_mov_b32 s15, 0x00020000
    s_bfe_u32 s22, s35, 0x20001
    s_lshl_b32 s22, s22, 3
    s_bfe_u32 s23, s35, 0x30003
    s_add_u32 s22, s22, s23
    s_and_b32 s21, s35, 1
    s_lshl_b32 s21, s21, 2
    s_lshr_b32 s32, s35, 6
    s_add_u32 s21, s21, s32
    s_cmp_ge_u32 s20, 2
    s_cselect_b32 s33, 13, 14
    s_mul_i32 s24, s20, 14
    s_cmp_eq_u32 s20, 3
    s_cselect_b32 s25, 1, 0
    s_sub_u32 s24, s24, s25
    s_mul_i32 s31, s23, 3
    s_lshr_b32 s31, s31, 1
    s_mul_i32 s23, s32, 3
    s_add_u32 s31, s31, s23
    s_cmp_ge_u32 s31, 13
    s_cselect_b32 s23, 13, 0
    s_sub_u32 s31, s31, s23
    s_mov_b32 s31, 0
    s_mov_b32 s32, s31
    s_mul_i32 s29, s24, 40960
    s_mul_i32 s23, s21, 1280
    s_add_u32 s29, s29, s23
    s_add_u32 s29, s29, 10485760
    s_mul_i32 s30, s24, 131072
    s_lshl_b32 s23, s22, 7
    s_add_u32 s30, s30, s23
    v_bfe_u32 v7, v0, 5, 1
    v_bfe_u32 v8, v0, 3, 2
    v_lshl_add_u32 v7, v7, 3, v8
    v_mul_u32_u24 v2, 4096, v7
    v_bfe_u32 v7, v0, 4, 2
    v_lshlrev_b32 v7, 1, v7
    v_and_b32 v8, 7, v0
    v_xor_b32 v7, v7, v8
    v_lshl_add_u32 v2, v7, 4, v2
    s_mul_i32 s27, s31, 131072
    s_add_u32 s27, s27, s30
    s_add_u32 s31, s31, 1
    s_cmp_eq_u32 s31, s33
    s_cselect_b32 s31, 0, s31
    s_add_u32 m0, s28, 0
    s_nop 0
    buffer_load_dwordx4 v2, s[12:15], s27 offen  lds
    s_add_u32 m0, s28, 1024
    s_add_u32 s34, s27, 65536
    buffer_load_dwordx4 v2, s[12:15], s34 offen  lds
    s_add_u32 m0, s28, 2048
    s_add_u32 s34, s27, 16384
    buffer_load_dwordx4 v2, s[12:15], s34 offen  lds
    s_add_u32 m0, s28, 3072
    s_add_u32 s34, s27, 81920
    buffer_load_dwordx4 v2, s[12:15], s34 offen  lds
    s_mul_i32 s27, s31, 131072
    s_add_u32 s27, s27, s30
    s_add_u32 s31, s31, 1
    s_cmp_eq_u32 s31, s33
    s_cselect_b32 s31, 0, s31
    s_add_u32 m0, s28, 4096
    s_nop 0
    buffer_load_dwordx4 v2, s[12:15], s27 offen  lds
    s_add_u32 m0, s28, 5120
    s_add_u32 s34, s27, 65536
    buffer_load_dwordx4 v2, s[12:15], s34 offen  lds
    s_add_u32 m0, s28, 6144
    s_add_u32 s34, s27, 16384
    buffer_load_dwordx4 v2, s[12:15], s34 offen  lds
    s_add_u32 m0, s28, 7168
    s_add_u32 s34, s27, 81920
    buffer_load_dwordx4 v2, s[12:15], s34 offen  lds
    s_mul_i32 s27, s31, 131072
    s_add_u32 s27, s27, s30
    s_add_u32 s31, s31, 1
    s_cmp_eq_u32 s31, s33
    s_cselect_b32 s31, 0, s31
    s_add_u32 m0, s28, 8192
    s_nop 0
    buffer_load_dwordx4 v2, s[12:15], s27 offen  lds
    s_add_u32 m0, s28, 9216
    s_add_u32 s34, s27, 65536
    buffer_load_dwordx4 v2, s[12:15], s34 offen  lds
    s_add_u32 m0, s28, 10240
    s_add_u32 s34, s27, 16384
    buffer_load_dwordx4 v2, s[12:15], s34 offen  lds
    s_add_u32 m0, s28, 11264
    s_add_u32 s34, s27, 81920
    buffer_load_dwordx4 v2, s[12:15], s34 offen  lds
    s_mul_i32 s27, s31, 131072
    s_add_u32 s27, s27, s30
    s_add_u32 s31, s31, 1
    s_cmp_eq_u32 s31, s33
    s_cselect_b32 s31, 0, s31
    s_add_u32 m0, s28, 12288
    s_nop 0
    buffer_load_dwordx4 v2, s[12:15], s27 offen  lds
    s_add_u32 m0, s28, 13312
    s_add_u32 s34, s27, 65536
    buffer_load_dwordx4 v2, s[12:15], s34 offen  lds
    s_add_u32 m0, s28, 14336
    s_add_u32 s34, s27, 16384
    buffer_load_dwordx4 v2, s[12:15], s34 offen  lds
    s_add_u32 m0, s28, 15360
    s_add_u32 s34, s27, 81920
    buffer_load_dwordx4 v2, s[12:15], s34 offen  lds
    v_bfe_u32 v7, v0, 2, 4
    v_lshlrev_b32 v3, 7, v7
    v_bfe_u32 v7, v0, 3, 2
    v_xor_b32 v7, s20, v7
    v_lshl_add_u32 v3, v7, 5, v3
    v_and_b32 v7, 3, v0
    v_lshl_add_u32 v3, v7, 3, v3
    v_add_u32 v3, s28, v3
    v_xor_b32 v4, 32, v3
    v_xor_b32 v5, 64, v3
    v_xor_b32 v6, 96, v3
    s_mul_i32 s23, s20, 7
    s_min_u32 s23, s23, 20
    s_lshl_b32 s24, s21, 5
    s_add_u32 s23, s23, s24
    s_lshl_b32 s23, s23, 7
    s_add_u32 s23, s23, 21790720
    v_and_b32 v164, 63, v0
    v_lshlrev_b32 v164, 7, v164
    s_mov_b32 exec_lo, 0x7f
    s_mov_b32 exec_hi, 0x0
    s_mov_b32 s61, 262144
Lg39:
    buffer_load_dword v165, v164, s[8:11], s23 offen sc1
    s_waitcnt vmcnt(0)
    v_cmp_gt_u32 vcc, 1, v165
    s_nop 4
    s_cbranch_vccz Lg39x
    s_sleep 3
    s_sub_u32 s61, s61, 1
    s_cmp_lg_u32 s61, 0
    s_cbranch_scc1 Lg39
Lg39x:
    s_mov_b64 exec, -1
    s_mul_i32 s26, s32, 40960
    s_add_u32 s26, s26, s29
    s_add_u32 s32, s32, 1
    s_cmp_eq_u32 s32, s33
    s_cselect_b32 s32, 0, s32
    buffer_load_dwordx4 v[124:127], v1, s[8:11], s26 offen offset:0 sc1
    buffer_load_dwordx4 v[128:131], v1, s[8:11], s26 offen offset:256 sc1
    buffer_load_dwordx4 v[132:135], v1, s[8:11], s26 offen offset:512 sc1
    buffer_load_dwordx4 v[136:139], v1, s[8:11], s26 offen offset:768 sc1
    buffer_load_dwordx4 v[140:143], v1, s[8:11], s26 offen offset:1024 sc1
    s_mul_i32 s26, s32, 40960
    s_add_u32 s26, s26, s29
    s_add_u32 s32, s32, 1
    s_cmp_eq_u32 s32, s33
    s_cselect_b32 s32, 0, s32
    buffer_load_dwordx4 v[144:147], v1, s[8:11], s26 offen offset:0 sc1
    buffer_load_dwordx4 v[148:151], v1, s[8:11], s26 offen offset:256 sc1
    buffer_load_dwordx4 v[152:155], v1, s[8:11], s26 offen offset:512 sc1
    buffer_load_dwordx4 v[156:159], v1, s[8:11], s26 offen offset:768 sc1
    buffer_load_dwordx4 v[160:163], v1, s[8:11], s26 offen offset:1024 sc1
    v_lshlrev_b32 v86, 16, v86
    v_lshlrev_b32 v12, 16, v76
    v_and_b32 v13, 0xffff0000, v76
    v_lshlrev_b32 v14, 16, v77
    v_and_b32 v15, 0xffff0000, v77
    v_lshlrev_b32 v16, 16, v78
    v_and_b32 v17, 0xffff0000, v78
    v_lshlrev_b32 v18, 16, v79
    v_and_b32 v19, 0xffff0000, v79
    v_lshlrev_b32 v20, 16, v80
    v_and_b32 v21, 0xffff0000, v80
    v_lshlrev_b32 v22, 16, v81
    v_and_b32 v23, 0xffff0000, v81
    v_lshlrev_b32 v24, 16, v82
    v_and_b32 v25, 0xffff0000, v82
    v_lshlrev_b32 v26, 16, v83
    v_and_b32 v27, 0xffff0000, v83
    v_lshlrev_b32 v28, 16, v84
    v_and_b32 v29, 0xffff0000, v84
    v_lshlrev_b32 v30, 16, v85
    v_and_b32 v31, 0xffff0000, v85
    v_add_f32 v12, v12, v86
    v_add_f32 v13, v13, v86
    v_add_f32 v14, v14, v86
    v_add_f32 v15, v15, v86
    v_add_f32 v16, v16, v86
    v_add_f32 v17, v17, v86
    v_add_f32 v18, v18, v86
    v_add_f32 v19, v19, v86
    v_add_f32 v20, v20, v86
    v_add_f32 v21, v21, v86
    v_add_f32 v22, v22, v86
    v_add_f32 v23, v23, v86
    v_add_f32 v24, v24, v86
    v_add_f32 v25, v25, v86
    v_add_f32 v26, v26, v86
    v_add_f32 v27, v27, v86
    v_add_f32 v28, v28, v86
    v_add_f32 v29, v29, v86
    v_add_f32 v30, v30, v86
    v_add_f32 v31, v31, v86
    s_setprio 1
    s_waitcnt vmcnt(22)
    ds_read_b64_tr_b16 v[92:93], v3 offset:0
    ds_read_b64_tr_b16 v[94:95], v3 offset:2048
    ds_read_b64_tr_b16 v[96:97], v4 offset:0
    ds_read_b64_tr_b16 v[98:99], v4 offset:2048
    ds_read_b64_tr_b16 v[100:101], v5 offset:0
    ds_read_b64_tr_b16 v[102:103], v5 offset:2048
    ds_read_b64_tr_b16 v[104:105], v6 offset:0
    ds_read_b64_tr_b16 v[106:107], v6 offset:2048
    s_waitcnt lgkmcnt(0)
    s_mul_i32 s27, s31, 131072
    s_add_u32 s27, s27, s30
    s_add_u32 s31, s31, 1
    s_cmp_eq_u32 s31, s33
    s_cselect_b32 s31, 0, s31
    s_add_u32 m0, s28, 0
    s_nop 0
    buffer_load_dwordx4 v2, s[12:15], s27 offen  lds
    s_add_u32 m0, s28, 1024
    s_add_u32 s34, s27, 65536
    buffer_load_dwordx4 v2, s[12:15], s34 offen  lds
    s_add_u32 m0, s28, 2048
    s_add_u32 s34, s27, 16384
    buffer_load_dwordx4 v2, s[12:15], s34 offen  lds
    s_add_u32 m0, s28, 3072
    s_add_u32 s34, s27, 81920
    buffer_load_dwordx4 v2, s[12:15], s34 offen  lds
    s_waitcnt vmcnt(13) lgkmcnt(0)
    s_mul_i32 s26, s32, 40960
    s_add_u32 s26, s26, s29
    s_add_u32 s32, s32, 1
    s_cmp_eq_u32 s32, s33
    s_cselect_b32 s32, 0, s32
    v_mfma_f32_16x16x32_bf16 v[12:15], v[124:127], v[92:95], v[12:15]
    ds_read_b64_tr_b16 v[108:109], v3 offset:4096
    ds_read_b64_tr_b16 v[110:111], v3 offset:6144
    v_mfma_f32_16x16x32_bf16 v[32:35], v[124:127], v[96:99], 0
    ds_read_b64_tr_b16 v[112:113], v4 offset:4096
    ds_read_b64_tr_b16 v[114:115], v4 offset:6144
    v_mfma_f32_16x16x32_bf16 v[52:55], v[124:127], v[100:103], 0
    ds_read_b64_tr_b16 v[116:117], v5 offset:4096
    ds_read_b64_tr_b16 v[118:119], v5 offset:6144
    v_mfma_f32_16x16x32_bf16 v[72:75], v[124:127], v[104:107], 0
    ds_read_b64_tr_b16 v[120:121], v6 offset:4096
    ds_read_b64_tr_b16 v[122:123], v6 offset:6144
    buffer_load_dwordx4 v[124:127], v1, s[8:11], s26 offen offset:0 sc1
    s_waitcnt vmcnt(13)
    v_mfma_f32_16x16x32_bf16 v[16:19], v[128:131], v[92:95], v[16:19]
    v_mfma_f32_16x16x32_bf16 v[36:39], v[128:131], v[96:99], 0
    v_mfma_f32_16x16x32_bf16 v[56:59], v[128:131], v[100:103], 0
    v_mfma_f32_16x16x32_bf16 v[76:79], v[128:131], v[104:107], 0
    buffer_load_dwordx4 v[128:131], v1, s[8:11], s26 offen offset:256 sc1
    s_waitcnt vmcnt(13)
    s_waitcnt lgkmcnt(0)
    s_mul_i32 s27, s31, 131072
    s_add_u32 s27, s27, s30
    s_add_u32 s31, s31, 1
    s_cmp_eq_u32 s31, s33
    s_cselect_b32 s31, 0, s31
    v_mfma_f32_16x16x32_bf16 v[20:23], v[132:135], v[92:95], v[20:23]
    v_mfma_f32_16x16x32_bf16 v[40:43], v[132:135], v[96:99], 0
    s_add_u32 m0, s28, 4096
    s_nop 0
    buffer_load_dwordx4 v2, s[12:15], s27 offen  lds
    v_mfma_f32_16x16x32_bf16 v[60:63], v[132:135], v[100:103], 0
    v_mfma_f32_16x16x32_bf16 v[80:83], v[132:135], v[104:107], 0
    buffer_load_dwordx4 v[132:135], v1, s[8:11], s26 offen offset:512 sc1
    s_waitcnt vmcnt(14)
    v_mfma_f32_16x16x32_bf16 v[24:27], v[136:139], v[92:95], v[24:27]
    s_add_u32 m0, s28, 5120
    s_add_u32 s34, s27, 65536
    buffer_load_dwordx4 v2, s[12:15], s34 offen  lds
    v_mfma_f32_16x16x32_bf16 v[44:47], v[136:139], v[96:99], 0
    v_mfma_f32_16x16x32_bf16 v[64:67], v[136:139], v[100:103], 0
    s_add_u32 m0, s28, 6144
    s_add_u32 s34, s27, 16384
    buffer_load_dwordx4 v2, s[12:15], s34 offen  lds
    v_mfma_f32_16x16x32_bf16 v[84:87], v[136:139], v[104:107], 0
    buffer_load_dwordx4 v[136:139], v1, s[8:11], s26 offen offset:768 sc1
    s_waitcnt vmcnt(16)
    v_mfma_f32_16x16x32_bf16 v[28:31], v[140:143], v[92:95], v[28:31]
    v_mfma_f32_16x16x32_bf16 v[48:51], v[140:143], v[96:99], 0
    s_add_u32 m0, s28, 7168
    s_add_u32 s34, s27, 81920
    buffer_load_dwordx4 v2, s[12:15], s34 offen  lds
    v_mfma_f32_16x16x32_bf16 v[68:71], v[140:143], v[100:103], 0
    v_mfma_f32_16x16x32_bf16 v[88:91], v[140:143], v[104:107], 0
    buffer_load_dwordx4 v[140:143], v1, s[8:11], s26 offen offset:1024 sc1
    s_waitcnt vmcnt(17) lgkmcnt(0)
    s_mul_i32 s26, s32, 40960
    s_add_u32 s26, s26, s29
    s_add_u32 s32, s32, 1
    s_cmp_eq_u32 s32, s33
    s_cselect_b32 s32, 0, s32
    v_mfma_f32_16x16x32_bf16 v[12:15], v[144:147], v[108:111], v[12:15]
    ds_read_b64_tr_b16 v[92:93], v3 offset:8192
    ds_read_b64_tr_b16 v[94:95], v3 offset:10240
    v_mfma_f32_16x16x32_bf16 v[32:35], v[144:147], v[112:115], v[32:35]
    ds_read_b64_tr_b16 v[96:97], v4 offset:8192
    ds_read_b64_tr_b16 v[98:99], v4 offset:10240
    v_mfma_f32_16x16x32_bf16 v[52:55], v[144:147], v[116:119], v[52:55]
    ds_read_b64_tr_b16 v[100:101], v5 offset:8192
    ds_read_b64_tr_b16 v[102:103], v5 offset:10240
    v_mfma_f32_16x16x32_bf16 v[72:75], v[144:147], v[120:123], v[72:75]
    ds_read_b64_tr_b16 v[104:105], v6 offset:8192
    ds_read_b64_tr_b16 v[106:107], v6 offset:10240
    buffer_load_dwordx4 v[144:147], v1, s[8:11], s26 offen offset:0 sc1
    s_waitcnt vmcnt(17)
    v_mfma_f32_16x16x32_bf16 v[16:19], v[148:151], v[108:111], v[16:19]
    v_mfma_f32_16x16x32_bf16 v[36:39], v[148:151], v[112:115], v[36:39]
    v_mfma_f32_16x16x32_bf16 v[56:59], v[148:151], v[116:119], v[56:59]
    v_mfma_f32_16x16x32_bf16 v[76:79], v[148:151], v[120:123], v[76:79]
    buffer_load_dwordx4 v[148:151], v1, s[8:11], s26 offen offset:256 sc1
    s_waitcnt vmcnt(17)
    s_waitcnt lgkmcnt(0)
    s_mul_i32 s27, s31, 131072
    s_add_u32 s27, s27, s30
    s_add_u32 s31, s31, 1
    s_cmp_eq_u32 s31, s33
    s_cselect_b32 s31, 0, s31
    v_mfma_f32_16x16x32_bf16 v[20:23], v[152:155], v[108:111], v[20:23]
    v_mfma_f32_16x16x32_bf16 v[40:43], v[152:155], v[112:115], v[40:43]
    s_add_u32 m0, s28, 8192
    s_nop 0
    buffer_load_dwordx4 v2, s[12:15], s27 offen  lds
    v_mfma_f32_16x16x32_bf16 v[60:63], v[152:155], v[116:119], v[60:63]
    v_mfma_f32_16x16x32_bf16 v[80:83], v[152:155], v[120:123], v[80:83]
    buffer_load_dwordx4 v[152:155], v1, s[8:11], s26 offen offset:512 sc1
    s_waitcnt vmcnt(18)
    v_mfma_f32_16x16x32_bf16 v[24:27], v[156:159], v[108:111], v[24:27]
    s_add_u32 m0, s28, 9216
    s_add_u32 s34, s27, 65536
    buffer_load_dwordx4 v2, s[12:15], s34 offen  lds
    v_mfma_f32_16x16x32_bf16 v[44:47], v[156:159], v[112:115], v[44:47]
    v_mfma_f32_16x16x32_bf16 v[64:67], v[156:159], v[116:119], v[64:67]
    s_add_u32 m0, s28, 10240
    s_add_u32 s34, s27, 16384
    buffer_load_dwordx4 v2, s[12:15], s34 offen  lds
    v_mfma_f32_16x16x32_bf16 v[84:87], v[156:159], v[120:123], v[84:87]
    buffer_load_dwordx4 v[156:159], v1, s[8:11], s26 offen offset:768 sc1
    s_waitcnt vmcnt(20)
    v_mfma_f32_16x16x32_bf16 v[28:31], v[160:163], v[108:111], v[28:31]
    v_mfma_f32_16x16x32_bf16 v[48:51], v[160:163], v[112:115], v[48:51]
    s_add_u32 m0, s28, 11264
    s_add_u32 s34, s27, 81920
    buffer_load_dwordx4 v2, s[12:15], s34 offen  lds
    v_mfma_f32_16x16x32_bf16 v[68:71], v[160:163], v[116:119], v[68:71]
    v_mfma_f32_16x16x32_bf16 v[88:91], v[160:163], v[120:123], v[88:91]
    buffer_load_dwordx4 v[160:163], v1, s[8:11], s26 offen offset:1024 sc1
    s_waitcnt vmcnt(17) lgkmcnt(0)
    s_mul_i32 s26, s32, 40960
    s_add_u32 s26, s26, s29
    s_add_u32 s32, s32, 1
    s_cmp_eq_u32 s32, s33
    s_cselect_b32 s32, 0, s32
    v_mfma_f32_16x16x32_bf16 v[12:15], v[124:127], v[92:95], v[12:15]
    ds_read_b64_tr_b16 v[108:109], v3 offset:12288
    ds_read_b64_tr_b16 v[110:111], v3 offset:14336
    v_mfma_f32_16x16x32_bf16 v[32:35], v[124:127], v[96:99], v[32:35]
    ds_read_b64_tr_b16 v[112:113], v4 offset:12288
    ds_read_b64_tr_b16 v[114:115], v4 offset:14336
    v_mfma_f32_16x16x32_bf16 v[52:55], v[124:127], v[100:103], v[52:55]
    ds_read_b64_tr_b16 v[116:117], v5 offset:12288
    ds_read_b64_tr_b16 v[118:119], v5 offset:14336
    v_mfma_f32_16x16x32_bf16 v[72:75], v[124:127], v[104:107], v[72:75]
    ds_read_b64_tr_b16 v[120:121], v6 offset:12288
    ds_read_b64_tr_b16 v[122:123], v6 offset:14336
    buffer_load_dwordx4 v[124:127], v1, s[8:11], s26 offen offset:0 sc1
    s_waitcnt vmcnt(17)
    v_mfma_f32_16x16x32_bf16 v[16:19], v[128:131], v[92:95], v[16:19]
    v_mfma_f32_16x16x32_bf16 v[36:39], v[128:131], v[96:99], v[36:39]
    v_mfma_f32_16x16x32_bf16 v[56:59], v[128:131], v[100:103], v[56:59]
    v_mfma_f32_16x16x32_bf16 v[76:79], v[128:131], v[104:107], v[76:79]
    buffer_load_dwordx4 v[128:131], v1, s[8:11], s26 offen offset:256 sc1
    s_waitcnt vmcnt(16)
    s_waitcnt lgkmcnt(0)
    s_mul_i32 s27, s31, 131072
    s_add_u32 s27, s27, s30
    s_add_u32 s31, s31, 1
    s_cmp_eq_u32 s31, s33
    s_cselect_b32 s31, 0, s31
    v_mfma_f32_16x16x32_bf16 v[20:23], v[132:135], v[92:95], v[20:23]
    v_mfma_f32_16x16x32_bf16 v[40:43], v[132:135], v[96:99], v[40:43]
    s_add_u32 m0, s28, 12288
    s_nop 0
    buffer_load_dwordx4 v2, s[12:15], s27 offen  lds
    v_mfma_f32_16x16x32_bf16 v[60:63], v[132:135], v[100:103], v[60:63]
    v_mfma_f32_16x16x32_bf16 v[80:83], v[132:135], v[104:107], v[80:83]
    buffer_load_dwordx4 v[132:135], v1, s[8:11], s26 offen offset:512 sc1
    s_waitcnt vmcnt(15)
    v_mfma_f32_16x16x32_bf16 v[24:27], v[136:139], v[92:95], v[24:27]
    s_add_u32 m0, s28, 13312
    s_add_u32 s34, s27, 65536
    buffer_load_dwordx4 v2, s[12:15], s34 offen  lds
    v_mfma_f32_16x16x32_bf16 v[44:47], v[136:139], v[96:99], v[44:47]
    v_mfma_f32_16x16x32_bf16 v[64:67], v[136:139], v[100:103], v[64:67]
    s_add_u32 m0, s28, 14336
    s_add_u32 s34, s27, 16384
    buffer_load_dwordx4 v2, s[12:15], s34 offen  lds
    v_mfma_f32_16x16x32_bf16 v[84:87], v[136:139], v[104:107], v[84:87]
    buffer_load_dwordx4 v[136:139], v1, s[8:11], s26 offen offset:768 sc1
    s_waitcnt vmcnt(16)
    v_mfma_f32_16x16x32_bf16 v[28:31], v[140:143], v[92:95], v[28:31]
    v_mfma_f32_16x16x32_bf16 v[48:51], v[140:143], v[96:99], v[48:51]
    s_add_u32 m0, s28, 15360
    s_add_u32 s34, s27, 81920
    buffer_load_dwordx4 v2, s[12:15], s34 offen  lds
    v_mfma_f32_16x16x32_bf16 v[68:71], v[140:143], v[100:103], v[68:71]
    v_mfma_f32_16x16x32_bf16 v[88:91], v[140:143], v[104:107], v[88:91]
    buffer_load_dwordx4 v[140:143], v1, s[8:11], s26 offen offset:1024 sc1
    s_waitcnt vmcnt(17) lgkmcnt(0)
    s_mul_i32 s26, s32, 40960
    s_add_u32 s26, s26, s29
    s_add_u32 s32, s32, 1
    s_cmp_eq_u32 s32, s33
    s_cselect_b32 s32, 0, s32
    v_mfma_f32_16x16x32_bf16 v[12:15], v[144:147], v[108:111], v[12:15]
    ds_read_b64_tr_b16 v[92:93], v3 offset:0
    ds_read_b64_tr_b16 v[94:95], v3 offset:2048
    v_mfma_f32_16x16x32_bf16 v[32:35], v[144:147], v[112:115], v[32:35]
    ds_read_b64_tr_b16 v[96:97], v4 offset:0
    ds_read_b64_tr_b16 v[98:99], v4 offset:2048
    v_mfma_f32_16x16x32_bf16 v[52:55], v[144:147], v[116:119], v[52:55]
    ds_read_b64_tr_b16 v[100:101], v5 offset:0
    ds_read_b64_tr_b16 v[102:103], v5 offset:2048
    v_mfma_f32_16x16x32_bf16 v[72:75], v[144:147], v[120:123], v[72:75]
    ds_read_b64_tr_b16 v[104:105], v6 offset:0
    ds_read_b64_tr_b16 v[106:107], v6 offset:2048
    buffer_load_dwordx4 v[144:147], v1, s[8:11], s26 offen offset:0 sc1
    s_waitcnt vmcnt(17)
    v_mfma_f32_16x16x32_bf16 v[16:19], v[148:151], v[108:111], v[16:19]
    v_mfma_f32_16x16x32_bf16 v[36:39], v[148:151], v[112:115], v[36:39]
    v_mfma_f32_16x16x32_bf16 v[56:59], v[148:151], v[116:119], v[56:59]
    v_mfma_f32_16x16x32_bf16 v[76:79], v[148:151], v[120:123], v[76:79]
    buffer_load_dwordx4 v[148:151], v1, s[8:11], s26 offen offset:256 sc1
    s_waitcnt vmcnt(16)
    s_waitcnt lgkmcnt(0)
    s_mul_i32 s27, s31, 131072
    s_add_u32 s27, s27, s30
    s_add_u32 s31, s31, 1
    s_cmp_eq_u32 s31, s33
    s_cselect_b32 s31, 0, s31
    v_mfma_f32_16x16x32_bf16 v[20:23], v[152:155], v[108:111], v[20:23]
    v_mfma_f32_16x16x32_bf16 v[40:43], v[152:155], v[112:115], v[40:43]
    s_add_u32 m0, s28, 0
    s_nop 0
    buffer_load_dwordx4 v2, s[12:15], s27 offen  lds
    v_mfma_f32_16x16x32_bf16 v[60:63], v[152:155], v[116:119], v[60:63]
    v_mfma_f32_16x16x32_bf16 v[80:83], v[152:155], v[120:123], v[80:83]
    buffer_load_dwordx4 v[152:155], v1, s[8:11], s26 offen offset:512 sc1
    s_waitcnt vmcnt(15)
    v_mfma_f32_16x16x32_bf16 v[24:27], v[156:159], v[108:111], v[24:27]
    s_add_u32 m0, s28, 1024
    s_add_u32 s34, s27, 65536
    buffer_load_dwordx4 v2, s[12:15], s34 offen  lds
    v_mfma_f32_16x16x32_bf16 v[44:47], v[156:159], v[112:115], v[44:47]
    v_mfma_f32_16x16x32_bf16 v[64:67], v[156:159], v[116:119], v[64:67]
    s_add_u32 m0, s28, 2048
    s_add_u32 s34, s27, 16384
    buffer_load_dwordx4 v2, s[12:15], s34 offen  lds
    v_mfma_f32_16x16x32_bf16 v[84:87], v[156:159], v[120:123], v[84:87]
    buffer_load_dwordx4 v[156:159], v1, s[8:11], s26 offen offset:768 sc1
    s_waitcnt vmcnt(16)
    v_mfma_f32_16x16x32_bf16 v[28:31], v[160:163], v[108:111], v[28:31]
    v_mfma_f32_16x16x32_bf16 v[48:51], v[160:163], v[112:115], v[48:51]
    s_add_u32 m0, s28, 3072
    s_add_u32 s34, s27, 81920
    buffer_load_dwordx4 v2, s[12:15], s34 offen  lds
    v_mfma_f32_16x16x32_bf16 v[68:71], v[160:163], v[116:119], v[68:71]
    v_mfma_f32_16x16x32_bf16 v[88:91], v[160:163], v[120:123], v[88:91]
    buffer_load_dwordx4 v[160:163], v1, s[8:11], s26 offen offset:1024 sc1
    s_waitcnt vmcnt(17) lgkmcnt(0)
    s_mul_i32 s26, s32, 40960
    s_add_u32 s26, s26, s29
    s_add_u32 s32, s32, 1
    s_cmp_eq_u32 s32, s33
    s_cselect_b32 s32, 0, s32
    v_mfma_f32_16x16x32_bf16 v[12:15], v[124:127], v[92:95], v[12:15]
    ds_read_b64_tr_b16 v[108:109], v3 offset:4096
    ds_read_b64_tr_b16 v[110:111], v3 offset:6144
    v_mfma_f32_16x16x32_bf16 v[32:35], v[124:127], v[96:99], v[32:35]
    ds_read_b64_tr_b16 v[112:113], v4 offset:4096
    ds_read_b64_tr_b16 v[114:115], v4 offset:6144
    v_mfma_f32_16x16x32_bf16 v[52:55], v[124:127], v[100:103], v[52:55]
    ds_read_b64_tr_b16 v[116:117], v5 offset:4096
    ds_read_b64_tr_b16 v[118:119], v5 offset:6144
    v_mfma_f32_16x16x32_bf16 v[72:75], v[124:127], v[104:107], v[72:75]
    ds_read_b64_tr_b16 v[120:121], v6 offset:4096
    ds_read_b64_tr_b16 v[122:123], v6 offset:6144
    buffer_load_dwordx4 v[124:127], v1, s[8:11], s26 offen offset:0 sc1
    s_waitcnt vmcnt(17)
    v_mfma_f32_16x16x32_bf16 v[16:19], v[128:131], v[92:95], v[16:19]
    v_mfma_f32_16x16x32_bf16 v[36:39], v[128:131], v[96:99], v[36:39]
    v_mfma_f32_16x16x32_bf16 v[56:59], v[128:131], v[100:103], v[56:59]
    v_mfma_f32_16x16x32_bf16 v[76:79], v[128:131], v[104:107], v[76:79]
    buffer_load_dwordx4 v[128:131], v1, s[8:11], s26 offen offset:256 sc1
    s_waitcnt vmcnt(16)
    s_waitcnt lgkmcnt(0)
    s_mul_i32 s27, s31, 131072
    s_add_u32 s27, s27, s30
    s_add_u32 s31, s31, 1
    s_cmp_eq_u32 s31, s33
    s_cselect_b32 s31, 0, s31
    v_mfma_f32_16x16x32_bf16 v[20:23], v[132:135], v[92:95], v[20:23]
    v_mfma_f32_16x16x32_bf16 v[40:43], v[132:135], v[96:99], v[40:43]
    s_add_u32 m0, s28, 4096
    s_nop 0
    buffer_load_dwordx4 v2, s[12:15], s27 offen  lds
    v_mfma_f32_16x16x32_bf16 v[60:63], v[132:135], v[100:103], v[60:63]
    v_mfma_f32_16x16x32_bf16 v[80:83], v[132:135], v[104:107], v[80:83]
    buffer_load_dwordx4 v[132:135], v1, s[8:11], s26 offen offset:512 sc1
    s_waitcnt vmcnt(15)
    v_mfma_f32_16x16x32_bf16 v[24:27], v[136:139], v[92:95], v[24:27]
    s_add_u32 m0, s28, 5120
    s_add_u32 s34, s27, 65536
    buffer_load_dwordx4 v2, s[12:15], s34 offen  lds
    v_mfma_f32_16x16x32_bf16 v[44:47], v[136:139], v[96:99], v[44:47]
    v_mfma_f32_16x16x32_bf16 v[64:67], v[136:139], v[100:103], v[64:67]
    s_add_u32 m0, s28, 6144
    s_add_u32 s34, s27, 16384
    buffer_load_dwordx4 v2, s[12:15], s34 offen  lds
    v_mfma_f32_16x16x32_bf16 v[84:87], v[136:139], v[104:107], v[84:87]
    buffer_load_dwordx4 v[136:139], v1, s[8:11], s26 offen offset:768 sc1
    s_waitcnt vmcnt(16)
    v_mfma_f32_16x16x32_bf16 v[28:31], v[140:143], v[92:95], v[28:31]
    v_mfma_f32_16x16x32_bf16 v[48:51], v[140:143], v[96:99], v[48:51]
    s_add_u32 m0, s28, 7168
    s_add_u32 s34, s27, 81920
    buffer_load_dwordx4 v2, s[12:15], s34 offen  lds
    v_mfma_f32_16x16x32_bf16 v[68:71], v[140:143], v[100:103], v[68:71]
    v_mfma_f32_16x16x32_bf16 v[88:91], v[140:143], v[104:107], v[88:91]
    buffer_load_dwordx4 v[140:143], v1, s[8:11], s26 offen offset:1024 sc1
    s_waitcnt vmcnt(17) lgkmcnt(0)
    s_mul_i32 s26, s32, 40960
    s_add_u32 s26, s26, s29
    s_add_u32 s32, s32, 1
    s_cmp_eq_u32 s32, s33
    s_cselect_b32 s32, 0, s32
    v_mfma_f32_16x16x32_bf16 v[12:15], v[144:147], v[108:111], v[12:15]
    ds_read_b64_tr_b16 v[92:93], v3 offset:8192
    ds_read_b64_tr_b16 v[94:95], v3 offset:10240
    v_mfma_f32_16x16x32_bf16 v[32:35], v[144:147], v[112:115], v[32:35]
    ds_read_b64_tr_b16 v[96:97], v4 offset:8192
    ds_read_b64_tr_b16 v[98:99], v4 offset:10240
    v_mfma_f32_16x16x32_bf16 v[52:55], v[144:147], v[116:119], v[52:55]
    ds_read_b64_tr_b16 v[100:101], v5 offset:8192
    ds_read_b64_tr_b16 v[102:103], v5 offset:10240
    v_mfma_f32_16x16x32_bf16 v[72:75], v[144:147], v[120:123], v[72:75]
    ds_read_b64_tr_b16 v[104:105], v6 offset:8192
    ds_read_b64_tr_b16 v[106:107], v6 offset:10240
    buffer_load_dwordx4 v[144:147], v1, s[8:11], s26 offen offset:0 sc1
    s_waitcnt vmcnt(17)
    v_mfma_f32_16x16x32_bf16 v[16:19], v[148:151], v[108:111], v[16:19]
    v_mfma_f32_16x16x32_bf16 v[36:39], v[148:151], v[112:115], v[36:39]
    v_mfma_f32_16x16x32_bf16 v[56:59], v[148:151], v[116:119], v[56:59]
    v_mfma_f32_16x16x32_bf16 v[76:79], v[148:151], v[120:123], v[76:79]
    buffer_load_dwordx4 v[148:151], v1, s[8:11], s26 offen offset:256 sc1
    s_waitcnt vmcnt(16)
    s_waitcnt lgkmcnt(0)
    s_mul_i32 s27, s31, 131072
    s_add_u32 s27, s27, s30
    s_add_u32 s31, s31, 1
    s_cmp_eq_u32 s31, s33
    s_cselect_b32 s31, 0, s31
    v_mfma_f32_16x16x32_bf16 v[20:23], v[152:155], v[108:111], v[20:23]
    v_mfma_f32_16x16x32_bf16 v[40:43], v[152:155], v[112:115], v[40:43]
    s_add_u32 m0, s28, 8192
    s_nop 0
    buffer_load_dwordx4 v2, s[12:15], s27 offen  lds
    v_mfma_f32_16x16x32_bf16 v[60:63], v[152:155], v[116:119], v[60:63]
    v_mfma_f32_16x16x32_bf16 v[80:83], v[152:155], v[120:123], v[80:83]
    buffer_load_dwordx4 v[152:155], v1, s[8:11], s26 offen offset:512 sc1
    s_waitcnt vmcnt(15)
    v_mfma_f32_16x16x32_bf16 v[24:27], v[156:159], v[108:111], v[24:27]
    s_add_u32 m0, s28, 9216
    s_add_u32 s34, s27, 65536
    buffer_load_dwordx4 v2, s[12:15], s34 offen  lds
    v_mfma_f32_16x16x32_bf16 v[44:47], v[156:159], v[112:115], v[44:47]
    v_mfma_f32_16x16x32_bf16 v[64:67], v[156:159], v[116:119], v[64:67]
    s_add_u32 m0, s28, 10240
    s_add_u32 s34, s27, 16384
    buffer_load_dwordx4 v2, s[12:15], s34 offen  lds
    v_mfma_f32_16x16x32_bf16 v[84:87], v[156:159], v[120:123], v[84:87]
    buffer_load_dwordx4 v[156:159], v1, s[8:11], s26 offen offset:768 sc1
    s_waitcnt vmcnt(16)
    v_mfma_f32_16x16x32_bf16 v[28:31], v[160:163], v[108:111], v[28:31]
    v_mfma_f32_16x16x32_bf16 v[48:51], v[160:163], v[112:115], v[48:51]
    s_add_u32 m0, s28, 11264
    s_add_u32 s34, s27, 81920
    buffer_load_dwordx4 v2, s[12:15], s34 offen  lds
    v_mfma_f32_16x16x32_bf16 v[68:71], v[160:163], v[116:119], v[68:71]
    v_mfma_f32_16x16x32_bf16 v[88:91], v[160:163], v[120:123], v[88:91]
    buffer_load_dwordx4 v[160:163], v1, s[8:11], s26 offen offset:1024 sc1
    s_waitcnt vmcnt(17) lgkmcnt(0)
    s_mul_i32 s26, s32, 40960
    s_add_u32 s26, s26, s29
    s_add_u32 s32, s32, 1
    s_cmp_eq_u32 s32, s33
    s_cselect_b32 s32, 0, s32
    v_mfma_f32_16x16x32_bf16 v[12:15], v[124:127], v[92:95], v[12:15]
    ds_read_b64_tr_b16 v[108:109], v3 offset:12288
    ds_read_b64_tr_b16 v[110:111], v3 offset:14336
    v_mfma_f32_16x16x32_bf16 v[32:35], v[124:127], v[96:99], v[32:35]
    ds_read_b64_tr_b16 v[112:113], v4 offset:12288
    ds_read_b64_tr_b16 v[114:115], v4 offset:14336
    v_mfma_f32_16x16x32_bf16 v[52:55], v[124:127], v[100:103], v[52:55]
    ds_read_b64_tr_b16 v[116:117], v5 offset:12288
    ds_read_b64_tr_b16 v[118:119], v5 offset:14336
    v_mfma_f32_16x16x32_bf16 v[72:75], v[124:127], v[104:107], v[72:75]
    ds_read_b64_tr_b16 v[120:121], v6 offset:12288
    ds_read_b64_tr_b16 v[122:123], v6 offset:14336
    buffer_load_dwordx4 v[124:127], v1, s[8:11], s26 offen offset:0 sc1
    s_waitcnt vmcnt(17)
    v_mfma_f32_16x16x32_bf16 v[16:19], v[128:131], v[92:95], v[16:19]
    v_mfma_f32_16x16x32_bf16 v[36:39], v[128:131], v[96:99], v[36:39]
    v_mfma_f32_16x16x32_bf16 v[56:59], v[128:131], v[100:103], v[56:59]
    v_mfma_f32_16x16x32_bf16 v[76:79], v[128:131], v[104:107], v[76:79]
    buffer_load_dwordx4 v[128:131], v1, s[8:11], s26 offen offset:256 sc1
    s_waitcnt vmcnt(16)
    s_waitcnt lgkmcnt(0)
    s_mul_i32 s27, s31, 131072
    s_add_u32 s27, s27, s30
    s_add_u32 s31, s31, 1
    s_cmp_eq_u32 s31, s33
    s_cselect_b32 s31, 0, s31
    v_mfma_f32_16x16x32_bf16 v[20:23], v[132:135], v[92:95], v[20:23]
    v_mfma_f32_16x16x32_bf16 v[40:43], v[132:135], v[96:99], v[40:43]
    s_add_u32 m0, s28, 12288
    s_nop 0
    buffer_load_dwordx4 v2, s[12:15], s27 offen  lds
    v_mfma_f32_16x16x32_bf16 v[60:63], v[132:135], v[100:103], v[60:63]
    v_mfma_f32_16x16x32_bf16 v[80:83], v[132:135], v[104:107], v[80:83]
    buffer_load_dwordx4 v[132:135], v1, s[8:11], s26 offen offset:512 sc1
    s_waitcnt vmcnt(15)
    v_mfma_f32_16x16x32_bf16 v[24:27], v[136:139], v[92:95], v[24:27]
    s_add_u32 m0, s28, 13312
    s_add_u32 s34, s27, 65536
    buffer_load_dwordx4 v2, s[12:15], s34 offen  lds
    v_mfma_f32_16x16x32_bf16 v[44:47], v[136:139], v[96:99], v[44:47]
    v_mfma_f32_16x16x32_bf16 v[64:67], v[136:139], v[100:103], v[64:67]
    s_add_u32 m0, s28, 14336
    s_add_u32 s34, s27, 16384
    buffer_load_dwordx4 v2, s[12:15], s34 offen  lds
    v_mfma_f32_16x16x32_bf16 v[84:87], v[136:139], v[104:107], v[84:87]
    buffer_load_dwordx4 v[136:139], v1, s[8:11], s26 offen offset:768 sc1
    s_waitcnt vmcnt(16)
    v_mfma_f32_16x16x32_bf16 v[28:31], v[140:143], v[92:95], v[28:31]
    v_mfma_f32_16x16x32_bf16 v[48:51], v[140:143], v[96:99], v[48:51]
    s_add_u32 m0, s28, 15360
    s_add_u32 s34, s27, 81920
    buffer_load_dwordx4 v2, s[12:15], s34 offen  lds
    v_mfma_f32_16x16x32_bf16 v[68:71], v[140:143], v[100:103], v[68:71]
    v_mfma_f32_16x16x32_bf16 v[88:91], v[140:143], v[104:107], v[88:91]
    buffer_load_dwordx4 v[140:143], v1, s[8:11], s26 offen offset:1024 sc1
    s_waitcnt vmcnt(17) lgkmcnt(0)
    s_mul_i32 s26, s32, 40960
    s_add_u32 s26, s26, s29
    s_add_u32 s32, s32, 1
    s_cmp_eq_u32 s32, s33
    s_cselect_b32 s32, 0, s32
    v_mfma_f32_16x16x32_bf16 v[12:15], v[144:147], v[108:111], v[12:15]
    ds_read_b64_tr_b16 v[92:93], v3 offset:0
    ds_read_b64_tr_b16 v[94:95], v3 offset:2048
    v_mfma_f32_16x16x32_bf16 v[32:35], v[144:147], v[112:115], v[32:35]
    ds_read_b64_tr_b16 v[96:97], v4 offset:0
    ds_read_b64_tr_b16 v[98:99], v4 offset:2048
    v_mfma_f32_16x16x32_bf16 v[52:55], v[144:147], v[116:119], v[52:55]
    ds_read_b64_tr_b16 v[100:101], v5 offset:0
    ds_read_b64_tr_b16 v[102:103], v5 offset:2048
    v_mfma_f32_16x16x32_bf16 v[72:75], v[144:147], v[120:123], v[72:75]
    ds_read_b64_tr_b16 v[104:105], v6 offset:0
    ds_read_b64_tr_b16 v[106:107], v6 offset:2048
    buffer_load_dwordx4 v[144:147], v1, s[8:11], s26 offen offset:0 sc1
    s_waitcnt vmcnt(17)
    v_mfma_f32_16x16x32_bf16 v[16:19], v[148:151], v[108:111], v[16:19]
    v_mfma_f32_16x16x32_bf16 v[36:39], v[148:151], v[112:115], v[36:39]
    v_mfma_f32_16x16x32_bf16 v[56:59], v[148:151], v[116:119], v[56:59]
    v_mfma_f32_16x16x32_bf16 v[76:79], v[148:151], v[120:123], v[76:79]
    buffer_load_dwordx4 v[148:151], v1, s[8:11], s26 offen offset:256 sc1
    s_waitcnt vmcnt(16)
    s_waitcnt lgkmcnt(0)
    s_mul_i32 s27, s31, 131072
    s_add_u32 s27, s27, s30
    s_add_u32 s31, s31, 1
    s_cmp_eq_u32 s31, s33
    s_cselect_b32 s31, 0, s31
    v_mfma_f32_16x16x32_bf16 v[20:23], v[152:155], v[108:111], v[20:23]
    v_mfma_f32_16x16x32_bf16 v[40:43], v[152:155], v[112:115], v[40:43]
    s_add_u32 m0, s28, 0
    s_nop 0
    buffer_load_dwordx4 v2, s[12:15], s27 offen  lds
    v_mfma_f32_16x16x32_bf16 v[60:63], v[152:155], v[116:119], v[60:63]
    v_mfma_f32_16x16x32_bf16 v[80:83], v[152:155], v[120:123], v[80:83]
    buffer_load_dwordx4 v[152:155], v1, s[8:11], s26 offen offset:512 sc1
    s_waitcnt vmcnt(15)
    v_mfma_f32_16x16x32_bf16 v[24:27], v[156:159], v[108:111], v[24:27]
    s_add_u32 m0, s28, 1024
    s_add_u32 s34, s27, 65536
    buffer_load_dwordx4 v2, s[12:15], s34 offen  lds
    v_mfma_f32_16x16x32_bf16 v[44:47], v[156:159], v[112:115], v[44:47]
    v_mfma_f32_16x16x32_bf16 v[64:67], v[156:159], v[116:119], v[64:67]
    s_add_u32 m0, s28, 2048
    s_add_u32 s34, s27, 16384
    buffer_load_dwordx4 v2, s[12:15], s34 offen  lds
    v_mfma_f32_16x16x32_bf16 v[84:87], v[156:159], v[120:123], v[84:87]
    buffer_load_dwordx4 v[156:159], v1, s[8:11], s26 offen offset:768 sc1
    s_waitcnt vmcnt(16)
    v_mfma_f32_16x16x32_bf16 v[28:31], v[160:163], v[108:111], v[28:31]
    v_mfma_f32_16x16x32_bf16 v[48:51], v[160:163], v[112:115], v[48:51]
    s_add_u32 m0, s28, 3072
    s_add_u32 s34, s27, 81920
    buffer_load_dwordx4 v2, s[12:15], s34 offen  lds
    v_mfma_f32_16x16x32_bf16 v[68:71], v[160:163], v[116:119], v[68:71]
    v_mfma_f32_16x16x32_bf16 v[88:91], v[160:163], v[120:123], v[88:91]
    buffer_load_dwordx4 v[160:163], v1, s[8:11], s26 offen offset:1024 sc1
    s_waitcnt vmcnt(17) lgkmcnt(0)
    s_mul_i32 s26, s32, 40960
    s_add_u32 s26, s26, s29
    s_add_u32 s32, s32, 1
    s_cmp_eq_u32 s32, s33
    s_cselect_b32 s32, 0, s32
    v_mfma_f32_16x16x32_bf16 v[12:15], v[124:127], v[92:95], v[12:15]
    ds_read_b64_tr_b16 v[108:109], v3 offset:4096
    ds_read_b64_tr_b16 v[110:111], v3 offset:6144
    v_mfma_f32_16x16x32_bf16 v[32:35], v[124:127], v[96:99], v[32:35]
    ds_read_b64_tr_b16 v[112:113], v4 offset:4096
    ds_read_b64_tr_b16 v[114:115], v4 offset:6144
    v_mfma_f32_16x16x32_bf16 v[52:55], v[124:127], v[100:103], v[52:55]
    ds_read_b64_tr_b16 v[116:117], v5 offset:4096
    ds_read_b64_tr_b16 v[118:119], v5 offset:6144
    v_mfma_f32_16x16x32_bf16 v[72:75], v[124:127], v[104:107], v[72:75]
    ds_read_b64_tr_b16 v[120:121], v6 offset:4096
    ds_read_b64_tr_b16 v[122:123], v6 offset:6144
    buffer_load_dwordx4 v[124:127], v1, s[8:11], s26 offen offset:0 sc1
    s_waitcnt vmcnt(17)
    v_mfma_f32_16x16x32_bf16 v[16:19], v[128:131], v[92:95], v[16:19]
    v_mfma_f32_16x16x32_bf16 v[36:39], v[128:131], v[96:99], v[36:39]
    v_mfma_f32_16x16x32_bf16 v[56:59], v[128:131], v[100:103], v[56:59]
    v_mfma_f32_16x16x32_bf16 v[76:79], v[128:131], v[104:107], v[76:79]
    buffer_load_dwordx4 v[128:131], v1, s[8:11], s26 offen offset:256 sc1
    s_waitcnt vmcnt(16)
    s_waitcnt lgkmcnt(0)
    s_mul_i32 s27, s31, 131072
    s_add_u32 s27, s27, s30
    s_cmp_lt_u32 s33, 14
    s_cselect_b32 s27, 2130706432, s27
    s_add_u32 s31, s31, 1
    s_cmp_eq_u32 s31, s33
    s_cselect_b32 s31, 0, s31
    v_mfma_f32_16x16x32_bf16 v[20:23], v[132:135], v[92:95], v[20:23]
    v_mfma_f32_16x16x32_bf16 v[40:43], v[132:135], v[96:99], v[40:43]
    s_add_u32 m0, s28, 4096
    s_nop 0
    buffer_load_dwordx4 v2, s[12:15], s27 offen  lds
    v_mfma_f32_16x16x32_bf16 v[60:63], v[132:135], v[100:103], v[60:63]
    v_mfma_f32_16x16x32_bf16 v[80:83], v[132:135], v[104:107], v[80:83]
    buffer_load_dwordx4 v[132:135], v1, s[8:11], s26 offen offset:512 sc1
    s_waitcnt vmcnt(15)
    v_mfma_f32_16x16x32_bf16 v[24:27], v[136:139], v[92:95], v[24:27]
    s_add_u32 m0, s28, 5120
    s_add_u32 s34, s27, 65536
    buffer_load_dwordx4 v2, s[12:15], s34 offen  lds
    v_mfma_f32_16x16x32_bf16 v[44:47], v[136:139], v[96:99], v[44:47]
    v_mfma_f32_16x16x32_bf16 v[64:67], v[136:139], v[100:103], v[64:67]
    s_add_u32 m0, s28, 6144
    s_add_u32 s34, s27, 16384
    buffer_load_dwordx4 v2, s[12:15], s34 offen  lds
    v_mfma_f32_16x16x32_bf16 v[84:87], v[136:139], v[104:107], v[84:87]
    buffer_load_dwordx4 v[136:139], v1, s[8:11], s26 offen offset:768 sc1
    s_waitcnt vmcnt(16)
    v_mfma_f32_16x16x32_bf16 v[28:31], v[140:143], v[92:95], v[28:31]
    v_mfma_f32_16x16x32_bf16 v[48:51], v[140:143], v[96:99], v[48:51]
    s_add_u32 m0, s28, 7168
    s_add_u32 s34, s27, 81920
    buffer_load_dwordx4 v2, s[12:15], s34 offen  lds
    v_mfma_f32_16x16x32_bf16 v[68:71], v[140:143], v[100:103], v[68:71]
    v_mfma_f32_16x16x32_bf16 v[88:91], v[140:143], v[104:107], v[88:91]
    buffer_load_dwordx4 v[140:143], v1, s[8:11], s26 offen offset:1024 sc1
    s_waitcnt vmcnt(17) lgkmcnt(0)
    s_mul_i32 s26, s32, 40960
    s_add_u32 s26, s26, s29
    s_add_u32 s32, s32, 1
    s_cmp_eq_u32 s32, s33
    s_cselect_b32 s32, 0, s32
    v_mfma_f32_16x16x32_bf16 v[12:15], v[144:147], v[108:111], v[12:15]
    ds_read_b64_tr_b16 v[92:93], v3 offset:8192
    ds_read_b64_tr_b16 v[94:95], v3 offset:10240
    v_mfma_f32_16x16x32_bf16 v[32:35], v[144:147], v[112:115], v[32:35]
    ds_read_b64_tr_b16 v[96:97], v4 offset:8192
    ds_read_b64_tr_b16 v[98:99], v4 offset:10240
    v_mfma_f32_16x16x32_bf16 v[52:55], v[144:147], v[116:119], v[52:55]
    ds_read_b64_tr_b16 v[100:101], v5 offset:8192
    ds_read_b64_tr_b16 v[102:103], v5 offset:10240
    v_mfma_f32_16x16x32_bf16 v[72:75], v[144:147], v[120:123], v[72:75]
    ds_read_b64_tr_b16 v[104:105], v6 offset:8192
    ds_read_b64_tr_b16 v[106:107], v6 offset:10240
    buffer_load_dwordx4 v[144:147], v1, s[8:11], s26 offen offset:0 sc1
    s_waitcnt vmcnt(17)
    v_mfma_f32_16x16x32_bf16 v[16:19], v[148:151], v[108:111], v[16:19]
    v_mfma_f32_16x16x32_bf16 v[36:39], v[148:151], v[112:115], v[36:39]
    v_mfma_f32_16x16x32_bf16 v[56:59], v[148:151], v[116:119], v[56:59]
    v_mfma_f32_16x16x32_bf16 v[76:79], v[148:151], v[120:123], v[76:79]
    buffer_load_dwordx4 v[148:151], v1, s[8:11], s26 offen offset:256 sc1
    s_waitcnt vmcnt(16)
    v_mfma_f32_16x16x32_bf16 v[20:23], v[152:155], v[108:111], v[20:23]
    v_mfma_f32_16x16x32_bf16 v[40:43], v[152:155], v[112:115], v[40:43]
    v_mfma_f32_16x16x32_bf16 v[60:63], v[152:155], v[116:119], v[60:63]
    v_mfma_f32_16x16x32_bf16 v[80:83], v[152:155], v[120:123], v[80:83]
    buffer_load_dwordx4 v[152:155], v1, s[8:11], s26 offen offset:512 sc1
    s_waitcnt vmcnt(14)
    v_mfma_f32_16x16x32_bf16 v[24:27], v[156:159], v[108:111], v[24:27]
    v_mfma_f32_16x16x32_bf16 v[44:47], v[156:159], v[112:115], v[44:47]
    v_mfma_f32_16x16x32_bf16 v[64:67], v[156:159], v[116:119], v[64:67]
    v_mfma_f32_16x16x32_bf16 v[84:87], v[156:159], v[120:123], v[84:87]
    buffer_load_dwordx4 v[156:159], v1, s[8:11], s26 offen offset:768 sc1
    s_waitcnt vmcnt(13)
    v_mfma_f32_16x16x32_bf16 v[28:31], v[160:163], v[108:111], v[28:31]
    v_mfma_f32_16x16x32_bf16 v[48:51], v[160:163], v[112:115], v[48:51]
    v_mfma_f32_16x16x32_bf16 v[68:71], v[160:163], v[116:119], v[68:71]
    v_mfma_f32_16x16x32_bf16 v[88:91], v[160:163], v[120:123], v[88:91]
    buffer_load_dwordx4 v[160:163], v1, s[8:11], s26 offen offset:1024 sc1
    s_waitcnt vmcnt(13) lgkmcnt(0)
    s_mul_i32 s26, s32, 40960
    s_add_u32 s26, s26, s29
    s_add_u32 s32, s32, 1
    s_cmp_eq_u32 s32, s33
    s_cselect_b32 s32, 0, s32
    v_mfma_f32_16x16x32_bf16 v[12:15], v[124:127], v[92:95], v[12:15]
    ds_read_b64_tr_b16 v[108:109], v3 offset:12288
    ds_read_b64_tr_b16 v[110:111], v3 offset:14336
    v_mfma_f32_16x16x32_bf16 v[32:35], v[124:127], v[96:99], v[32:35]
    ds_read_b64_tr_b16 v[112:113], v4 offset:12288
    ds_read_b64_tr_b16 v[114:115], v4 offset:14336
    v_mfma_f32_16x16x32_bf16 v[52:55], v[124:127], v[100:103], v[52:55]
    ds_read_b64_tr_b16 v[116:117], v5 offset:12288
    ds_read_b64_tr_b16 v[118:119], v5 offset:14336
    v_mfma_f32_16x16x32_bf16 v[72:75], v[124:127], v[104:107], v[72:75]
    ds_read_b64_tr_b16 v[120:121], v6 offset:12288
    ds_read_b64_tr_b16 v[122:123], v6 offset:14336
    buffer_load_dwordx4 v[124:127], v1, s[8:11], s26 offen offset:0 sc1
    s_waitcnt vmcnt(13)
    v_mfma_f32_16x16x32_bf16 v[16:19], v[128:131], v[92:95], v[16:19]
    v_mfma_f32_16x16x32_bf16 v[36:39], v[128:131], v[96:99], v[36:39]
    v_mfma_f32_16x16x32_bf16 v[56:59], v[128:131], v[100:103], v[56:59]
    v_mfma_f32_16x16x32_bf16 v[76:79], v[128:131], v[104:107], v[76:79]
    buffer_load_dwordx4 v[128:131], v1, s[8:11], s26 offen offset:256 sc1
    s_waitcnt vmcnt(12)
    v_mfma_f32_16x16x32_bf16 v[20:23], v[132:135], v[92:95], v[20:23]
    v_mfma_f32_16x16x32_bf16 v[40:43], v[132:135], v[96:99], v[40:43]
    v_mfma_f32_16x16x32_bf16 v[60:63], v[132:135], v[100:103], v[60:63]
    v_mfma_f32_16x16x32_bf16 v[80:83], v[132:135], v[104:107], v[80:83]
    buffer_load_dwordx4 v[132:135], v1, s[8:11], s26 offen offset:512 sc1
    s_waitcnt vmcnt(10)
    v_mfma_f32_16x16x32_bf16 v[24:27], v[136:139], v[92:95], v[24:27]
    v_mfma_f32_16x16x32_bf16 v[44:47], v[136:139], v[96:99], v[44:47]
    v_mfma_f32_16x16x32_bf16 v[64:67], v[136:139], v[100:103], v[64:67]
    v_mfma_f32_16x16x32_bf16 v[84:87], v[136:139], v[104:107], v[84:87]
    buffer_load_dwordx4 v[136:139], v1, s[8:11], s26 offen offset:768 sc1
    s_waitcnt vmcnt(9)
    v_mfma_f32_16x16x32_bf16 v[28:31], v[140:143], v[92:95], v[28:31]
    v_mfma_f32_16x16x32_bf16 v[48:51], v[140:143], v[96:99], v[48:51]
    v_mfma_f32_16x16x32_bf16 v[68:71], v[140:143], v[100:103], v[68:71]
    v_mfma_f32_16x16x32_bf16 v[88:91], v[140:143], v[104:107], v[88:91]
    buffer_load_dwordx4 v[140:143], v1, s[8:11], s26 offen offset:1024 sc1
    s_waitcnt vmcnt(9) lgkmcnt(0)
    s_mul_i32 s26, s32, 40960
    s_add_u32 s26, s26, s29
    s_cmp_lt_u32 s33, 14
    s_cselect_b32 s26, 2130706432, s26
    s_add_u32 s32, s32, 1
    s_cmp_eq_u32 s32, s33
    s_cselect_b32 s32, 0, s32
    v_mfma_f32_16x16x32_bf16 v[12:15], v[144:147], v[108:111], v[12:15]
    ds_read_b64_tr_b16 v[92:93], v3 offset:0
    ds_read_b64_tr_b16 v[94:95], v3 offset:2048
    v_mfma_f32_16x16x32_bf16 v[32:35], v[144:147], v[112:115], v[32:35]
    ds_read_b64_tr_b16 v[96:97], v4 offset:0
    ds_read_b64_tr_b16 v[98:99], v4 offset:2048
    v_mfma_f32_16x16x32_bf16 v[52:55], v[144:147], v[116:119], v[52:55]
    ds_read_b64_tr_b16 v[100:101], v5 offset:0
    ds_read_b64_tr_b16 v[102:103], v5 offset:2048
    v_mfma_f32_16x16x32_bf16 v[72:75], v[144:147], v[120:123], v[72:75]
    ds_read_b64_tr_b16 v[104:105], v6 offset:0
    ds_read_b64_tr_b16 v[106:107], v6 offset:2048
    buffer_load_dwordx4 v[144:147], v1, s[8:11], s26 offen offset:0 sc1
    s_waitcnt vmcnt(9)
    v_mfma_f32_16x16x32_bf16 v[16:19], v[148:151], v[108:111], v[16:19]
    v_mfma_f32_16x16x32_bf16 v[36:39], v[148:151], v[112:115], v[36:39]
    v_mfma_f32_16x16x32_bf16 v[56:59], v[148:151], v[116:119], v[56:59]
    v_mfma_f32_16x16x32_bf16 v[76:79], v[148:151], v[120:123], v[76:79]
    buffer_load_dwordx4 v[148:151], v1, s[8:11], s26 offen offset:256 sc1
    s_waitcnt vmcnt(9)
    v_mfma_f32_16x16x32_bf16 v[20:23], v[152:155], v[108:111], v[20:23]
    v_mfma_f32_16x16x32_bf16 v[40:43], v[152:155], v[112:115], v[40:43]
    v_mfma_f32_16x16x32_bf16 v[60:63], v[152:155], v[116:119], v[60:63]
    v_mfma_f32_16x16x32_bf16 v[80:83], v[152:155], v[120:123], v[80:83]
    buffer_load_dwordx4 v[152:155], v1, s[8:11], s26 offen offset:512 sc1
    s_waitcnt vmcnt(9)
    v_mfma_f32_16x16x32_bf16 v[24:27], v[156:159], v[108:111], v[24:27]
    v_mfma_f32_16x16x32_bf16 v[44:47], v[156:159], v[112:115], v[44:47]
    v_mfma_f32_16x16x32_bf16 v[64:67], v[156:159], v[116:119], v[64:67]
    v_mfma_f32_16x16x32_bf16 v[84:87], v[156:159], v[120:123], v[84:87]
    buffer_load_dwordx4 v[156:159], v1, s[8:11], s26 offen offset:768 sc1
    s_waitcnt vmcnt(9)
    v_mfma_f32_16x16x32_bf16 v[28:31], v[160:163], v[108:111], v[28:31]
    v_mfma_f32_16x16x32_bf16 v[48:51], v[160:163], v[112:115], v[48:51]
    v_mfma_f32_16x16x32_bf16 v[68:71], v[160:163], v[116:119], v[68:71]
    v_mfma_f32_16x16x32_bf16 v[88:91], v[160:163], v[120:123], v[88:91]
    buffer_load_dwordx4 v[160:163], v1, s[8:11], s26 offen offset:1024 sc1
    s_mul_i32 s30, s21, 1280
    s_lshl_b32 s23, s20, 8
    s_add_u32 s30, s30, s23
    s_add_u32 s30, s30, 20709376
    s_lshl_b32 s56, s20, 10
    s_lshl_b32 s23, s22, 2
    s_add_u32 s23, s23, s20
    s_lshl_b32 s29, s23, 8
    s_add_u32 s29, s29, 12713984
    s_lshl_b32 s26, s23, 7
    s_add_u32 s26, s26, 14811136
    s_lshr_b32 s33, s22, 1
    s_lshl_b32 s33, s33, 12
    s_add_u32 s33, s33, 21823488
    v_bfe_u32 v7, v0, 4, 2
    v_and_b32 v8, 15, v0
    v_lshlrev_b32 v10, 15, v7
    v_lshl_add_u32 v11, v8, 3, v10
    v_lshl_add_u32 v10, v8, 4, v10
    v_and_b32 v166, 31, v0
    v_lshlrev_b32 v166, 7, v166
    v_mov_b32 v164, 141776
    ds_read_b32 v165, v164
    v_mov_b32 v167, 0
    s_waitcnt lgkmcnt(0)
    v_readfirstlane_b32 s57, v165
    s_nop 0
    s_cmp_ge_u32 s57, 8
    s_cselect_b32 s57, 8, 1
    s_mov_b64 exec, 1
    v_mov_b32 v164, 141796
    v_mov_b32 v165, s57
    ds_cmpst_rtn_b32 v164, v164, v167, v165
    s_waitcnt lgkmcnt(0)
    v_readfirstlane_b32 s23, v164
    s_mov_b64 exec, -1
    s_cmp_eq_u32 s23, 0
    s_cselect_b32 s57, s57, s23
    s_cmp_eq_u32 s57, 8
    s_cselect_b32 s23, 0, 65536
    s_add_u32 s32, s56, s23
    s_sub_u32 s27, s28, s23
    s_cmp_lt_u32 s57, 8
    s_cbranch_scc1 Lalt40
    s_waitcnt vmcnt(9) lgkmcnt(0)
    v_mfma_f32_16x16x32_bf16 v[12:15], v[124:127], v[92:95], v[12:15]
    ds_read_b64_tr_b16 v[108:109], v3 offset:4096
    ds_read_b64_tr_b16 v[110:111], v3 offset:6144
    s_add_u32 m0, s32, 0
    s_add_u32 s23, s20, 0
    s_mul_i32 s24, s23, 205
    s_lshr_b32 s24, s24, 10
    s_mul_i32 s24, s24, 39680
    s_add_u32 s24, s24, s30
    s_add_u32 s24, s24, 0
    buffer_load_dwordx4 v1, s[8:11], s24 offen sc1 lds
    v_mfma_f32_16x16x32_bf16 v[32:35], v[124:127], v[96:99], v[32:35]
    ds_read_b64_tr_b16 v[112:113], v4 offset:4096
    ds_read_b64_tr_b16 v[114:115], v4 offset:6144
    s_add_u32 m0, s32, 4096
    s_add_u32 s23, s20, 4
    s_mul_i32 s24, s23, 205
    s_lshr_b32 s24, s24, 10
    s_mul_i32 s24, s24, 39680
    s_add_u32 s24, s24, s30
    s_add_u32 s24, s24, 1024
    buffer_load_dwordx4 v1, s[8:11], s24 offen sc1 lds
    v_mfma_f32_16x16x32_bf16 v[52:55], v[124:127], v[100:103], v[52:55]
    ds_read_b64_tr_b16 v[116:117], v5 offset:4096
    ds_read_b64_tr_b16 v[118:119], v5 offset:6144
    s_add_u32 m0, s32, 8192
    s_add_u32 s23, s20, 8
    s_mul_i32 s24, s23, 205
    s_lshr_b32 s24, s24, 10
    s_mul_i32 s24, s24, 39680
    s_add_u32 s24, s24, s30
    s_add_u32 s24, s24, 2048
    buffer_load_dwordx4 v1, s[8:11], s24 offen sc1 lds
    v_mfma_f32_16x16x32_bf16 v[72:75], v[124:127], v[104:107], v[72:75]
    ds_read_b64_tr_b16 v[120:121], v6 offset:4096
    ds_read_b64_tr_b16 v[122:123], v6 offset:6144
    s_add_u32 m0, s32, 12288
    s_add_u32 s23, s20, 12
    s_mul_i32 s24, s23, 205
    s_lshr_b32 s24, s24, 10
    s_mul_i32 s24, s24, 39680
    s_add_u32 s24, s24, s30
    s_add_u32 s24, s24, 3072
    buffer_load_dwordx4 v1, s[8:11], s24 offen sc1 lds
    s_waitcnt vmcnt(12)
    v_mfma_f32_16x16x32_bf16 v[16:19], v[128:131], v[92:95], v[16:19]
    s_add_u32 m0, s32, 16384
    s_add_u32 s23, s20, 16
    s_mul_i32 s24, s23, 205
    s_lshr_b32 s24, s24, 10
    s_mul_i32 s24, s24, 39680
    s_add_u32 s24, s24, s30
    s_add_u32 s24, s24, 4096
    buffer_load_dwordx4 v1, s[8:11], s24 offen sc1 lds
    v_mfma_f32_16x16x32_bf16 v[36:39], v[128:131], v[96:99], v[36:39]
    s_add_u32 m0, s32, 20480
    s_add_u32 s23, s20, 20
    s_mul_i32 s24, s23, 205
    s_lshr_b32 s24, s24, 10
    s_mul_i32 s24, s24, 39680
    s_add_u32 s24, s24, s30
    s_add_u32 s24, s24, 5120
    buffer_load_dwordx4 v1, s[8:11], s24 offen sc1 lds
    v_mfma_f32_16x16x32_bf16 v[56:59], v[128:131], v[100:103], v[56:59]
    s_add_u32 m0, s32, 24576
    s_add_u32 s23, s20, 24
    s_mul_i32 s24, s23, 205
    s_lshr_b32 s24, s24, 10
    s_mul_i32 s24, s24, 39680
    s_add_u32 s24, s24, s30
    s_add_u32 s24, s24, 6144
    buffer_load_dwordx4 v1, s[8:11], s24 offen sc1 lds
    v_mfma_f32_16x16x32_bf16 v[76:79], v[128:131], v[104:107], v[76:79]
    s_add_u32 m0, s32, 28672
    s_add_u32 s23, s20, 28
    s_mul_i32 s24, s23, 205
    s_lshr_b32 s24, s24, 10
    s_mul_i32 s24, s24, 39680
    s_add_u32 s24, s24, s30
    s_add_u32 s24, s24, 7168
    buffer_load_dwordx4 v1, s[8:11], s24 offen sc1 lds
    s_waitcnt vmcnt(15)
    v_mfma_f32_16x16x32_bf16 v[20:23], v[132:135], v[92:95], v[20:23]
    s_add_u32 m0, s32, 32768
    s_add_u32 s23, s20, 32
    s_mul_i32 s24, s23, 205
    s_lshr_b32 s24, s24, 10
    s_mul_i32 s24, s24, 39680
    s_add_u32 s24, s24, s30
    s_add_u32 s24, s24, 8192
    buffer_load_dwordx4 v1, s[8:11], s24 offen sc1 lds
    v_mfma_f32_16x16x32_bf16 v[40:43], v[132:135], v[96:99], v[40:43]
    s_add_u32 m0, s32, 36864
    s_add_u32 s23, s20, 36
    s_mul_i32 s24, s23, 205
    s_lshr_b32 s24, s24, 10
    s_mul_i32 s24, s24, 39680
    s_add_u32 s24, s24, s30
    s_add_u32 s24, s24, 9216
    buffer_load_dwordx4 v1, s[8:11], s24 offen sc1 lds
    v_mfma_f32_16x16x32_bf16 v[60:63], v[132:135], v[100:103], v[60:63]
    s_add_u32 m0, s32, 40960
    s_add_u32 s23, s20, 40
    s_mul_i32 s24, s23, 205
    s_lshr_b32 s24, s24, 10
    s_mul_i32 s24, s24, 39680
    s_add_u32 s24, s24, s30
    s_add_u32 s24, s24, 10240
    buffer_load_dwordx4 v1, s[8:11], s24 offen sc1 lds
    v_mfma_f32_16x16x32_bf16 v[80:83], v[132:135], v[104:107], v[80:83]
    s_add_u32 m0, s32, 45056
    s_add_u32 s23, s20, 44
    s_mul_i32 s24, s23, 205
    s_lshr_b32 s24, s24, 10
    s_mul_i32 s24, s24, 39680
    s_add_u32 s24, s24, s30
    s_add_u32 s24, s24, 11264
    buffer_load_dwordx4 v1, s[8:11], s24 offen sc1 lds
    s_waitcnt vmcnt(18)
    v_mfma_f32_16x16x32_bf16 v[24:27], v[136:139], v[92:95], v[24:27]
    s_add_u32 m0, s32, 49152
    s_add_u32 s23, s20, 48
    s_mul_i32 s24, s23, 205
    s_lshr_b32 s24, s24, 10
    s_mul_i32 s24, s24, 39680
    s_add_u32 s24, s24, s30
    s_add_u32 s24, s24, 12288
    buffer_load_dwordx4 v1, s[8:11], s24 offen sc1 lds
    v_mfma_f32_16x16x32_bf16 v[44:47], v[136:139], v[96:99], v[44:47]
    s_add_u32 m0, s32, 53248
    s_add_u32 s23, s20, 52
    s_mul_i32 s24, s23, 205
    s_lshr_b32 s24, s24, 10
    s_mul_i32 s24, s24, 39680
    s_add_u32 s24, s24, s30
    s_add_u32 s24, s24, 13312
    buffer_load_dwordx4 v1, s[8:11], s24 offen sc1 lds
    v_mfma_f32_16x16x32_bf16 v[64:67], v[136:139], v[100:103], v[64:67]
    s_add_u32 m0, s32, 57344
    s_add_u32 s23, s20, 56
    s_mul_i32 s24, s23, 205
    s_lshr_b32 s24, s24, 10
    s_mul_i32 s24, s24, 39680
    s_add_u32 s24, s24, s30
    s_add_u32 s24, s24, 14336
    buffer_load_dwordx4 v1, s[8:11], s24 offen sc1 lds
    v_mfma_f32_16x16x32_bf16 v[84:87], v[136:139], v[104:107], v[84:87]
    s_add_u32 m0, s32, 61440
    s_add_u32 s23, s20, 60
    s_mul_i32 s24, s23, 205
    s_lshr_b32 s24, s24, 10
    s_mul_i32 s24, s24, 39680
    s_add_u32 s24, s24, s30
    s_add_u32 s24, s24, 15360
    buffer_load_dwordx4 v1, s[8:11], s24 offen sc1 lds
    s_waitcnt vmcnt(21)
    v_mfma_f32_16x16x32_bf16 v[28:31], v[140:143], v[92:95], v[28:31]
    s_add_u32 m0, s56, 131072
    s_add_u32 s23, s20, 64
    s_mul_i32 s24, s23, 205
    s_lshr_b32 s24, s24, 10
    s_mul_i32 s24, s24, 39680
    s_add_u32 s24, s24, s30
    s_add_u32 s24, s24, 16384
    buffer_load_dwordx4 v1, s[8:11], s24 offen sc1 lds
    v_mfma_f32_16x16x32_bf16 v[48:51], v[140:143], v[96:99], v[48:51]
    s_add_u32 m0, s56, 135168
    s_add_u32 s23, s20, 68
    s_mul_i32 s24, s23, 205
    s_lshr_b32 s24, s24, 10
    s_mul_i32 s24, s24, 39680
    s_add_u32 s24, s24, s30
    s_add_u32 s24, s24, 17408
    buffer_load_dwordx4 v1, s[8:11], s24 offen sc1 lds
    v_mfma_f32_16x16x32_bf16 v[68:71], v[140:143], v[100:103], v[68:71]
    s_add_u32 m0, s56, 143360
    s_add_u32 s23, s20, 72
    s_mul_i32 s24, s23, 205
    s_lshr_b32 s24, s24, 10
    s_mul_i32 s24, s24, 39680
    s_add_u32 s24, s24, s30
    s_add_u32 s24, s24, 18432
    buffer_load_dwordx4 v1, s[8:11], s24 offen sc1 lds
    v_mfma_f32_16x16x32_bf16 v[88:91], v[140:143], v[104:107], v[88:91]
    s_add_u32 m0, s56, 147456
    s_add_u32 s23, s20, 76
    s_mul_i32 s24, s23, 205
    s_lshr_b32 s24, s24, 10
    s_mul_i32 s24, s24, 39680
    s_add_u32 s24, s24, s30
    s_add_u32 s24, s24, 19456
    buffer_load_dwordx4 v1, s[8:11], s24 offen sc1 lds
    s_waitcnt vmcnt(24) lgkmcnt(0)
    v_mfma_f32_16x16x32_bf16 v[12:15], v[144:147], v[108:111], v[12:15]
    s_add_u32 m0, s56, 151552
    s_add_u32 s23, s20, 80
    s_mul_i32 s24, s23, 205
    s_lshr_b32 s24, s24, 10
    s_mul_i32 s24, s24, 39680
    s_add_u32 s24, s24, s30
    s_add_u32 s24, s24, 20480
    buffer_load_dwordx4 v1, s[8:11], s24 offen sc1 lds
    v_mfma_f32_16x16x32_bf16 v[32:35], v[144:147], v[112:115], v[32:35]
    s_add_u32 m0, s56, 155648
    s_add_u32 s23, s20, 84
    s_mul_i32 s24, s23, 205
    s_lshr_b32 s24, s24, 10
    s_mul_i32 s24, s24, 39680
    s_add_u32 s24, s24, s30
    s_add_u32 s24, s24, 21504
    buffer_load_dwordx4 v1, s[8:11], s24 offen sc1 lds
    v_mfma_f32_16x16x32_bf16 v[52:55], v[144:147], v[116:119], v[52:55]
    s_add_u32 m0, s56, 159744
    s_add_u32 s23, s20, 88
    s_mul_i32 s24, s23, 205
    s_lshr_b32 s24, s24, 10
    s_mul_i32 s24, s24, 39680
    s_add_u32 s24, s24, s30
    s_add_u32 s24, s24, 22528
    buffer_load_dwordx4 v1, s[8:11], s24 offen sc1 lds
    v_mfma_f32_16x16x32_bf16 v[72:75], v[144:147], v[120:123], v[72:75]
    s_add_u32 m0, s27, 12288
    s_add_u32 s23, s20, 92
    s_mul_i32 s24, s23, 205
    s_lshr_b32 s24, s24, 10
    s_mul_i32 s24, s24, 39680
    s_add_u32 s24, s24, s30
    s_add_u32 s24, s24, 23552
    buffer_load_dwordx4 v1, s[8:11], s24 offen sc1 lds
    s_waitcnt vmcnt(27)
    v_mfma_f32_16x16x32_bf16 v[16:19], v[148:151], v[108:111], v[16:19]
    buffer_load_dword v167, v166, s[8:11], s33 offen sc1
    v_mfma_f32_16x16x32_bf16 v[36:39], v[148:151], v[112:115], v[36:39]
    s_add_u32 m0, s27, 13312
    s_add_u32 s23, s20, 96
    s_mul_i32 s24, s23, 205
    s_lshr_b32 s24, s24, 10
    s_mul_i32 s24, s24, 39680
    s_add_u32 s24, s24, s30
    s_add_u32 s24, s24, 24576
    buffer_load_dwordx4 v1, s[8:11], s24 offen sc1 lds
    v_mfma_f32_16x16x32_bf16 v[56:59], v[148:151], v[116:119], v[56:59]
    v_mfma_f32_16x16x32_bf16 v[76:79], v[148:151], v[120:123], v[76:79]
    s_waitcnt vmcnt(28)
    v_mfma_f32_16x16x32_bf16 v[20:23], v[152:155], v[108:111], v[20:23]
    v_mfma_f32_16x16x32_bf16 v[40:43], v[152:155], v[112:115], v[40:43]
    v_mfma_f32_16x16x32_bf16 v[60:63], v[152:155], v[116:119], v[60:63]
    v_mfma_f32_16x16x32_bf16 v[80:83], v[152:155], v[120:123], v[80:83]
    s_waitcnt vmcnt(27)
    v_mfma_f32_16x16x32_bf16 v[24:27], v[156:159], v[108:111], v[24:27]
    v_mfma_f32_16x16x32_bf16 v[44:47], v[156:159], v[112:115], v[44:47]
    v_mfma_f32_16x16x32_bf16 v[64:67], v[156:159], v[116:119], v[64:67]
    v_mfma_f32_16x16x32_bf16 v[84:87], v[156:159], v[120:123], v[84:87]
    s_waitcnt vmcnt(26)
    v_mfma_f32_16x16x32_bf16 v[28:31], v[160:163], v[108:111], v[28:31]
    v_mfma_f32_16x16x32_bf16 v[48:51], v[160:163], v[112:115], v[48:51]
    v_mfma_f32_16x16x32_bf16 v[68:71], v[160:163], v[116:119], v[68:71]
    v_mfma_f32_16x16x32_bf16 v[88:91], v[160:163], v[120:123], v[88:91]
    s_branch Lalt40j
Lalt40:
    s_waitcnt vmcnt(9) lgkmcnt(0)
    v_mfma_f32_16x16x32_bf16 v[12:15], v[124:127], v[92:95], v[12:15]
    ds_read_b64_tr_b16 v[108:109], v3 offset:4096
    ds_read_b64_tr_b16 v[110:111], v3 offset:6144
    v_mfma_f32_16x16x32_bf16 v[32:35], v[124:127], v[96:99], v[32:35]
    ds_read_b64_tr_b16 v[112:113], v4 offset:4096
    ds_read_b64_tr_b16 v[114:115], v4 offset:6144
    v_mfma_f32_16x16x32_bf16 v[52:55], v[124:127], v[100:103], v[52:55]
    ds_read_b64_tr_b16 v[116:117], v5 offset:4096
    ds_read_b64_tr_b16 v[118:119], v5 offset:6144
    v_mfma_f32_16x16x32_bf16 v[72:75], v[124:127], v[104:107], v[72:75]
    ds_read_b64_tr_b16 v[120:121], v6 offset:4096
    ds_read_b64_tr_b16 v[122:123], v6 offset:6144
    s_waitcnt vmcnt(8)
    v_mfma_f32_16x16x32_bf16 v[16:19], v[128:131], v[92:95], v[16:19]
    v_mfma_f32_16x16x32_bf16 v[36:39], v[128:131], v[96:99], v[36:39]
    v_mfma_f32_16x16x32_bf16 v[56:59], v[128:131], v[100:103], v[56:59]
    v_mfma_f32_16x16x32_bf16 v[76:79], v[128:131], v[104:107], v[76:79]
    s_waitcnt vmcnt(7)
    v_mfma_f32_16x16x32_bf16 v[20:23], v[132:135], v[92:95], v[20:23]
    v_mfma_f32_16x16x32_bf16 v[40:43], v[132:135], v[96:99], v[40:43]
    v_mfma_f32_16x16x32_bf16 v[60:63], v[132:135], v[100:103], v[60:63]
    v_mfma_f32_16x16x32_bf16 v[80:83], v[132:135], v[104:107], v[80:83]
    s_waitcnt vmcnt(6)
    v_mfma_f32_16x16x32_bf16 v[24:27], v[136:139], v[92:95], v[24:27]
    v_mfma_f32_16x16x32_bf16 v[44:47], v[136:139], v[96:99], v[44:47]
    v_mfma_f32_16x16x32_bf16 v[64:67], v[136:139], v[100:103], v[64:67]
    v_mfma_f32_16x16x32_bf16 v[84:87], v[136:139], v[104:107], v[84:87]
    s_waitcnt vmcnt(5)
    v_mfma_f32_16x16x32_bf16 v[28:31], v[140:143], v[92:95], v[28:31]
    v_mfma_f32_16x16x32_bf16 v[48:51], v[140:143], v[96:99], v[48:51]
    v_mfma_f32_16x16x32_bf16 v[68:71], v[140:143], v[100:103], v[68:71]
    v_mfma_f32_16x16x32_bf16 v[88:91], v[140:143], v[104:107], v[88:91]
    s_waitcnt vmcnt(4) lgkmcnt(0)
    v_mfma_f32_16x16x32_bf16 v[12:15], v[144:147], v[108:111], v[12:15]
    v_mfma_f32_16x16x32_bf16 v[32:35], v[144:147], v[112:115], v[32:35]
    v_mfma_f32_16x16x32_bf16 v[52:55], v[144:147], v[116:119], v[52:55]
    v_mfma_f32_16x16x32_bf16 v[72:75], v[144:147], v[120:123], v[72:75]
    s_waitcnt vmcnt(3)
    v_mfma_f32_16x16x32_bf16 v[16:19], v[148:151], v[108:111], v[16:19]
    v_mfma_f32_16x16x32_bf16 v[36:39], v[148:151], v[112:115], v[36:39]
    v_mfma_f32_16x16x32_bf16 v[56:59], v[148:151], v[116:119], v[56:59]
    v_mfma_f32_16x16x32_bf16 v[76:79], v[148:151], v[120:123], v[76:79]
    s_waitcnt vmcnt(2)
    v_mfma_f32_16x16x32_bf16 v[20:23], v[152:155], v[108:111], v[20:23]
    v_mfma_f32_16x16x32_bf16 v[40:43], v[152:155], v[112:115], v[40:43]
    v_mfma_f32_16x16x32_bf16 v[60:63], v[152:155], v[116:119], v[60:63]
    v_mfma_f32_16x16x32_bf16 v[80:83], v[152:155], v[120:123], v[80:83]
    s_waitcnt vmcnt(1)
    v_mfma_f32_16x16x32_bf16 v[24:27], v[156:159], v[108:111], v[24:27]
    v_mfma_f32_16x16x32_bf16 v[44:47], v[156:159], v[112:115], v[44:47]
    v_mfma_f32_16x16x32_bf16 v[64:67], v[156:159], v[116:119], v[64:67]
    v_mfma_f32_16x16x32_bf16 v[84:87], v[156:159], v[120:123], v[84:87]
    s_waitcnt vmcnt(0)
    v_mfma_f32_16x16x32_bf16 v[28:31], v[160:163], v[108:111], v[28:31]
    v_mfma_f32_16x16x32_bf16 v[48:51], v[160:163], v[112:115], v[48:51]
    v_mfma_f32_16x16x32_bf16 v[68:71], v[160:163], v[116:119], v[68:71]
    v_mfma_f32_16x16x32_bf16 v[88:91], v[160:163], v[120:123], v[88:91]
Lalt40j:
    s_setprio 3
    v_and_b32 v7, 63, v0
    v_lshlrev_b32 v7, 4, v7
    v_add_u32 v3, s28, v7
    s_xor_b32 s23, s20, 1
    s_mul_i32 s23, s23, 16384
    s_add_u32 s23, s23, 65536
    v_add_u32 v4, s23, v7
    s_xor_b32 s23, s20, 3
    s_mul_i32 s23, s23, 16384
    s_add_u32 s23, s23, 65536
    v_add_u32 v5, s23, v7
    ds_write_b128 v3, v[32:35] offset:0
    ds_write_b128 v3, v[36:39] offset:1024
    ds_write_b128 v3, v[40:43] offset:2048
    ds_write_b128 v3, v[44:47] offset:3072
    ds_write_b128 v3, v[48:51] offset:4096
    ds_write_b128 v3, v[72:75] offset:5120
    ds_write_b128 v3, v[76:79] offset:6144
    ds_write_b128 v3, v[80:83] offset:7168
    ds_write_b128 v3, v[84:87] offset:8192
    ds_write_b128 v3, v[88:91] offset:9216
    s_lshl_b32 s59, s20, 2
    s_add_u32 s59, s59, 140448
    s_mov_b64 exec, 1
    v_mov_b32 v164, s59
    v_mov_b32 v165, 1
    ds_add_u32 v164, v165
    s_mov_b64 exec, -1
    s_add_u32 s41, s41, 1
    s_waitcnt vmcnt(1)
    v_cmp_ne_u32 vcc, 1, v167
    s_mov_b32 s31, 0
    s_nop 3
    s_cbranch_vccnz parallel_sum__mha_block__mixer_token_mlp__prompt_kernel_m_no1
    s_mov_b32 s31, 1
    buffer_load_dwordx4 v[92:95], v10, s[8:11], s29 offen sc1
    s_add_u32 s29, s29, 131072
    buffer_load_dwordx4 v[96:99], v10, s[8:11], s29 offen sc1
    s_add_u32 s29, s29, 131072
    buffer_load_dwordx4 v[100:103], v10, s[8:11], s29 offen sc1
    s_add_u32 s29, s29, 131072
    buffer_load_dwordx4 v[104:107], v10, s[8:11], s29 offen sc1
    s_add_u32 s29, s29, 131072
    buffer_load_dwordx2 v[108:109], v11, s[8:11], s26 offen sc1
    s_add_u32 s26, s26, 16384
    buffer_load_dwordx2 v[110:111], v11, s[8:11], s26 offen sc1
    s_add_u32 s26, s26, 114688
    buffer_load_dwordx4 v[112:115], v10, s[8:11], s29 offen sc1
    s_add_u32 s29, s29, 131072
    buffer_load_dwordx4 v[116:119], v10, s[8:11], s29 offen sc1
    s_add_u32 s29, s29, 131072
    buffer_load_dwordx4 v[120:123], v10, s[8:11], s29 offen sc1
    s_add_u32 s29, s29, 131072
    buffer_load_dwordx4 v[124:127], v10, s[8:11], s29 offen sc1
    s_add_u32 s29, s29, 131072
parallel_sum__mha_block__mixer_token_mlp__prompt_kernel_m_no1:
    s_xor_b32 s59, s20, 1
    s_lshl_b32 s59, s59, 2
    s_add_u32 s59, s59, 140448
    s_mov_b64 exec, 1
    v_mov_b32 v164, s59
    s_mov_b32 s61, 1048576
Lw41:
    ds_read_b32 v165, v164
    s_waitcnt lgkmcnt(0)
    v_readfirstlane_b32 s59, v165
    s_nop 0
    s_cmp_ge_u32 s59, s41
    s_cbranch_scc1 Lw41x
    s_sleep 1
    s_sub_u32 s61, s61, 1
    s_cmp_lg_u32 s61, 0
    s_cbranch_scc1 Lw41
Lw41x:
    s_mov_b64 exec, -1
    ds_read_b128 v[72:75], v4 offset:5120
    ds_read_b128 v[76:79], v4 offset:6144
    ds_read_b128 v[80:83], v4 offset:7168
    ds_read_b128 v[84:87], v4 offset:8192
    ds_read_b128 v[88:91], v4 offset:9216
    ds_read_b128 v[32:35], v4 offset:0
    ds_read_b128 v[36:39], v4 offset:1024
    ds_read_b128 v[40:43], v4 offset:2048
    ds_read_b128 v[44:47], v4 offset:3072
    ds_read_b128 v[48:51], v4 offset:4096
    s_waitcnt lgkmcnt(5)
    v_add_f32 v52, v52, v72
    v_add_f32 v53, v53, v73
    v_add_f32 v54, v54, v74
    v_add_f32 v55, v55, v75
    v_add_f32 v56, v56, v76
    v_add_f32 v57, v57, v77
    v_add_f32 v58, v58, v78
    v_add_f32 v59, v59, v79
    v_add_f32 v60, v60, v80
    v_add_f32 v61, v61, v81
    v_add_f32 v62, v62, v82
    v_add_f32 v63, v63, v83
    v_add_f32 v64, v64, v84
    v_add_f32 v65, v65, v85
    v_add_f32 v66, v66, v86
    v_add_f32 v67, v67, v87
    v_add_f32 v68, v68, v88
    v_add_f32 v69, v69, v89
    v_add_f32 v70, v70, v90
    v_add_f32 v71, v71, v91
    s_waitcnt lgkmcnt(0)
    ds_write_b128 v4, v[52:55] offset:0
    ds_write_b128 v4, v[56:59] offset:1024
    ds_write_b128 v4, v[60:63] offset:2048
    ds_write_b128 v4, v[64:67] offset:3072
    ds_write_b128 v4, v[68:71] offset:4096
    s_lshl_b32 s59, s20, 2
    s_add_u32 s59, s59, 140448
    s_mov_b64 exec, 1
    v_mov_b32 v164, s59
    v_mov_b32 v165, 1
    ds_add_u32 v164, v165
    s_mov_b64 exec, -1
    s_add_u32 s41, s41, 1
    v_add_f32 v12, v12, v32
    v_add_f32 v13, v13, v33
    v_add_f32 v14, v14, v34
    v_add_f32 v15, v15, v35
    v_add_f32 v16, v16, v36
    v_add_f32 v17, v17, v37
    v_add_f32 v18, v18, v38
    v_add_f32 v19, v19, v39
    v_add_f32 v20, v20, v40
    v_add_f32 v21, v21, v41
    v_add_f32 v22, v22, v42
    v_add_f32 v23, v23, v43
    v_add_f32 v24, v24, v44
    v_add_f32 v25, v25, v45
    v_add_f32 v26, v26, v46
    v_add_f32 v27, v27, v47
    v_add_f32 v28, v28, v48
    v_add_f32 v29, v29, v49
    v_add_f32 v30, v30, v50
    v_add_f32 v31, v31, v51
    s_cmp_eq_u32 s31, 0
    s_cbranch_scc1 parallel_sum__mha_block__mixer_token_mlp__prompt_kernel_m_no2
    buffer_load_dwordx2 v[128:129], v11, s[8:11], s26 offen sc1
    s_add_u32 s26, s26, 16384
    buffer_load_dwordx2 v[130:131], v11, s[8:11], s26 offen sc1
    s_add_u32 s26, s26, 114688
    buffer_load_dwordx4 v[132:135], v10, s[8:11], s29 offen sc1
    s_add_u32 s29, s29, 131072
    buffer_load_dwordx4 v[136:139], v10, s[8:11], s29 offen sc1
    s_add_u32 s29, s29, 131072
    buffer_load_dwordx4 v[140:143], v10, s[8:11], s29 offen sc1
    s_add_u32 s29, s29, 131072
    buffer_load_dwordx4 v[144:147], v10, s[8:11], s29 offen sc1
    s_add_u32 s29, s29, 131072
    buffer_load_dwordx2 v[148:149], v11, s[8:11], s26 offen sc1
    s_add_u32 s26, s26, 16384
    buffer_load_dwordx2 v[150:151], v11, s[8:11], s26 offen sc1
    s_add_u32 s26, s26, 114688
    buffer_load_dwordx4 v[152:155], v10, s[8:11], s29 offen sc1
    s_add_u32 s29, s29, 131072
    buffer_load_dwordx4 v[156:159], v10, s[8:11], s29 offen sc1
    s_add_u32 s29, s29, 131072
    buffer_load_dwordx4 v[160:163], v10, s[8:11], s29 offen sc1
    s_add_u32 s29, s29, 131072
parallel_sum__mha_block__mixer_token_mlp__prompt_kernel_m_no2:
    s_xor_b32 s59, s20, 2
    s_lshl_b32 s59, s59, 2
    s_add_u32 s59, s59, 140448
    s_mov_b64 exec, 1
    v_mov_b32 v164, s59
    s_mov_b32 s61, 1048576
Lw42:
    ds_read_b32 v165, v164
    s_waitcnt lgkmcnt(0)
    v_readfirstlane_b32 s59, v165
    s_nop 0
    s_cmp_ge_u32 s59, s41
    s_cbranch_scc1 Lw42x
    s_sleep 1
    s_sub_u32 s61, s61, 1
    s_cmp_lg_u32 s61, 0
    s_cbranch_scc1 Lw42
Lw42x:
    s_mov_b64 exec, -1
    ds_read_b128 v[32:35], v5 offset:0
    ds_read_b128 v[36:39], v5 offset:1024
    ds_read_b128 v[40:43], v5 offset:2048
    ds_read_b128 v[44:47], v5 offset:3072
    ds_read_b128 v[48:51], v5 offset:4096
    s_waitcnt lgkmcnt(0)
    v_add_f32 v12, v12, v32
    v_add_f32 v13, v13, v33
    v_add_f32 v14, v14, v34
    v_add_f32 v15, v15, v35
    v_add_f32 v16, v16, v36
    v_add_f32 v17, v17, v37
    v_add_f32 v18, v18, v38
    v_add_f32 v19, v19, v39
    v_add_f32 v20, v20, v40
    v_add_f32 v21, v21, v41
    v_add_f32 v22, v22, v42
    v_add_f32 v23, v23, v43
    v_add_f32 v24, v24, v44
    v_add_f32 v25, v25, v45
    v_add_f32 v26, v26, v46
    v_add_f32 v27, v27, v47
    v_add_f32 v28, v28, v48
    v_add_f32 v29, v29, v49
    v_add_f32 v30, v30, v50
    v_add_f32 v31, v31, v51
    s_sub_u32 s23, s32, s56
    v_add_u32 v3, s23, v7
    v_add_u32 v4, 131072, v7
    v_xor_b32 v5, 65536, v3
    s_mov_b32 s52, s50
    s_and_b32 s53, s51, 0xffff
    s_mov_b32 s54, 2621440
    s_mov_b32 s55, 0x00020000
    s_cmp_ge_u32 s57, 8
    s_cbranch_scc1 parallel_sum__mha_block__mixer_token_mlp__prompt_kernel_m_de
    s_mov_b64 exec, 1
    v_mov_b32 v164, 141764
    v_mov_b32 v165, 1
    ds_add_u32 v164, v165
    s_mov_b64 exec, -1
    s_add_u32 s60, s60, 4
    s_mov_b64 exec, 1
    v_mov_b32 v164, 141764
    s_mov_b32 s61, 1048576
Lw43:
    ds_read_b32 v165, v164
    s_waitcnt lgkmcnt(0)
    v_readfirstlane_b32 s59, v165
    s_nop 0
    s_cmp_ge_u32 s59, s60
    s_cbranch_scc1 Lw43x
    s_sleep 1
    s_sub_u32 s61, s61, 1
    s_cmp_lg_u32 s61, 0
    s_cbranch_scc1 Lw43
Lw43x:
    s_mov_b64 exec, -1
    s_add_u32 m0, s32, 0
    s_add_u32 s23, s20, 0
    s_mul_i32 s24, s23, 205
    s_lshr_b32 s24, s24, 10
    s_mul_i32 s24, s24, 39680
    s_add_u32 s24, s24, s30
    s_add_u32 s24, s24, 0
    buffer_load_dwordx4 v1, s[8:11], s24 offen sc1 lds
    s_add_u32 m0, s32, 4096
    s_add_u32 s23, s20, 4
    s_mul_i32 s24, s23, 205
    s_lshr_b32 s24, s24, 10
    s_mul_i32 s24, s24, 39680
    s_add_u32 s24, s24, s30
    s_add_u32 s24, s24, 1024
    buffer_load_dwordx4 v1, s[8:11], s24 offen sc1 lds
    s_add_u32 m0, s32, 8192
    s_add_u32 s23, s20, 8
    s_mul_i32 s24, s23, 205
    s_lshr_b32 s24, s24, 10
    s_mul_i32 s24, s24, 39680
    s_add_u32 s24, s24, s30
    s_add_u32 s24, s24, 2048
    buffer_load_dwordx4 v1, s[8:11], s24 offen sc1 lds
    s_add_u32 m0, s32, 12288
    s_add_u32 s23, s20, 12
    s_mul_i32 s24, s23, 205
    s_lshr_b32 s24, s24, 10
    s_mul_i32 s24, s24, 39680
    s_add_u32 s24, s24, s30
    s_add_u32 s24, s24, 3072
    buffer_load_dwordx4 v1, s[8:11], s24 offen sc1 lds
    s_add_u32 m0, s32, 16384
    s_add_u32 s23, s20, 16
    s_mul_i32 s24, s23, 205
    s_lshr_b32 s24, s24, 10
    s_mul_i32 s24, s24, 39680
    s_add_u32 s24, s24, s30
    s_add_u32 s24, s24, 4096
    buffer_load_dwordx4 v1, s[8:11], s24 offen sc1 lds
    s_add_u32 m0, s32, 20480
    s_add_u32 s23, s20, 20
    s_mul_i32 s24, s23, 205
    s_lshr_b32 s24, s24, 10
    s_mul_i32 s24, s24, 39680
    s_add_u32 s24, s24, s30
    s_add_u32 s24, s24, 5120
    buffer_load_dwordx4 v1, s[8:11], s24 offen sc1 lds
    s_add_u32 m0, s32, 24576
    s_add_u32 s23, s20, 24
    s_mul_i32 s24, s23, 205
    s_lshr_b32 s24, s24, 10
    s_mul_i32 s24, s24, 39680
    s_add_u32 s24, s24, s30
    s_add_u32 s24, s24, 6144
    buffer_load_dwordx4 v1, s[8:11], s24 offen sc1 lds
    s_add_u32 m0, s32, 28672
    s_add_u32 s23, s20, 28
    s_mul_i32 s24, s23, 205
    s_lshr_b32 s24, s24, 10
    s_mul_i32 s24, s24, 39680
    s_add_u32 s24, s24, s30
    s_add_u32 s24, s24, 7168
    buffer_load_dwordx4 v1, s[8:11], s24 offen sc1 lds
    s_add_u32 m0, s32, 32768
    s_add_u32 s23, s20, 32
    s_mul_i32 s24, s23, 205
    s_lshr_b32 s24, s24, 10
    s_mul_i32 s24, s24, 39680
    s_add_u32 s24, s24, s30
    s_add_u32 s24, s24, 8192
    buffer_load_dwordx4 v1, s[8:11], s24 offen sc1 lds
    s_add_u32 m0, s32, 36864
    s_add_u32 s23, s20, 36
    s_mul_i32 s24, s23, 205
    s_lshr_b32 s24, s24, 10
    s_mul_i32 s24, s24, 39680
    s_add_u32 s24, s24, s30
    s_add_u32 s24, s24, 9216
    buffer_load_dwordx4 v1, s[8:11], s24 offen sc1 lds
    s_add_u32 m0, s32, 40960
    s_add_u32 s23, s20, 40
    s_mul_i32 s24, s23, 205
    s_lshr_b32 s24, s24, 10
    s_mul_i32 s24, s24, 39680
    s_add_u32 s24, s24, s30
    s_add_u32 s24, s24, 10240
    buffer_load_dwordx4 v1, s[8:11], s24 offen sc1 lds
    s_add_u32 m0, s32, 45056
    s_add_u32 s23, s20, 44
    s_mul_i32 s24, s23, 205
    s_lshr_b32 s24, s24, 10
    s_mul_i32 s24, s24, 39680
    s_add_u32 s24, s24, s30
    s_add_u32 s24, s24, 11264
    buffer_load_dwordx4 v1, s[8:11], s24 offen sc1 lds
    s_add_u32 m0, s32, 49152
    s_add_u32 s23, s20, 48
    s_mul_i32 s24, s23, 205
    s_lshr_b32 s24, s24, 10
    s_mul_i32 s24, s24, 39680
    s_add_u32 s24, s24, s30
    s_add_u32 s24, s24, 12288
    buffer_load_dwordx4 v1, s[8:11], s24 offen sc1 lds
    s_add_u32 m0, s32, 53248
    s_add_u32 s23, s20, 52
    s_mul_i32 s24, s23, 205
    s_lshr_b32 s24, s24, 10
    s_mul_i32 s24, s24, 39680
    s_add_u32 s24, s24, s30
    s_add_u32 s24, s24, 13312
    buffer_load_dwordx4 v1, s[8:11], s24 offen sc1 lds
    s_add_u32 m0, s32, 57344
    s_add_u32 s23, s20, 56
    s_mul_i32 s24, s23, 205
    s_lshr_b32 s24, s24, 10
    s_mul_i32 s24, s24, 39680
    s_add_u32 s24, s24, s30
    s_add_u32 s24, s24, 14336
    buffer_load_dwordx4 v1, s[8:11], s24 offen sc1 lds
    s_add_u32 m0, s32, 61440
    s_add_u32 s23, s20, 60
    s_mul_i32 s24, s23, 205
    s_lshr_b32 s24, s24, 10
    s_mul_i32 s24, s24, 39680
    s_add_u32 s24, s24, s30
    s_add_u32 s24, s24, 15360
    buffer_load_dwordx4 v1, s[8:11], s24 offen sc1 lds
    s_add_u32 m0, s56, 131072
    s_add_u32 s23, s20, 64
    s_mul_i32 s24, s23, 205
    s_lshr_b32 s24, s24, 10
    s_mul_i32 s24, s24, 39680
    s_add_u32 s24, s24, s30
    s_add_u32 s24, s24, 16384
    buffer_load_dwordx4 v1, s[8:11], s24 offen sc1 lds
    s_add_u32 m0, s56, 135168
    s_add_u32 s23, s20, 68
    s_mul_i32 s24, s23, 205
    s_lshr_b32 s24, s24, 10
    s_mul_i32 s24, s24, 39680
    s_add_u32 s24, s24, s30
    s_add_u32 s24, s24, 17408
    buffer_load_dwordx4 v1, s[8:11], s24 offen sc1 lds
    s_mov_b64 exec, 1
    v_mov_b32 v164, 141776
    s_mov_b32 s61, 1048576
Lw44:
    ds_read_b32 v165, v164
    s_waitcnt lgkmcnt(0)
    v_readfirstlane_b32 s59, v165
    s_nop 0
    s_cmp_ge_u32 s59, 8
    s_cbranch_scc1 Lw44x
    s_sleep 2
    s_sub_u32 s61, s61, 1
    s_cmp_lg_u32 s61, 0
    s_cbranch_scc1 Lw44
Lw44x:
    s_mov_b64 exec, -1
    s_add_u32 m0, s56, 143360
    s_add_u32 s23, s20, 72
    s_mul_i32 s24, s23, 205
    s_lshr_b32 s24, s24, 10
    s_mul_i32 s24, s24, 39680
    s_add_u32 s24, s24, s30
    s_add_u32 s24, s24, 18432
    buffer_load_dwordx4 v1, s[8:11], s24 offen sc1 lds
    s_add_u32 m0, s56, 147456
    s_add_u32 s23, s20, 76
    s_mul_i32 s24, s23, 205
    s_lshr_b32 s24, s24, 10
    s_mul_i32 s24, s24, 39680
    s_add_u32 s24, s24, s30
    s_add_u32 s24, s24, 19456
    buffer_load_dwordx4 v1, s[8:11], s24 offen sc1 lds
    s_add_u32 m0, s56, 151552
    s_add_u32 s23, s20, 80
    s_mul_i32 s24, s23, 205
    s_lshr_b32 s24, s24, 10
    s_mul_i32 s24, s24, 39680
    s_add_u32 s24, s24, s30
    s_add_u32 s24, s24, 20480
    buffer_load_dwordx4 v1, s[8:11], s24 offen sc1 lds
    s_add_u32 m0, s56, 155648
    s_add_u32 s23, s20, 84
    s_mul_i32 s24, s23, 205
    s_lshr_b32 s24, s24, 10
    s_mul_i32 s24, s24, 39680
    s_add_u32 s24, s24, s30
    s_add_u32 s24, s24, 21504
    buffer_load_dwordx4 v1, s[8:11], s24 offen sc1 lds
    s_add_u32 m0, s56, 159744
    s_add_u32 s23, s20, 88
    s_mul_i32 s24, s23, 205
    s_lshr_b32 s24, s24, 10
    s_mul_i32 s24, s24, 39680
    s_add_u32 s24, s24, s30
    s_add_u32 s24, s24, 22528
    buffer_load_dwordx4 v1, s[8:11], s24 offen sc1 lds
    s_add_u32 m0, s27, 12288
    s_add_u32 s23, s20, 92
    s_mul_i32 s24, s23, 205
    s_lshr_b32 s24, s24, 10
    s_mul_i32 s24, s24, 39680
    s_add_u32 s24, s24, s30
    s_add_u32 s24, s24, 23552
    buffer_load_dwordx4 v1, s[8:11], s24 offen sc1 lds
    s_add_u32 m0, s27, 13312
    s_add_u32 s23, s20, 96
    s_mul_i32 s24, s23, 205
    s_lshr_b32 s24, s24, 10
    s_mul_i32 s24, s24, 39680
    s_add_u32 s24, s24, s30
    s_add_u32 s24, s24, 24576
    buffer_load_dwordx4 v1, s[8:11], s24 offen sc1 lds
parallel_sum__mha_block__mixer_token_mlp__prompt_kernel_m_de:
    s_cmp_eq_u32 s31, 1
    s_cbranch_scc1 parallel_sum__mha_block__mixer_token_mlp__prompt_kernel_m_oe
    s_mov_b32 exec_lo, 0xffffffff
    s_mov_b32 exec_hi, 0xffffffff
    s_mov_b32 s61, 262144
Lg45:
    buffer_load_dword v167, v166, s[8:11], s33 offen sc1
    s_waitcnt vmcnt(0)
    v_cmp_gt_u32 vcc, 1, v167
    s_nop 4
    s_cbranch_vccz Lg45x
    s_sleep 3
    s_sub_u32 s61, s61, 1
    s_cmp_lg_u32 s61, 0
    s_cbranch_scc1 Lg45
Lg45x:
    s_mov_b64 exec, -1
    buffer_load_dwordx4 v[92:95], v10, s[8:11], s29 offen sc1
    s_add_u32 s29, s29, 131072
    buffer_load_dwordx4 v[96:99], v10, s[8:11], s29 offen sc1
    s_add_u32 s29, s29, 131072
    buffer_load_dwordx4 v[100:103], v10, s[8:11], s29 offen sc1
    s_add_u32 s29, s29, 131072
    buffer_load_dwordx4 v[104:107], v10, s[8:11], s29 offen sc1
    s_add_u32 s29, s29, 131072
    buffer_load_dwordx2 v[108:109], v11, s[8:11], s26 offen sc1
    s_add_u32 s26, s26, 16384
    buffer_load_dwordx2 v[110:111], v11, s[8:11], s26 offen sc1
    s_add_u32 s26, s26, 114688
    buffer_load_dwordx4 v[112:115], v10, s[8:11], s29 offen sc1
    s_add_u32 s29, s29, 131072
    buffer_load_dwordx4 v[116:119], v10, s[8:11], s29 offen sc1
    s_add_u32 s29, s29, 131072
    buffer_load_dwordx4 v[120:123], v10, s[8:11], s29 offen sc1
    s_add_u32 s29, s29, 131072
    buffer_load_dwordx4 v[124:127], v10, s[8:11], s29 offen sc1
    s_add_u32 s29, s29, 131072
    buffer_load_dwordx2 v[128:129], v11, s[8:11], s26 offen sc1
    s_add_u32 s26, s26, 16384
    buffer_load_dwordx2 v[130:131], v11, s[8:11], s26 offen sc1
    s_add_u32 s26, s26, 114688
    buffer_load_dwordx4 v[132:135], v10, s[8:11], s29 offen sc1
    s_add_u32 s29, s29, 131072
    buffer_load_dwordx4 v[136:139], v10, s[8:11], s29 offen sc1
    s_add_u32 s29, s29, 131072
    buffer_load_dwordx4 v[140:143], v10, s[8:11], s29 offen sc1
    s_add_u32 s29, s29, 131072
    buffer_load_dwordx4 v[144:147], v10, s[8:11], s29 offen sc1
    s_add_u32 s29, s29, 131072
    buffer_load_dwordx2 v[148:149], v11, s[8:11], s26 offen sc1
    s_add_u32 s26, s26, 16384
    buffer_load_dwordx2 v[150:151], v11, s[8:11], s26 offen sc1
    s_add_u32 s26, s26, 114688
    buffer_load_dwordx4 v[152:155], v10, s[8:11], s29 offen sc1
    s_add_u32 s29, s29, 131072
    buffer_load_dwordx4 v[156:159], v10, s[8:11], s29 offen sc1
    s_add_u32 s29, s29, 131072
    buffer_load_dwordx4 v[160:163], v10, s[8:11], s29 offen sc1
    s_add_u32 s29, s29, 131072
parallel_sum__mha_block__mixer_token_mlp__prompt_kernel_m_oe:
    buffer_load_dwordx4 v[88:91], v10, s[8:11], s29 offen sc1
    s_add_u32 s29, s29, 131072
    buffer_load_dwordx2 v[164:165], v11, s[8:11], s26 offen sc1
    s_add_u32 s26, s26, 16384
    buffer_load_dwordx2 v[166:167], v11, s[8:11], s26 offen sc1
    s_add_u32 s26, s26, 114688
    s_waitcnt vmcnt(24)
    s_mov_b64 exec, 1
    v_mov_b32 v7, 141764
    v_mov_b32 v8, 1
    ds_add_u32 v7, v8
    s_mov_b64 exec, -1
    s_add_u32 s60, s60, 4
    s_mov_b64 exec, 1
    v_mov_b32 v7, 141764
    s_mov_b32 s61, 1048576
Lw46:
    ds_read_b32 v8, v7
    s_waitcnt lgkmcnt(0)
    v_readfirstlane_b32 s59, v8
    s_nop 0
    s_cmp_ge_u32 s59, s60
    s_cbranch_scc1 Lw46x
    s_sleep 1
    s_sub_u32 s61, s61, 1
    s_cmp_lg_u32 s61, 0
    s_cbranch_scc1 Lw46
Lw46x:
    s_mov_b64 exec, -1
    ds_read_b128 v[32:35], v3 offset:0
    ds_read_b128 v[36:39], v3 offset:1024
    ds_read_b128 v[40:43], v3 offset:2048
    ds_read_b128 v[44:47], v3 offset:3072
    ds_read_b128 v[48:51], v3 offset:4096
    ds_read_b128 v[52:55], v3 offset:5120
    ds_read_b128 v[56:59], v3 offset:6144
    ds_read_b128 v[60:63], v3 offset:7168
    ds_read_b128 v[64:67], v3 offset:8192
    s_waitcnt vmcnt(23) lgkmcnt(4)
    v_mfma_f32_16x16x32_bf16 v[12:15], v[32:35], v[92:95], v[12:15]
    ds_read_b128 v[68:71], v3 offset:9216
    v_mfma_f32_16x16x32_bf16 v[16:19], v[36:39], v[92:95], v[16:19]
    ds_read_b128 v[72:75], v3 offset:10240
    v_mfma_f32_16x16x32_bf16 v[20:23], v[40:43], v[92:95], v[20:23]
    ds_read_b128 v[76:79], v3 offset:11264
    v_mfma_f32_16x16x32_bf16 v[24:27], v[44:47], v[92:95], v[24:27]
    ds_read_b128 v[80:83], v3 offset:12288
    v_mfma_f32_16x16x32_bf16 v[28:31], v[48:51], v[92:95], v[28:31]
    ds_read_b128 v[84:87], v3 offset:13312
    s_waitcnt vmcnt(22) lgkmcnt(4)
    v_mfma_f32_16x16x32_bf16 v[12:15], v[52:55], v[96:99], v[12:15]
    ds_read_b128 v[32:35], v3 offset:14336
    v_mfma_f32_16x16x32_bf16 v[16:19], v[56:59], v[96:99], v[16:19]
    ds_read_b128 v[36:39], v3 offset:15360
    v_mfma_f32_16x16x32_bf16 v[20:23], v[60:63], v[96:99], v[20:23]
    ds_read_b128 v[40:43], v3 offset:16384
    v_mfma_f32_16x16x32_bf16 v[24:27], v[64:67], v[96:99], v[24:27]
    ds_read_b128 v[44:47], v3 offset:17408
    v_mfma_f32_16x16x32_bf16 v[28:31], v[68:71], v[96:99], v[28:31]
    ds_read_b128 v[48:51], v3 offset:18432
    s_waitcnt vmcnt(21) lgkmcnt(4)
    v_mfma_f32_16x16x32_bf16 v[12:15], v[72:75], v[100:103], v[12:15]
    ds_read_b128 v[52:55], v3 offset:19456
    v_mfma_f32_16x16x32_bf16 v[16:19], v[76:79], v[100:103], v[16:19]
    ds_read_b128 v[56:59], v3 offset:20480
    v_mfma_f32_16x16x32_bf16 v[20:23], v[80:83], v[100:103], v[20:23]
    ds_read_b128 v[60:63], v3 offset:21504
    v_mfma_f32_16x16x32_bf16 v[24:27], v[84:87], v[100:103], v[24:27]
    ds_read_b128 v[64:67], v3 offset:22528
    v_mfma_f32_16x16x32_bf16 v[28:31], v[32:35], v[100:103], v[28:31]
    ds_read_b128 v[68:71], v3 offset:23552
    s_waitcnt vmcnt(20) lgkmcnt(4)
    v_mfma_f32_16x16x32_bf16 v[12:15], v[36:39], v[104:107], v[12:15]
    ds_read_b128 v[72:75], v3 offset:24576
    v_mfma_f32_16x16x32_bf16 v[16:19], v[40:43], v[104:107], v[16:19]
    ds_read_b128 v[76:79], v3 offset:25600
    v_mfma_f32_16x16x32_bf16 v[20:23], v[44:47], v[104:107], v[20:23]
    ds_read_b128 v[80:83], v3 offset:26624
    v_mfma_f32_16x16x32_bf16 v[24:27], v[48:51], v[104:107], v[24:27]
    ds_read_b128 v[84:87], v3 offset:27648
    v_mfma_f32_16x16x32_bf16 v[28:31], v[52:55], v[104:107], v[28:31]
    ds_read_b128 v[32:35], v3 offset:28672
    s_waitcnt vmcnt(18) lgkmcnt(4)
    v_mfma_f32_16x16x32_bf16 v[12:15], v[56:59], v[108:111], v[12:15]
    ds_read_b128 v[36:39], v3 offset:29696
    v_mfma_f32_16x16x32_bf16 v[16:19], v[60:63], v[108:111], v[16:19]
    ds_read_b128 v[40:43], v3 offset:30720
    v_mfma_f32_16x16x32_bf16 v[20:23], v[64:67], v[108:111], v[20:23]
    ds_read_b128 v[44:47], v3 offset:31744
    v_mfma_f32_16x16x32_bf16 v[24:27], v[68:71], v[108:111], v[24:27]
    ds_read_b128 v[48:51], v3 offset:32768
    v_mfma_f32_16x16x32_bf16 v[28:31], v[72:75], v[108:111], v[28:31]
    ds_read_b128 v[52:55], v3 offset:33792
    s_waitcnt vmcnt(17) lgkmcnt(4)
    v_mfma_f32_16x16x32_bf16 v[12:15], v[76:79], v[112:115], v[12:15]
    ds_read_b128 v[56:59], v3 offset:34816
    v_mfma_f32_16x16x32_bf16 v[16:19], v[80:83], v[112:115], v[16:19]
    ds_read_b128 v[60:63], v3 offset:35840
    v_mfma_f32_16x16x32_bf16 v[20:23], v[84:87], v[112:115], v[20:23]
    ds_read_b128 v[64:67], v3 offset:36864
    v_mfma_f32_16x16x32_bf16 v[24:27], v[32:35], v[112:115], v[24:27]
    ds_read_b128 v[68:71], v3 offset:37888
    v_mfma_f32_16x16x32_bf16 v[28:31], v[36:39], v[112:115], v[28:31]
    ds_read_b128 v[72:75], v3 offset:38912
    s_waitcnt vmcnt(16) lgkmcnt(4)
    v_mfma_f32_16x16x32_bf16 v[12:15], v[40:43], v[116:119], v[12:15]
    ds_read_b128 v[76:79], v3 offset:39936
    v_mfma_f32_16x16x32_bf16 v[16:19], v[44:47], v[116:119], v[16:19]
    ds_read_b128 v[80:83], v3 offset:40960
    v_mfma_f32_16x16x32_bf16 v[20:23], v[48:51], v[116:119], v[20:23]
    ds_read_b128 v[84:87], v3 offset:41984
    v_mfma_f32_16x16x32_bf16 v[24:27], v[52:55], v[116:119], v[24:27]
    ds_read_b128 v[32:35], v3 offset:43008
    v_mfma_f32_16x16x32_bf16 v[28:31], v[56:59], v[116:119], v[28:31]
    ds_read_b128 v[36:39], v3 offset:44032
    s_waitcnt vmcnt(15) lgkmcnt(4)
    v_mfma_f32_16x16x32_bf16 v[12:15], v[60:63], v[120:123], v[12:15]
    ds_read_b128 v[40:43], v3 offset:45056
    v_mfma_f32_16x16x32_bf16 v[16:19], v[64:67], v[120:123], v[16:19]
    ds_read_b128 v[44:47], v3 offset:46080
    v_mfma_f32_16x16x32_bf16 v[20:23], v[68:71], v[120:123], v[20:23]
    ds_read_b128 v[48:51], v3 offset:47104
    v_mfma_f32_16x16x32_bf16 v[24:27], v[72:75], v[120:123], v[24:27]
    ds_read_b128 v[52:55], v3 offset:48128
    v_mfma_f32_16x16x32_bf16 v[28:31], v[76:79], v[120:123], v[28:31]
    ds_read_b128 v[56:59], v3 offset:49152
    s_waitcnt vmcnt(14) lgkmcnt(4)
    v_mfma_f32_16x16x32_bf16 v[12:15], v[80:83], v[124:127], v[12:15]
    ds_read_b128 v[60:63], v3 offset:50176
    v_mfma_f32_16x16x32_bf16 v[16:19], v[84:87], v[124:127], v[16:19]
    ds_read_b128 v[64:67], v3 offset:51200
    v_mfma_f32_16x16x32_bf16 v[20:23], v[32:35], v[124:127], v[20:23]
    ds_read_b128 v[68:71], v3 offset:52224
    v_mfma_f32_16x16x32_bf16 v[24:27], v[36:39], v[124:127], v[24:27]
    ds_read_b128 v[72:75], v3 offset:53248
    v_mfma_f32_16x16x32_bf16 v[28:31], v[40:43], v[124:127], v[28:31]
    ds_read_b128 v[76:79], v3 offset:54272
    s_waitcnt vmcnt(12) lgkmcnt(4)
    v_mfma_f32_16x16x32_bf16 v[12:15], v[44:47], v[128:131], v[12:15]
    ds_read_b128 v[80:83], v3 offset:55296
    v_mfma_f32_16x16x32_bf16 v[16:19], v[48:51], v[128:131], v[16:19]
    ds_read_b128 v[84:87], v3 offset:56320
    v_mfma_f32_16x16x32_bf16 v[20:23], v[52:55], v[128:131], v[20:23]
    ds_read_b128 v[32:35], v3 offset:57344
    v_mfma_f32_16x16x32_bf16 v[24:27], v[56:59], v[128:131], v[24:27]
    ds_read_b128 v[36:39], v3 offset:58368
    v_mfma_f32_16x16x32_bf16 v[28:31], v[60:63], v[128:131], v[28:31]
    ds_read_b128 v[40:43], v3 offset:59392
    s_waitcnt vmcnt(11) lgkmcnt(4)
    v_mfma_f32_16x16x32_bf16 v[12:15], v[64:67], v[132:135], v[12:15]
    ds_read_b128 v[44:47], v3 offset:60416
    v_mfma_f32_16x16x32_bf16 v[16:19], v[68:71], v[132:135], v[16:19]
    ds_read_b128 v[48:51], v3 offset:61440
    v_mfma_f32_16x16x32_bf16 v[20:23], v[72:75], v[132:135], v[20:23]
    ds_read_b128 v[52:55], v3 offset:62464
    v_mfma_f32_16x16x32_bf16 v[24:27], v[76:79], v[132:135], v[24:27]
    ds_read_b128 v[56:59], v3 offset:63488
    v_mfma_f32_16x16x32_bf16 v[28:31], v[80:83], v[132:135], v[28:31]
    ds_read_b128 v[60:63], v3 offset:64512
    s_waitcnt vmcnt(10) lgkmcnt(4)
    v_mfma_f32_16x16x32_bf16 v[12:15], v[84:87], v[136:139], v[12:15]
    ds_read_b128 v[64:67], v4 offset:0
    v_mfma_f32_16x16x32_bf16 v[16:19], v[32:35], v[136:139], v[16:19]
    ds_read_b128 v[68:71], v4 offset:1024
    v_mfma_f32_16x16x32_bf16 v[20:23], v[36:39], v[136:139], v[20:23]
    ds_read_b128 v[72:75], v4 offset:2048
    v_mfma_f32_16x16x32_bf16 v[24:27], v[40:43], v[136:139], v[24:27]
    ds_read_b128 v[76:79], v4 offset:3072
    v_mfma_f32_16x16x32_bf16 v[28:31], v[44:47], v[136:139], v[28:31]
    ds_read_b128 v[80:83], v4 offset:4096
    s_waitcnt vmcnt(9) lgkmcnt(4)
    v_mfma_f32_16x16x32_bf16 v[12:15], v[48:51], v[140:143], v[12:15]
    ds_read_b128 v[84:87], v4 offset:5120
    v_mfma_f32_16x16x32_bf16 v[16:19], v[52:55], v[140:143], v[16:19]
    ds_read_b128 v[32:35], v4 offset:6144
    v_mfma_f32_16x16x32_bf16 v[20:23], v[56:59], v[140:143], v[20:23]
    ds_read_b128 v[36:39], v4 offset:7168
    v_mfma_f32_16x16x32_bf16 v[24:27], v[60:63], v[140:143], v[24:27]
    ds_read_b128 v[40:43], v4 offset:12288
    v_mfma_f32_16x16x32_bf16 v[28:31], v[64:67], v[140:143], v[28:31]
    ds_read_b128 v[44:47], v4 offset:13312
    s_waitcnt vmcnt(8) lgkmcnt(4)
    v_mfma_f32_16x16x32_bf16 v[12:15], v[68:71], v[144:147], v[12:15]
    ds_read_b128 v[48:51], v4 offset:14336
    v_mfma_f32_16x16x32_bf16 v[16:19], v[72:75], v[144:147], v[16:19]
    ds_read_b128 v[52:55], v4 offset:15360
    v_mfma_f32_16x16x32_bf16 v[20:23], v[76:79], v[144:147], v[20:23]
    ds_read_b128 v[56:59], v4 offset:16384
    v_mfma_f32_16x16x32_bf16 v[24:27], v[80:83], v[144:147], v[24:27]
    ds_read_b128 v[60:63], v4 offset:17408
    v_mfma_f32_16x16x32_bf16 v[28:31], v[84:87], v[144:147], v[28:31]
    ds_read_b128 v[64:67], v4 offset:18432
    s_waitcnt vmcnt(6) lgkmcnt(4)
    v_mfma_f32_16x16x32_bf16 v[12:15], v[32:35], v[148:151], v[12:15]
    ds_read_b128 v[68:71], v4 offset:19456
    v_mfma_f32_16x16x32_bf16 v[16:19], v[36:39], v[148:151], v[16:19]
    ds_read_b128 v[72:75], v4 offset:20480
    v_mfma_f32_16x16x32_bf16 v[20:23], v[40:43], v[148:151], v[20:23]
    ds_read_b128 v[76:79], v4 offset:21504
    v_mfma_f32_16x16x32_bf16 v[24:27], v[44:47], v[148:151], v[24:27]
    ds_read_b128 v[80:83], v4 offset:22528
    v_mfma_f32_16x16x32_bf16 v[28:31], v[48:51], v[148:151], v[28:31]
    ds_read_b128 v[84:87], v4 offset:23552
    v_and_b32 v7, 15, v0
    v_mul_u32_u24 v6, 176, v7
    v_bfe_u32 v7, v0, 4, 2
    v_lshl_add_u32 v6, v7, 3, v6
    v_add_u32 v6, s27, v6
    v_and_b32 v7, 63, v0
    v_add_u32 v7, 0, v7
    v_mul_u32_u24 v8, 0xcccd, v7
    v_lshrrev_b32 v8, 19, v8
    v_lshlrev_b32 v7, 4, v7
    v_mul_u32_u24 v96, 1120, v8
    v_add_u32 v96, v96, v7
    v_lshl_add_u32 v92, v8, 4, v7
    v_add_u32 v92, s27, v92
    v_and_b32 v7, 63, v0
    v_add_u32 v7, 64, v7
    v_mul_u32_u24 v8, 0xcccd, v7
    v_lshrrev_b32 v8, 19, v8
    v_lshlrev_b32 v7, 4, v7
    v_mul_u32_u24 v97, 1120, v8
    v_add_u32 v97, v97, v7
    v_lshl_add_u32 v93, v8, 4, v7
    v_add_u32 v93, s27, v93
    v_and_b32 v7, 63, v0
    v_add_u32 v7, 128, v7
    v_mul_u32_u24 v8, 0xcccd, v7
    v_lshrrev_b32 v8, 19, v8
    v_lshlrev_b32 v7, 4, v7
    v_mul_u32_u24 v98, 1120, v8
    v_add_u32 v98, v98, v7
    v_lshl_add_u32 v94, v8, 4, v7
    v_add_u32 v94, s27, v94
    s_waitcnt vmcnt(5) lgkmcnt(4)
    v_mfma_f32_16x16x32_bf16 v[12:15], v[52:55], v[152:155], v[12:15]
    ds_read_b128 v[32:35], v4 offset:24576
    v_mfma_f32_16x16x32_bf16 v[16:19], v[56:59], v[152:155], v[16:19]
    ds_read_b128 v[36:39], v4 offset:25600
    v_mfma_f32_16x16x32_bf16 v[20:23], v[60:63], v[152:155], v[20:23]
    ds_read_b128 v[40:43], v4 offset:26624
    v_mfma_f32_16x16x32_bf16 v[24:27], v[64:67], v[152:155], v[24:27]
    ds_read_b128 v[44:47], v4 offset:27648
    v_mfma_f32_16x16x32_bf16 v[28:31], v[68:71], v[152:155], v[28:31]
    ds_read_b128 v[48:51], v4 offset:28672
    s_waitcnt vmcnt(4) lgkmcnt(4)
    v_mfma_f32_16x16x32_bf16 v[12:15], v[72:75], v[156:159], v[12:15]
    ds_read_b128 v[52:55], v4 offset:29696
    v_mfma_f32_16x16x32_bf16 v[16:19], v[76:79], v[156:159], v[16:19]
    ds_read_b128 v[56:59], v4 offset:30720
    v_mfma_f32_16x16x32_bf16 v[20:23], v[80:83], v[156:159], v[20:23]
    ds_read_b128 v[60:63], v4 offset:31744
    v_mfma_f32_16x16x32_bf16 v[24:27], v[84:87], v[156:159], v[24:27]
    ds_read_b128 v[64:67], v5 offset:12288
    v_mfma_f32_16x16x32_bf16 v[28:31], v[32:35], v[156:159], v[28:31]
    ds_read_b128 v[68:71], v5 offset:28672
    s_waitcnt vmcnt(3) lgkmcnt(4)
    v_mfma_f32_16x16x32_bf16 v[12:15], v[36:39], v[160:163], v[12:15]
    ds_read_b128 v[72:75], v5 offset:45056
    v_mfma_f32_16x16x32_bf16 v[16:19], v[40:43], v[160:163], v[16:19]
    ds_read_b128 v[76:79], v5 offset:61440
    v_mfma_f32_16x16x32_bf16 v[20:23], v[44:47], v[160:163], v[20:23]
    ds_read_b128 v[80:83], v5 offset:13312
    v_mfma_f32_16x16x32_bf16 v[24:27], v[48:51], v[160:163], v[24:27]
    ds_read_b128 v[84:87], v5 offset:29696
    v_mfma_f32_16x16x32_bf16 v[28:31], v[52:55], v[160:163], v[28:31]
    ds_read_b128 v[32:35], v5 offset:46080
    s_waitcnt vmcnt(2) lgkmcnt(4)
    v_mfma_f32_16x16x32_bf16 v[12:15], v[56:59], v[88:91], v[12:15]
    ds_read_b128 v[36:39], v5 offset:62464
    v_mfma_f32_16x16x32_bf16 v[16:19], v[60:63], v[88:91], v[16:19]
    v_mfma_f32_16x16x32_bf16 v[20:23], v[64:67], v[88:91], v[20:23]
    v_mfma_f32_16x16x32_bf16 v[24:27], v[68:71], v[88:91], v[24:27]
    v_mfma_f32_16x16x32_bf16 v[28:31], v[72:75], v[88:91], v[28:31]
    s_waitcnt vmcnt(0) lgkmcnt(0)
    v_mfma_f32_16x16x32_bf16 v[12:15], v[76:79], v[164:167], v[12:15]
    v_mfma_f32_16x16x32_bf16 v[16:19], v[80:83], v[164:167], v[16:19]
    v_mfma_f32_16x16x32_bf16 v[20:23], v[84:87], v[164:167], v[20:23]
    v_mfma_f32_16x16x32_bf16 v[24:27], v[32:35], v[164:167], v[24:27]
    v_mfma_f32_16x16x32_bf16 v[28:31], v[36:39], v[164:167], v[28:31]
    s_nop 3
    v_cvt_pk_bf16_f32 v12, v12, v13
    v_cvt_pk_bf16_f32 v13, v14, v15
    ds_write_b64 v6, v[12:13] offset:0
    v_cvt_pk_bf16_f32 v16, v16, v17
    v_cvt_pk_bf16_f32 v17, v18, v19
    ds_write_b64 v6, v[16:17] offset:32
    v_cvt_pk_bf16_f32 v20, v20, v21
    v_cvt_pk_bf16_f32 v21, v22, v23
    ds_write_b64 v6, v[20:21] offset:64
    v_cvt_pk_bf16_f32 v24, v24, v25
    v_cvt_pk_bf16_f32 v25, v26, v27
    ds_write_b64 v6, v[24:25] offset:96
    v_cvt_pk_bf16_f32 v28, v28, v29
    v_cvt_pk_bf16_f32 v29, v30, v31
    ds_write_b64 v6, v[28:29] offset:128
    s_waitcnt lgkmcnt(0)
    ds_read_b128 v[108:111], v92
    ds_read_b128 v[112:115], v93
    ds_read_b128 v[116:119], v94
    s_waitcnt lgkmcnt(2)
    buffer_store_dwordx4 v[108:111], v96, s[52:55], s58 offen
    s_waitcnt lgkmcnt(1)
    buffer_store_dwordx4 v[112:115], v97, s[52:55], s58 offen
    s_waitcnt lgkmcnt(0)
    s_mov_b32 exec_hi, 0
    buffer_store_dwordx4 v[116:119], v98, s[52:55], s58 offen
    s_endpgm
parallel_sum__mha_block__mixer_token_mlp__prompt_kernel_end:
    s_endpgm
code_end:
    s_endpgm
.section .rodata,"a"
.p2align 6
.amdhsa_kernel parallel_sum__mha_block__mixer_token_mlp__prompt_kernel
  .amdhsa_next_free_vgpr 168
  .amdhsa_next_free_sgpr 64
  .amdhsa_accum_offset 168
  .amdhsa_group_segment_fixed_size 0
  .amdhsa_kernarg_size 88
  .amdhsa_user_sgpr_count 2
  .amdhsa_user_sgpr_kernarg_segment_ptr 1
  .amdhsa_system_sgpr_workgroup_id_x 1
.end_amdhsa_kernel
```
